```python
import torch

def _softmax(x, axis=-1):
    return torch.softmax(x, dim=axis)
def _gelu(x):
    return torch.nn.functional.gelu(x, approximate="tanh")
def _silu(x):
    return torch.nn.functional.silu(x)
def _sigmoid(x):
    return torch.sigmoid(x)
def _layernorm(x, axis=-1, eps=1e-5):
    m = x.mean(dim=axis, keepdim=True)
    v = x.var(dim=axis, keepdim=True, unbiased=False)
    return (x - m) / torch.sqrt(v + eps)
def _scatter_add(tgt, idx, src, axis=0):
    return tgt.clone().index_add_(axis, idx, src)
def _segment_sum(src, seg, n):
    out = torch.zeros((n,) + src.shape[1:], dtype=src.dtype)
    return out.index_add_(0, seg, src)
def _pad(x, pw):
    flat = tuple(v for pair in reversed(pw) for v in pair)
    return torch.nn.functional.pad(x, flat)

kernel_name = 'sequential_preLN__mha_block__mixer_token_mlp__prompt'

def setup_inputs():

    _w = (lambda a: (lambda t: t.to(torch.bfloat16) if t.is_floating_point() else t)(torch.as_tensor(a)))
    def _A_setup():
        B, S, D, H = 1, 2048, 512, 32
        return {
            "x": _w((lambda *s: torch.randn(*s, dtype=torch.bfloat16) * 0.05)(B, S, D)),
            "wqkv": _w((lambda *s: torch.randn(*s, dtype=torch.bfloat16) * 0.05)(D, 3 * D)),
            "wo": _w((lambda *s: torch.randn(*s, dtype=torch.bfloat16) * 0.05)(D, D)),
        }
    _A_in = _A_setup()

    def _B_setup():
        B, S, D, F = 1, 2048, 512, 1376
        return {
            "x": _w((lambda *s: torch.randn(*s, dtype=torch.bfloat16) * 0.05)(B, S, D)),
            "w1": _w((lambda *s: torch.randn(*s, dtype=torch.bfloat16) * 0.8)(S, F) * (S ** -0.5)),
            "b1": _w((lambda *s: torch.randn(*s, dtype=torch.bfloat16) * 12.8)(F) * 0.02),
            "w2": _w((lambda *s: torch.randn(*s, dtype=torch.bfloat16) * 0.2)(F, S) * (F ** -0.5)),
            "b2": _w((lambda *s: torch.randn(*s, dtype=torch.bfloat16) * 3.2)(S) * 0.02),
        }
    _B_in = _B_setup()

    return {
        "A_x": _A_in["x"],
        "A_wqkv": _A_in["wqkv"],
        "A_wo": _A_in["wo"],
        "B_x": _B_in["x"],
        "B_w1": _B_in["w1"],
        "B_b1": _B_in["b1"],
        "B_w2": _B_in["w2"],
        "B_b2": _B_in["b2"],
    }

def reference(A_x, A_wqkv, A_wo, B_x, B_w1, B_b1, B_w2, B_b2):
    def _A_ref(x, wqkv, wo):
        B, S, D = x.shape
        H = 32
        Dh = D // H
        qkv = (lambda x, *d: x.permute(*d))((x @ wqkv).reshape(B, S, 3, H, Dh), 2, 0, 3, 1, 4)
        q, k, v = qkv[0], qkv[1], qkv[2]
        scores = torch.einsum("bhqd,bhkd->bhqk", q, k) * (Dh ** -0.5)
        p = _softmax(scores, axis=-1)
        o = torch.einsum("bhqk,bhkd->bhqd", p, v)
        return (lambda x, *d: x.permute(*d))(o, 0, 2, 1, 3).reshape(B, S, D) @ wo

    def _B_ref(x, w1, b1, w2, b2):
        B, S, D = x.shape
        h = _layernorm(x, axis=-1)
        u = torch.einsum("bsd,sf->bdf", h, w1) + b1
        u = _gelu(u)
        y = torch.einsum("bdf,fs->bds", u, w2) + b2
        return (lambda x, *d: x.permute(*d))(y, 0, 2, 1)

    x = A_x
    h = x + _A_ref(_layernorm(x, axis=-1), A_wqkv, A_wo)
    h2 = h + _B_ref(_layernorm(h, axis=-1), B_w1, B_b1, B_w2, B_b2)
    return h2
```

```asm
; @launch grid=(256,1,1) block=(512,1,1) lds=163840
.amdgcn_target "amdgcn-amd-amdhsa--gfx950"
.text
.globl sequential_preLN__mha_block__mixer_token_mlp__prompt_kernel
.p2align 8
.type sequential_preLN__mha_block__mixer_token_mlp__prompt_kernel,@function
sequential_preLN__mha_block__mixer_token_mlp__prompt_kernel:
    s_cmp_ge_u32 s2, 256
    s_cbranch_scc1 L_end
    s_load_dwordx16 s[4:19], s[0:1], 0
    s_load_dwordx4 s[20:23], s[0:1], 64
    s_load_dwordx2 s[24:25], s[0:1], 80
    v_and_b32 v1, 63, v0
    v_lshrrev_b32 v2, 6, v0
    s_and_b32 s27, s2, 7
    v_readfirstlane_b32 s26, v2
    s_lshr_b32 s3, s2, 3
    s_waitcnt lgkmcnt(0)
    s_mov_b32 s36, s24
    s_and_b32 s37, s25, 0xffff
    s_mov_b32 s38, 0x1000000
    s_mov_b32 s39, 0x20000
    s_cmp_lg_u32 s2, 0
    s_cbranch_scc1 L_nz_1
    s_cmp_lg_u32 s26, 3
    s_cbranch_scc1 L_nz_1
    v_lshlrev_b32 v2, 8, v1
    v_mov_b32 v3, 0
    s_mov_b32 s40, 14417920
    buffer_store_dword v3, v2, s[36:39], s40 offen sc1
    s_add_u32 s40, s40, 16384
    buffer_store_dword v3, v2, s[36:39], s40 offen sc1
    s_add_u32 s40, s40, 16384
    buffer_store_dword v3, v2, s[36:39], s40 offen sc1
    s_add_u32 s40, s40, 16384
    buffer_store_dword v3, v2, s[36:39], s40 offen sc1
    s_add_u32 s40, s40, 16384
    buffer_store_dword v3, v2, s[36:39], s40 offen sc1
    s_add_u32 s40, s40, 16384
    s_waitcnt vmcnt(0)
    s_memrealtime s[40:41]
    s_waitcnt lgkmcnt(0)
    s_or_b32 s40, s40, 1
    v_mov_b32 v2, 0
    v_mov_b32 v3, s40
    s_mov_b64 exec, 1
    global_store_dword v2, v3, s[22:23] sc1
    s_mov_b64 exec, -1
L_nz_1:
    s_lshr_b32 s41, s27, 1
    s_lshl_b32 s41, s41, 3
    s_and_b32 s44, s3, 7
    s_add_u32 s41, s41, s44
    s_and_b32 s40, s27, 1
    s_lshl_b32 s40, s40, 2
    s_lshr_b32 s44, s3, 3
    s_add_u32 s40, s40, s44
    s_lshr_b32 s42, s26, 2
    s_and_b32 s43, s26, 3
    s_mov_b32 s28, s4
    s_and_b32 s29, s5, 0xffff
    s_mov_b32 s30, 0x200000
    s_mov_b32 s31, 0x20000
    s_mov_b32 s32, s6
    s_and_b32 s33, s7, 0xffff
    s_mov_b32 s34, 0x180000
    s_mov_b32 s35, 0x20000
    v_lshrrev_b32 v5, 3, v1
    v_lshlrev_b32 v18, 10, v5
    v_and_b32 v6, 7, v1
    v_lshrrev_b32 v7, 4, v1
    v_xor_b32 v7, v6, v7
    v_lshl_add_u32 v18, v7, 4, v18
    s_and_b32 s44, s26, 1
    s_lshl_b32 s48, s44, 6
    v_xor_b32 v18, s48, v18
    v_mul_u32_u24 v19, 3072, v5
    v_bfe_u32 v7, v1, 4, 1
    s_lshl_b32 s48, s44, 1
    v_or_b32 v7, s48, v7
    v_lshlrev_b32 v7, 1, v7
    v_xor_b32 v7, v7, v6
    v_lshl_add_u32 v19, v7, 4, v19
    s_lshl_b32 s45, s41, 16
    s_lshl_b32 s44, s26, 13
    s_add_u32 s45, s45, s44
    s_mul_i32 s46, s26, 24576
    s_lshl_b32 s44, s40, 7
    s_add_u32 s46, s46, s44
    s_lshl_b32 s47, s26, 10
    s_lshr_b32 s49, s3, 3
    s_and_b32 s44, s3, 7
    s_add_u32 s49, s49, s44
    s_mul_i32 s49, s49, 1
    s_add_u32 s50, s49, 0
    s_and_b32 s50, s50, 7
    s_lshl_b32 s51, s50, 7
    s_add_u32 s51, s51, s45
    s_add_u32 m0, s47, 0
    s_mul_i32 s50, s50, 196608
    buffer_load_dwordx4 v18, s[28:31], s51 offen lds
    s_add_u32 s50, s50, s46
    s_add_u32 m0, s47, 8192
    s_add_u32 s44, s50, 0
    buffer_load_dwordx4 v19, s[32:35], s44 offen lds
    s_add_u32 m0, s47, 16384
    s_add_u32 s44, s50, 1024
    buffer_load_dwordx4 v19, s[32:35], s44 offen lds
    s_add_u32 m0, s47, 24576
    s_add_u32 s44, s50, 2048
    buffer_load_dwordx4 v19, s[32:35], s44 offen lds
    s_add_u32 s50, s49, 1
    s_and_b32 s50, s50, 7
    s_lshl_b32 s51, s50, 7
    s_add_u32 s51, s51, s45
    s_add_u32 m0, s47, 32768
    s_mul_i32 s50, s50, 196608
    buffer_load_dwordx4 v18, s[28:31], s51 offen lds
    s_add_u32 s50, s50, s46
    s_add_u32 m0, s47, 40960
    s_add_u32 s44, s50, 0
    buffer_load_dwordx4 v19, s[32:35], s44 offen lds
    s_add_u32 m0, s47, 49152
    s_add_u32 s44, s50, 1024
    buffer_load_dwordx4 v19, s[32:35], s44 offen lds
    s_add_u32 m0, s47, 57344
    s_add_u32 s44, s50, 2048
    buffer_load_dwordx4 v19, s[32:35], s44 offen lds
    v_and_b32 v3, 15, v1
    v_lshrrev_b32 v4, 4, v1
    v_lshrrev_b32 v5, 1, v3
    v_xor_b32 v5, v5, v4
    v_lshlrev_b32 v5, 4, v5
    s_lshl_b32 s44, s42, 12
    v_lshlrev_b32 v6, 7, v3
    v_add_u32 v6, s44, v6
    v_add_u32 v8, v6, v5
    v_xor_b32 v5, 64, v5
    v_add_u32 v9, v6, v5
    v_lshrrev_b32 v5, 2, v3
    v_lshl_add_u32 v6, v4, 3, v5
    v_lshlrev_b32 v6, 7, v6
    v_lshrrev_b32 v5, 1, v5
    v_and_b32 v7, 1, v4
    v_lshl_or_b32 v5, v7, 1, v5
    v_xor_b32 v5, s43, v5
    v_lshl_add_u32 v6, v5, 5, v6
    v_and_b32 v5, 3, v3
    v_lshl_add_u32 v6, v5, 3, v6
    v_add_u32 v10, 8192, v6
    v_mov_b32 v32, 0
    v_mov_b32 v33, 0
    v_mov_b32 v34, 0
    v_mov_b32 v35, 0
    v_mov_b32 v36, 0
    v_mov_b32 v37, 0
    v_mov_b32 v38, 0
    v_mov_b32 v39, 0
    v_mov_b32 v40, 0
    v_mov_b32 v41, 0
    v_mov_b32 v42, 0
    v_mov_b32 v43, 0
    v_mov_b32 v44, 0
    v_mov_b32 v45, 0
    v_mov_b32 v46, 0
    v_mov_b32 v47, 0
    v_mov_b32 v48, 0
    v_mov_b32 v49, 0
    v_mov_b32 v50, 0
    v_mov_b32 v51, 0
    v_mov_b32 v52, 0
    v_mov_b32 v53, 0
    v_mov_b32 v54, 0
    v_mov_b32 v55, 0
    v_mov_b32 v56, 0
    v_mov_b32 v57, 0
    v_mov_b32 v58, 0
    v_mov_b32 v59, 0
    v_mov_b32 v60, 0
    v_mov_b32 v61, 0
    v_mov_b32 v62, 0
    v_mov_b32 v63, 0
    v_mov_b32 v64, 0
    v_mov_b32 v65, 0
    v_mov_b32 v66, 0
    v_mov_b32 v67, 0
    v_mov_b32 v68, 0
    v_mov_b32 v69, 0
    v_mov_b32 v70, 0
    v_mov_b32 v71, 0
    v_mov_b32 v72, 0
    v_mov_b32 v73, 0
    v_mov_b32 v74, 0
    v_mov_b32 v75, 0
    v_mov_b32 v20, 0x3f803f80
    v_mov_b32 v21, 0x3f803f80
    v_mov_b32 v22, 0x3f803f80
    v_mov_b32 v23, 0x3f803f80
    s_cmp_eq_u32 s26, 1
    s_cbranch_scc1 L_k1_c1
    s_cmp_eq_u32 s26, 2
    s_cbranch_scc1 L_k1_c2
    s_cmp_eq_u32 s26, 3
    s_cbranch_scc1 L_k1_c3
    s_cmp_eq_u32 s26, 4
    s_cbranch_scc1 L_k1_c4
    s_cmp_eq_u32 s26, 5
    s_cbranch_scc1 L_k1_c5
    s_cmp_eq_u32 s26, 6
    s_cbranch_scc1 L_k1_c6
    s_cmp_eq_u32 s26, 7
    s_cbranch_scc1 L_k1_c7
    s_waitcnt vmcnt(4) lgkmcnt(0)
    s_barrier
    v_add_u32 v11, 0, v8
    v_add_u32 v12, 0, v9
    v_add_u32 v13, 0, v10
    ds_read_b128 v[80:83], v11 offset:0
    ds_read_b128 v[88:91], v11 offset:2048
    ds_read_b64_tr_b16 v[96:97], v13 offset:0
    ds_read_b64_tr_b16 v[98:99], v13 offset:512
    ds_read_b64_tr_b16 v[104:105], v13 offset:8192
    ds_read_b64_tr_b16 v[106:107], v13 offset:8704
    ds_read_b64_tr_b16 v[112:113], v13 offset:16384
    ds_read_b64_tr_b16 v[114:115], v13 offset:16896
    ds_read_b128 v[84:87], v12 offset:0
    ds_read_b128 v[92:95], v12 offset:2048
    ds_read_b64_tr_b16 v[100:101], v13 offset:4096
    ds_read_b64_tr_b16 v[102:103], v13 offset:4608
    ds_read_b64_tr_b16 v[108:109], v13 offset:12288
    ds_read_b64_tr_b16 v[110:111], v13 offset:12800
    ds_read_b64_tr_b16 v[116:117], v13 offset:20480
    ds_read_b64_tr_b16 v[118:119], v13 offset:20992
    s_add_u32 s50, s49, 2
    s_and_b32 s50, s50, 7
    s_lshl_b32 s51, s50, 7
    s_add_u32 s51, s51, s45
    s_add_u32 m0, s47, 65536
    s_mul_i32 s50, s50, 196608
    buffer_load_dwordx4 v18, s[28:31], s51 offen lds
    s_add_u32 s50, s50, s46
    s_add_u32 m0, s47, 73728
    s_add_u32 s44, s50, 0
    buffer_load_dwordx4 v19, s[32:35], s44 offen lds
    s_add_u32 m0, s47, 81920
    s_add_u32 s44, s50, 1024
    buffer_load_dwordx4 v19, s[32:35], s44 offen lds
    s_add_u32 m0, s47, 90112
    s_add_u32 s44, s50, 2048
    buffer_load_dwordx4 v19, s[32:35], s44 offen lds
    s_add_u32 s50, s49, 3
    s_and_b32 s50, s50, 7
    s_lshl_b32 s51, s50, 7
    s_add_u32 s51, s51, s45
    s_add_u32 m0, s47, 98304
    s_mul_i32 s50, s50, 196608
    buffer_load_dwordx4 v18, s[28:31], s51 offen lds
    s_add_u32 s50, s50, s46
    s_add_u32 m0, s47, 106496
    s_add_u32 s44, s50, 0
    buffer_load_dwordx4 v19, s[32:35], s44 offen lds
    s_add_u32 m0, s47, 114688
    s_add_u32 s44, s50, 1024
    buffer_load_dwordx4 v19, s[32:35], s44 offen lds
    s_add_u32 m0, s47, 122880
    s_add_u32 s44, s50, 2048
    buffer_load_dwordx4 v19, s[32:35], s44 offen lds
    s_waitcnt vmcnt(8) lgkmcnt(0)
    s_barrier
    v_add_u32 v11, 32768, v8
    v_add_u32 v12, 32768, v9
    v_add_u32 v13, 32768, v10
    v_mfma_f32_16x16x32_bf16 v[32:35], v[96:99], v[80:83], v[32:35]
    ds_read_b128 v[120:123], v11 offset:0
    ds_read_b128 v[128:131], v11 offset:2048
    v_mfma_f32_16x16x32_bf16 v[40:43], v[104:107], v[80:83], v[40:43]
    ds_read_b64_tr_b16 v[136:137], v13 offset:0
    ds_read_b64_tr_b16 v[138:139], v13 offset:512
    v_mfma_f32_16x16x32_bf16 v[48:51], v[80:83], v[112:115], v[48:51]
    ds_read_b64_tr_b16 v[144:145], v13 offset:8192
    ds_read_b64_tr_b16 v[146:147], v13 offset:8704
    v_mfma_f32_16x16x32_bf16 v[64:67], v[20:23], v[96:99], v[64:67]
    ds_read_b64_tr_b16 v[152:153], v13 offset:16384
    ds_read_b64_tr_b16 v[154:155], v13 offset:16896
    v_mfma_f32_16x16x32_bf16 v[36:39], v[96:99], v[88:91], v[36:39]
    ds_read_b128 v[124:127], v12 offset:0
    ds_read_b128 v[132:135], v12 offset:2048
    v_mfma_f32_16x16x32_bf16 v[44:47], v[104:107], v[88:91], v[44:47]
    ds_read_b64_tr_b16 v[140:141], v13 offset:4096
    ds_read_b64_tr_b16 v[142:143], v13 offset:4608
    v_mfma_f32_16x16x32_bf16 v[68:71], v[20:23], v[104:107], v[68:71]
    ds_read_b64_tr_b16 v[148:149], v13 offset:12288
    ds_read_b64_tr_b16 v[150:151], v13 offset:12800
    v_mfma_f32_16x16x32_bf16 v[52:55], v[88:91], v[112:115], v[52:55]
    ds_read_b64_tr_b16 v[156:157], v13 offset:20480
    ds_read_b64_tr_b16 v[158:159], v13 offset:20992
    v_mfma_f32_16x16x32_bf16 v[32:35], v[100:103], v[84:87], v[32:35]
    s_add_u32 s50, s49, 4
    s_and_b32 s50, s50, 7
    s_lshl_b32 s51, s50, 7
    s_add_u32 s51, s51, s45
    s_add_u32 m0, s47, 0
    s_mul_i32 s50, s50, 196608
    buffer_load_dwordx4 v18, s[28:31], s51 offen lds
    v_mfma_f32_16x16x32_bf16 v[40:43], v[108:111], v[84:87], v[40:43]
    s_add_u32 s50, s50, s46
    s_add_u32 m0, s47, 8192
    s_add_u32 s44, s50, 0
    buffer_load_dwordx4 v19, s[32:35], s44 offen lds
    v_mfma_f32_16x16x32_bf16 v[72:75], v[20:23], v[112:115], v[72:75]
    s_add_u32 m0, s47, 16384
    s_add_u32 s44, s50, 1024
    buffer_load_dwordx4 v19, s[32:35], s44 offen lds
    v_mfma_f32_16x16x32_bf16 v[48:51], v[84:87], v[116:119], v[48:51]
    s_add_u32 m0, s47, 24576
    s_add_u32 s44, s50, 2048
    buffer_load_dwordx4 v19, s[32:35], s44 offen lds
    s_waitcnt vmcnt(8) lgkmcnt(0)
    v_mfma_f32_16x16x32_bf16 v[36:39], v[100:103], v[92:95], v[36:39]
    v_mfma_f32_16x16x32_bf16 v[56:59], v[80:83], v[80:83], v[56:59]
    v_mfma_f32_16x16x32_bf16 v[44:47], v[108:111], v[92:95], v[44:47]
    v_mfma_f32_16x16x32_bf16 v[52:55], v[92:95], v[116:119], v[52:55]
    v_mfma_f32_16x16x32_bf16 v[60:63], v[80:83], v[20:23], v[60:63]
    s_barrier
    v_add_u32 v11, 65536, v8
    v_add_u32 v12, 65536, v9
    v_add_u32 v13, 65536, v10
    v_mfma_f32_16x16x32_bf16 v[32:35], v[136:139], v[120:123], v[32:35]
    ds_read_b128 v[80:83], v11 offset:0
    ds_read_b128 v[88:91], v11 offset:2048
    v_mfma_f32_16x16x32_bf16 v[40:43], v[144:147], v[120:123], v[40:43]
    ds_read_b64_tr_b16 v[96:97], v13 offset:0
    ds_read_b64_tr_b16 v[98:99], v13 offset:512
    v_mfma_f32_16x16x32_bf16 v[48:51], v[120:123], v[152:155], v[48:51]
    ds_read_b64_tr_b16 v[104:105], v13 offset:8192
    ds_read_b64_tr_b16 v[106:107], v13 offset:8704
    v_mfma_f32_16x16x32_bf16 v[64:67], v[20:23], v[136:139], v[64:67]
    ds_read_b64_tr_b16 v[112:113], v13 offset:16384
    ds_read_b64_tr_b16 v[114:115], v13 offset:16896
    v_mfma_f32_16x16x32_bf16 v[36:39], v[136:139], v[128:131], v[36:39]
    ds_read_b128 v[84:87], v12 offset:0
    ds_read_b128 v[92:95], v12 offset:2048
    v_mfma_f32_16x16x32_bf16 v[44:47], v[144:147], v[128:131], v[44:47]
    ds_read_b64_tr_b16 v[100:101], v13 offset:4096
    ds_read_b64_tr_b16 v[102:103], v13 offset:4608
    v_mfma_f32_16x16x32_bf16 v[68:71], v[20:23], v[144:147], v[68:71]
    ds_read_b64_tr_b16 v[108:109], v13 offset:12288
    ds_read_b64_tr_b16 v[110:111], v13 offset:12800
    v_mfma_f32_16x16x32_bf16 v[52:55], v[128:131], v[152:155], v[52:55]
    ds_read_b64_tr_b16 v[116:117], v13 offset:20480
    ds_read_b64_tr_b16 v[118:119], v13 offset:20992
    v_mfma_f32_16x16x32_bf16 v[32:35], v[140:143], v[124:127], v[32:35]
    s_add_u32 s50, s49, 5
    s_and_b32 s50, s50, 7
    s_lshl_b32 s51, s50, 7
    s_add_u32 s51, s51, s45
    s_add_u32 m0, s47, 32768
    s_mul_i32 s50, s50, 196608
    buffer_load_dwordx4 v18, s[28:31], s51 offen lds
    v_mfma_f32_16x16x32_bf16 v[40:43], v[148:151], v[124:127], v[40:43]
    s_add_u32 s50, s50, s46
    s_add_u32 m0, s47, 40960
    s_add_u32 s44, s50, 0
    buffer_load_dwordx4 v19, s[32:35], s44 offen lds
    v_mfma_f32_16x16x32_bf16 v[72:75], v[20:23], v[152:155], v[72:75]
    s_add_u32 m0, s47, 49152
    s_add_u32 s44, s50, 1024
    buffer_load_dwordx4 v19, s[32:35], s44 offen lds
    v_mfma_f32_16x16x32_bf16 v[48:51], v[124:127], v[156:159], v[48:51]
    s_add_u32 m0, s47, 57344
    s_add_u32 s44, s50, 2048
    buffer_load_dwordx4 v19, s[32:35], s44 offen lds
    s_waitcnt vmcnt(8) lgkmcnt(0)
    v_mfma_f32_16x16x32_bf16 v[36:39], v[140:143], v[132:135], v[36:39]
    v_mfma_f32_16x16x32_bf16 v[56:59], v[120:123], v[120:123], v[56:59]
    v_mfma_f32_16x16x32_bf16 v[44:47], v[148:151], v[132:135], v[44:47]
    v_mfma_f32_16x16x32_bf16 v[52:55], v[132:135], v[156:159], v[52:55]
    v_mfma_f32_16x16x32_bf16 v[60:63], v[120:123], v[20:23], v[60:63]
    s_barrier
    v_add_u32 v11, 98304, v8
    v_add_u32 v12, 98304, v9
    v_add_u32 v13, 98304, v10
    v_mfma_f32_16x16x32_bf16 v[32:35], v[96:99], v[80:83], v[32:35]
    ds_read_b128 v[120:123], v11 offset:0
    ds_read_b128 v[128:131], v11 offset:2048
    v_mfma_f32_16x16x32_bf16 v[40:43], v[104:107], v[80:83], v[40:43]
    ds_read_b64_tr_b16 v[136:137], v13 offset:0
    ds_read_b64_tr_b16 v[138:139], v13 offset:512
    v_mfma_f32_16x16x32_bf16 v[48:51], v[80:83], v[112:115], v[48:51]
    ds_read_b64_tr_b16 v[144:145], v13 offset:8192
    ds_read_b64_tr_b16 v[146:147], v13 offset:8704
    v_mfma_f32_16x16x32_bf16 v[64:67], v[20:23], v[96:99], v[64:67]
    ds_read_b64_tr_b16 v[152:153], v13 offset:16384
    ds_read_b64_tr_b16 v[154:155], v13 offset:16896
    v_mfma_f32_16x16x32_bf16 v[36:39], v[96:99], v[88:91], v[36:39]
    ds_read_b128 v[124:127], v12 offset:0
    ds_read_b128 v[132:135], v12 offset:2048
    v_mfma_f32_16x16x32_bf16 v[44:47], v[104:107], v[88:91], v[44:47]
    ds_read_b64_tr_b16 v[140:141], v13 offset:4096
    ds_read_b64_tr_b16 v[142:143], v13 offset:4608
    v_mfma_f32_16x16x32_bf16 v[68:71], v[20:23], v[104:107], v[68:71]
    ds_read_b64_tr_b16 v[148:149], v13 offset:12288
    ds_read_b64_tr_b16 v[150:151], v13 offset:12800
    v_mfma_f32_16x16x32_bf16 v[52:55], v[88:91], v[112:115], v[52:55]
    ds_read_b64_tr_b16 v[156:157], v13 offset:20480
    ds_read_b64_tr_b16 v[158:159], v13 offset:20992
    v_mfma_f32_16x16x32_bf16 v[32:35], v[100:103], v[84:87], v[32:35]
    s_add_u32 s50, s49, 6
    s_and_b32 s50, s50, 7
    s_lshl_b32 s51, s50, 7
    s_add_u32 s51, s51, s45
    s_add_u32 m0, s47, 65536
    s_mul_i32 s50, s50, 196608
    buffer_load_dwordx4 v18, s[28:31], s51 offen lds
    v_mfma_f32_16x16x32_bf16 v[40:43], v[108:111], v[84:87], v[40:43]
    s_add_u32 s50, s50, s46
    s_add_u32 m0, s47, 73728
    s_add_u32 s44, s50, 0
    buffer_load_dwordx4 v19, s[32:35], s44 offen lds
    v_mfma_f32_16x16x32_bf16 v[72:75], v[20:23], v[112:115], v[72:75]
    s_add_u32 m0, s47, 81920
    s_add_u32 s44, s50, 1024
    buffer_load_dwordx4 v19, s[32:35], s44 offen lds
    v_mfma_f32_16x16x32_bf16 v[48:51], v[84:87], v[116:119], v[48:51]
    s_add_u32 m0, s47, 90112
    s_add_u32 s44, s50, 2048
    buffer_load_dwordx4 v19, s[32:35], s44 offen lds
    s_waitcnt vmcnt(8) lgkmcnt(0)
    v_mfma_f32_16x16x32_bf16 v[36:39], v[100:103], v[92:95], v[36:39]
    v_mfma_f32_16x16x32_bf16 v[56:59], v[80:83], v[80:83], v[56:59]
    v_mfma_f32_16x16x32_bf16 v[44:47], v[108:111], v[92:95], v[44:47]
    v_mfma_f32_16x16x32_bf16 v[52:55], v[92:95], v[116:119], v[52:55]
    v_mfma_f32_16x16x32_bf16 v[60:63], v[80:83], v[20:23], v[60:63]
    s_barrier
    v_add_u32 v11, 0, v8
    v_add_u32 v12, 0, v9
    v_add_u32 v13, 0, v10
    v_mfma_f32_16x16x32_bf16 v[32:35], v[136:139], v[120:123], v[32:35]
    ds_read_b128 v[80:83], v11 offset:0
    ds_read_b128 v[88:91], v11 offset:2048
    v_mfma_f32_16x16x32_bf16 v[40:43], v[144:147], v[120:123], v[40:43]
    ds_read_b64_tr_b16 v[96:97], v13 offset:0
    ds_read_b64_tr_b16 v[98:99], v13 offset:512
    v_mfma_f32_16x16x32_bf16 v[48:51], v[120:123], v[152:155], v[48:51]
    ds_read_b64_tr_b16 v[104:105], v13 offset:8192
    ds_read_b64_tr_b16 v[106:107], v13 offset:8704
    v_mfma_f32_16x16x32_bf16 v[64:67], v[20:23], v[136:139], v[64:67]
    ds_read_b64_tr_b16 v[112:113], v13 offset:16384
    ds_read_b64_tr_b16 v[114:115], v13 offset:16896
    v_mfma_f32_16x16x32_bf16 v[36:39], v[136:139], v[128:131], v[36:39]
    ds_read_b128 v[84:87], v12 offset:0
    ds_read_b128 v[92:95], v12 offset:2048
    v_mfma_f32_16x16x32_bf16 v[44:47], v[144:147], v[128:131], v[44:47]
    ds_read_b64_tr_b16 v[100:101], v13 offset:4096
    ds_read_b64_tr_b16 v[102:103], v13 offset:4608
    v_mfma_f32_16x16x32_bf16 v[68:71], v[20:23], v[144:147], v[68:71]
    ds_read_b64_tr_b16 v[108:109], v13 offset:12288
    ds_read_b64_tr_b16 v[110:111], v13 offset:12800
    v_mfma_f32_16x16x32_bf16 v[52:55], v[128:131], v[152:155], v[52:55]
    ds_read_b64_tr_b16 v[116:117], v13 offset:20480
    ds_read_b64_tr_b16 v[118:119], v13 offset:20992
    v_mfma_f32_16x16x32_bf16 v[32:35], v[140:143], v[124:127], v[32:35]
    s_add_u32 s50, s49, 7
    s_and_b32 s50, s50, 7
    s_lshl_b32 s51, s50, 7
    s_add_u32 s51, s51, s45
    s_add_u32 m0, s47, 98304
    s_mul_i32 s50, s50, 196608
    buffer_load_dwordx4 v18, s[28:31], s51 offen lds
    v_mfma_f32_16x16x32_bf16 v[40:43], v[148:151], v[124:127], v[40:43]
    s_add_u32 s50, s50, s46
    s_add_u32 m0, s47, 106496
    s_add_u32 s44, s50, 0
    buffer_load_dwordx4 v19, s[32:35], s44 offen lds
    v_mfma_f32_16x16x32_bf16 v[72:75], v[20:23], v[152:155], v[72:75]
    s_add_u32 m0, s47, 114688
    s_add_u32 s44, s50, 1024
    buffer_load_dwordx4 v19, s[32:35], s44 offen lds
    v_mfma_f32_16x16x32_bf16 v[48:51], v[124:127], v[156:159], v[48:51]
    s_add_u32 m0, s47, 122880
    s_add_u32 s44, s50, 2048
    buffer_load_dwordx4 v19, s[32:35], s44 offen lds
    s_waitcnt vmcnt(8) lgkmcnt(0)
    v_mfma_f32_16x16x32_bf16 v[36:39], v[140:143], v[132:135], v[36:39]
    v_mfma_f32_16x16x32_bf16 v[56:59], v[120:123], v[120:123], v[56:59]
    v_mfma_f32_16x16x32_bf16 v[44:47], v[148:151], v[132:135], v[44:47]
    v_mfma_f32_16x16x32_bf16 v[52:55], v[132:135], v[156:159], v[52:55]
    v_mfma_f32_16x16x32_bf16 v[60:63], v[120:123], v[20:23], v[60:63]
    s_barrier
    s_and_b32 s53, s27, 1
    s_lshl_b32 s53, s53, 2
    s_and_b32 s54, s3, 3
    s_add_u32 s53, s53, s54
    s_lshr_b32 s54, s27, 1
    s_lshl_b32 s54, s54, 3
    s_lshr_b32 s55, s3, 2
    s_add_u32 s54, s54, s55
    s_lshl_b32 s53, s53, 18
    s_lshl_b32 s54, s54, 13
    s_add_u32 s53, s53, s54
    s_lshl_b32 s54, s26, 10
    s_add_u32 s53, s53, s54
    s_add_u32 s53, s53, 10747904
    v_lshlrev_b32 v28, 4, v1
    v_mov_b32 v24, -1
    v_mov_b32 v25, -1
    v_mov_b32 v26, -1
    v_mov_b32 v27, -1
    buffer_store_dwordx4 v[24:27], v28, s[36:39], s53 offen sc1
    v_add_u32 v11, 32768, v8
    v_add_u32 v12, 32768, v9
    v_add_u32 v13, 32768, v10
    v_mfma_f32_16x16x32_bf16 v[32:35], v[96:99], v[80:83], v[32:35]
    ds_read_b128 v[120:123], v11 offset:0
    ds_read_b128 v[128:131], v11 offset:2048
    v_mfma_f32_16x16x32_bf16 v[40:43], v[104:107], v[80:83], v[40:43]
    ds_read_b64_tr_b16 v[136:137], v13 offset:0
    ds_read_b64_tr_b16 v[138:139], v13 offset:512
    v_mfma_f32_16x16x32_bf16 v[48:51], v[80:83], v[112:115], v[48:51]
    ds_read_b64_tr_b16 v[144:145], v13 offset:8192
    ds_read_b64_tr_b16 v[146:147], v13 offset:8704
    v_mfma_f32_16x16x32_bf16 v[64:67], v[20:23], v[96:99], v[64:67]
    ds_read_b64_tr_b16 v[152:153], v13 offset:16384
    ds_read_b64_tr_b16 v[154:155], v13 offset:16896
    v_mfma_f32_16x16x32_bf16 v[36:39], v[96:99], v[88:91], v[36:39]
    ds_read_b128 v[124:127], v12 offset:0
    ds_read_b128 v[132:135], v12 offset:2048
    v_mfma_f32_16x16x32_bf16 v[44:47], v[104:107], v[88:91], v[44:47]
    ds_read_b64_tr_b16 v[140:141], v13 offset:4096
    ds_read_b64_tr_b16 v[142:143], v13 offset:4608
    v_mfma_f32_16x16x32_bf16 v[68:71], v[20:23], v[104:107], v[68:71]
    ds_read_b64_tr_b16 v[148:149], v13 offset:12288
    ds_read_b64_tr_b16 v[150:151], v13 offset:12800
    v_mfma_f32_16x16x32_bf16 v[52:55], v[88:91], v[112:115], v[52:55]
    ds_read_b64_tr_b16 v[156:157], v13 offset:20480
    ds_read_b64_tr_b16 v[158:159], v13 offset:20992
    v_mfma_f32_16x16x32_bf16 v[32:35], v[100:103], v[84:87], v[32:35]
    v_mfma_f32_16x16x32_bf16 v[40:43], v[108:111], v[84:87], v[40:43]
    v_mfma_f32_16x16x32_bf16 v[72:75], v[20:23], v[112:115], v[72:75]
    v_mfma_f32_16x16x32_bf16 v[48:51], v[84:87], v[116:119], v[48:51]
    s_waitcnt vmcnt(5) lgkmcnt(0)
    v_mfma_f32_16x16x32_bf16 v[36:39], v[100:103], v[92:95], v[36:39]
    v_mfma_f32_16x16x32_bf16 v[56:59], v[80:83], v[80:83], v[56:59]
    v_mfma_f32_16x16x32_bf16 v[44:47], v[108:111], v[92:95], v[44:47]
    v_mfma_f32_16x16x32_bf16 v[52:55], v[92:95], v[116:119], v[52:55]
    v_mfma_f32_16x16x32_bf16 v[60:63], v[80:83], v[20:23], v[60:63]
    s_barrier
    v_add_u32 v11, 65536, v8
    v_add_u32 v12, 65536, v9
    v_add_u32 v13, 65536, v10
    v_mfma_f32_16x16x32_bf16 v[32:35], v[136:139], v[120:123], v[32:35]
    ds_read_b128 v[80:83], v11 offset:0
    ds_read_b128 v[88:91], v11 offset:2048
    v_mfma_f32_16x16x32_bf16 v[40:43], v[144:147], v[120:123], v[40:43]
    ds_read_b64_tr_b16 v[96:97], v13 offset:0
    ds_read_b64_tr_b16 v[98:99], v13 offset:512
    v_mfma_f32_16x16x32_bf16 v[48:51], v[120:123], v[152:155], v[48:51]
    ds_read_b64_tr_b16 v[104:105], v13 offset:8192
    ds_read_b64_tr_b16 v[106:107], v13 offset:8704
    v_mfma_f32_16x16x32_bf16 v[64:67], v[20:23], v[136:139], v[64:67]
    ds_read_b64_tr_b16 v[112:113], v13 offset:16384
    ds_read_b64_tr_b16 v[114:115], v13 offset:16896
    v_mfma_f32_16x16x32_bf16 v[36:39], v[136:139], v[128:131], v[36:39]
    ds_read_b128 v[84:87], v12 offset:0
    ds_read_b128 v[92:95], v12 offset:2048
    v_mfma_f32_16x16x32_bf16 v[44:47], v[144:147], v[128:131], v[44:47]
    ds_read_b64_tr_b16 v[100:101], v13 offset:4096
    ds_read_b64_tr_b16 v[102:103], v13 offset:4608
    v_mfma_f32_16x16x32_bf16 v[68:71], v[20:23], v[144:147], v[68:71]
    ds_read_b64_tr_b16 v[108:109], v13 offset:12288
    ds_read_b64_tr_b16 v[110:111], v13 offset:12800
    v_mfma_f32_16x16x32_bf16 v[52:55], v[128:131], v[152:155], v[52:55]
    ds_read_b64_tr_b16 v[116:117], v13 offset:20480
    ds_read_b64_tr_b16 v[118:119], v13 offset:20992
    v_mfma_f32_16x16x32_bf16 v[32:35], v[140:143], v[124:127], v[32:35]
    v_mfma_f32_16x16x32_bf16 v[40:43], v[148:151], v[124:127], v[40:43]
    v_mfma_f32_16x16x32_bf16 v[72:75], v[20:23], v[152:155], v[72:75]
    v_mfma_f32_16x16x32_bf16 v[48:51], v[124:127], v[156:159], v[48:51]
    s_waitcnt vmcnt(1) lgkmcnt(0)
    v_mfma_f32_16x16x32_bf16 v[36:39], v[140:143], v[132:135], v[36:39]
    v_mfma_f32_16x16x32_bf16 v[56:59], v[120:123], v[120:123], v[56:59]
    v_mfma_f32_16x16x32_bf16 v[44:47], v[148:151], v[132:135], v[44:47]
    v_mfma_f32_16x16x32_bf16 v[52:55], v[132:135], v[156:159], v[52:55]
    v_mfma_f32_16x16x32_bf16 v[60:63], v[120:123], v[20:23], v[60:63]
    s_barrier
    v_add_u32 v11, 98304, v8
    v_add_u32 v12, 98304, v9
    v_add_u32 v13, 98304, v10
    v_mfma_f32_16x16x32_bf16 v[32:35], v[96:99], v[80:83], v[32:35]
    ds_read_b128 v[120:123], v11 offset:0
    v_mfma_f32_16x16x32_bf16 v[40:43], v[104:107], v[80:83], v[40:43]
    ds_read_b128 v[128:131], v11 offset:2048
    v_mfma_f32_16x16x32_bf16 v[48:51], v[80:83], v[112:115], v[48:51]
    ds_read_b64_tr_b16 v[136:137], v13 offset:0
    ds_read_b64_tr_b16 v[138:139], v13 offset:512
    v_mfma_f32_16x16x32_bf16 v[64:67], v[20:23], v[96:99], v[64:67]
    ds_read_b64_tr_b16 v[144:145], v13 offset:8192
    v_mfma_f32_16x16x32_bf16 v[36:39], v[96:99], v[88:91], v[36:39]
    ds_read_b64_tr_b16 v[146:147], v13 offset:8704
    ds_read_b64_tr_b16 v[152:153], v13 offset:16384
    v_mfma_f32_16x16x32_bf16 v[44:47], v[104:107], v[88:91], v[44:47]
    ds_read_b64_tr_b16 v[154:155], v13 offset:16896
    v_mfma_f32_16x16x32_bf16 v[68:71], v[20:23], v[104:107], v[68:71]
    ds_read_b128 v[124:127], v12 offset:0
    ds_read_b128 v[132:135], v12 offset:2048
    v_mfma_f32_16x16x32_bf16 v[52:55], v[88:91], v[112:115], v[52:55]
    ds_read_b64_tr_b16 v[140:141], v13 offset:4096
    v_mfma_f32_16x16x32_bf16 v[32:35], v[100:103], v[84:87], v[32:35]
    ds_read_b64_tr_b16 v[142:143], v13 offset:4608
    ds_read_b64_tr_b16 v[148:149], v13 offset:12288
    v_mfma_f32_16x16x32_bf16 v[40:43], v[108:111], v[84:87], v[40:43]
    ds_read_b64_tr_b16 v[150:151], v13 offset:12800
    v_mfma_f32_16x16x32_bf16 v[72:75], v[20:23], v[112:115], v[72:75]
    ds_read_b64_tr_b16 v[156:157], v13 offset:20480
    ds_read_b64_tr_b16 v[158:159], v13 offset:20992
    v_mfma_f32_16x16x32_bf16 v[48:51], v[84:87], v[116:119], v[48:51]
    v_mfma_f32_16x16x32_bf16 v[36:39], v[100:103], v[92:95], v[36:39]
    v_mfma_f32_16x16x32_bf16 v[56:59], v[80:83], v[80:83], v[56:59]
    v_mfma_f32_16x16x32_bf16 v[44:47], v[108:111], v[92:95], v[44:47]
    v_mfma_f32_16x16x32_bf16 v[52:55], v[92:95], v[116:119], v[52:55]
    v_mfma_f32_16x16x32_bf16 v[60:63], v[80:83], v[20:23], v[60:63]
    s_waitcnt lgkmcnt(0)
    v_mfma_f32_16x16x32_bf16 v[32:35], v[136:139], v[120:123], v[32:35]
    v_mfma_f32_16x16x32_bf16 v[40:43], v[144:147], v[120:123], v[40:43]
    v_mfma_f32_16x16x32_bf16 v[48:51], v[120:123], v[152:155], v[48:51]
    v_mfma_f32_16x16x32_bf16 v[64:67], v[20:23], v[136:139], v[64:67]
    v_mfma_f32_16x16x32_bf16 v[36:39], v[136:139], v[128:131], v[36:39]
    v_mfma_f32_16x16x32_bf16 v[44:47], v[144:147], v[128:131], v[44:47]
    v_mfma_f32_16x16x32_bf16 v[68:71], v[20:23], v[144:147], v[68:71]
    v_mfma_f32_16x16x32_bf16 v[52:55], v[128:131], v[152:155], v[52:55]
    v_mfma_f32_16x16x32_bf16 v[32:35], v[140:143], v[124:127], v[32:35]
    v_mfma_f32_16x16x32_bf16 v[40:43], v[148:151], v[124:127], v[40:43]
    v_mfma_f32_16x16x32_bf16 v[72:75], v[20:23], v[152:155], v[72:75]
    v_mfma_f32_16x16x32_bf16 v[48:51], v[124:127], v[156:159], v[48:51]
    v_mfma_f32_16x16x32_bf16 v[36:39], v[140:143], v[132:135], v[36:39]
    v_mfma_f32_16x16x32_bf16 v[56:59], v[120:123], v[120:123], v[56:59]
    v_mfma_f32_16x16x32_bf16 v[44:47], v[148:151], v[132:135], v[44:47]
    v_mfma_f32_16x16x32_bf16 v[52:55], v[132:135], v[156:159], v[52:55]
    v_mfma_f32_16x16x32_bf16 v[60:63], v[120:123], v[20:23], v[60:63]
    s_branch L_k1_cj
L_k1_c1:
    s_waitcnt vmcnt(4) lgkmcnt(0)
    s_barrier
    v_add_u32 v11, 0, v8
    v_add_u32 v12, 0, v9
    v_add_u32 v13, 0, v10
    ds_read_b128 v[80:83], v11 offset:0
    ds_read_b128 v[88:91], v11 offset:2048
    ds_read_b64_tr_b16 v[96:97], v13 offset:0
    ds_read_b64_tr_b16 v[98:99], v13 offset:512
    ds_read_b64_tr_b16 v[104:105], v13 offset:8192
    ds_read_b64_tr_b16 v[106:107], v13 offset:8704
    ds_read_b64_tr_b16 v[112:113], v13 offset:16384
    ds_read_b64_tr_b16 v[114:115], v13 offset:16896
    ds_read_b128 v[84:87], v12 offset:0
    ds_read_b128 v[92:95], v12 offset:2048
    ds_read_b64_tr_b16 v[100:101], v13 offset:4096
    ds_read_b64_tr_b16 v[102:103], v13 offset:4608
    ds_read_b64_tr_b16 v[108:109], v13 offset:12288
    ds_read_b64_tr_b16 v[110:111], v13 offset:12800
    ds_read_b64_tr_b16 v[116:117], v13 offset:20480
    ds_read_b64_tr_b16 v[118:119], v13 offset:20992
    s_add_u32 s50, s49, 2
    s_and_b32 s50, s50, 7
    s_lshl_b32 s51, s50, 7
    s_add_u32 s51, s51, s45
    s_add_u32 m0, s47, 65536
    s_mul_i32 s50, s50, 196608
    buffer_load_dwordx4 v18, s[28:31], s51 offen lds
    s_add_u32 s50, s50, s46
    s_add_u32 m0, s47, 73728
    s_add_u32 s44, s50, 0
    buffer_load_dwordx4 v19, s[32:35], s44 offen lds
    s_add_u32 m0, s47, 81920
    s_add_u32 s44, s50, 1024
    buffer_load_dwordx4 v19, s[32:35], s44 offen lds
    s_add_u32 m0, s47, 90112
    s_add_u32 s44, s50, 2048
    buffer_load_dwordx4 v19, s[32:35], s44 offen lds
    s_add_u32 s50, s49, 3
    s_and_b32 s50, s50, 7
    s_lshl_b32 s51, s50, 7
    s_add_u32 s51, s51, s45
    s_add_u32 m0, s47, 98304
    s_mul_i32 s50, s50, 196608
    buffer_load_dwordx4 v18, s[28:31], s51 offen lds
    s_add_u32 s50, s50, s46
    s_add_u32 m0, s47, 106496
    s_add_u32 s44, s50, 0
    buffer_load_dwordx4 v19, s[32:35], s44 offen lds
    s_add_u32 m0, s47, 114688
    s_add_u32 s44, s50, 1024
    buffer_load_dwordx4 v19, s[32:35], s44 offen lds
    s_add_u32 m0, s47, 122880
    s_add_u32 s44, s50, 2048
    buffer_load_dwordx4 v19, s[32:35], s44 offen lds
    s_waitcnt vmcnt(8) lgkmcnt(0)
    s_barrier
    v_add_u32 v11, 32768, v8
    v_add_u32 v12, 32768, v9
    v_add_u32 v13, 32768, v10
    v_mfma_f32_16x16x32_bf16 v[32:35], v[96:99], v[80:83], v[32:35]
    ds_read_b128 v[120:123], v11 offset:0
    ds_read_b128 v[128:131], v11 offset:2048
    v_mfma_f32_16x16x32_bf16 v[40:43], v[104:107], v[80:83], v[40:43]
    ds_read_b64_tr_b16 v[136:137], v13 offset:0
    ds_read_b64_tr_b16 v[138:139], v13 offset:512
    v_mfma_f32_16x16x32_bf16 v[48:51], v[80:83], v[112:115], v[48:51]
    ds_read_b64_tr_b16 v[144:145], v13 offset:8192
    ds_read_b64_tr_b16 v[146:147], v13 offset:8704
    v_mfma_f32_16x16x32_bf16 v[64:67], v[20:23], v[96:99], v[64:67]
    ds_read_b64_tr_b16 v[152:153], v13 offset:16384
    ds_read_b64_tr_b16 v[154:155], v13 offset:16896
    v_mfma_f32_16x16x32_bf16 v[36:39], v[96:99], v[88:91], v[36:39]
    ds_read_b128 v[124:127], v12 offset:0
    ds_read_b128 v[132:135], v12 offset:2048
    v_mfma_f32_16x16x32_bf16 v[44:47], v[104:107], v[88:91], v[44:47]
    ds_read_b64_tr_b16 v[140:141], v13 offset:4096
    ds_read_b64_tr_b16 v[142:143], v13 offset:4608
    v_mfma_f32_16x16x32_bf16 v[68:71], v[20:23], v[104:107], v[68:71]
    ds_read_b64_tr_b16 v[148:149], v13 offset:12288
    ds_read_b64_tr_b16 v[150:151], v13 offset:12800
    v_mfma_f32_16x16x32_bf16 v[52:55], v[88:91], v[112:115], v[52:55]
    ds_read_b64_tr_b16 v[156:157], v13 offset:20480
    ds_read_b64_tr_b16 v[158:159], v13 offset:20992
    v_mfma_f32_16x16x32_bf16 v[32:35], v[100:103], v[84:87], v[32:35]
    s_add_u32 s50, s49, 4
    s_and_b32 s50, s50, 7
    s_lshl_b32 s51, s50, 7
    s_add_u32 s51, s51, s45
    s_add_u32 m0, s47, 0
    s_mul_i32 s50, s50, 196608
    buffer_load_dwordx4 v18, s[28:31], s51 offen lds
    v_mfma_f32_16x16x32_bf16 v[40:43], v[108:111], v[84:87], v[40:43]
    s_add_u32 s50, s50, s46
    s_add_u32 m0, s47, 8192
    s_add_u32 s44, s50, 0
    buffer_load_dwordx4 v19, s[32:35], s44 offen lds
    v_mfma_f32_16x16x32_bf16 v[72:75], v[20:23], v[112:115], v[72:75]
    s_add_u32 m0, s47, 16384
    s_add_u32 s44, s50, 1024
    buffer_load_dwordx4 v19, s[32:35], s44 offen lds
    v_mfma_f32_16x16x32_bf16 v[48:51], v[84:87], v[116:119], v[48:51]
    s_add_u32 m0, s47, 24576
    s_add_u32 s44, s50, 2048
    buffer_load_dwordx4 v19, s[32:35], s44 offen lds
    s_waitcnt vmcnt(8) lgkmcnt(0)
    v_mfma_f32_16x16x32_bf16 v[36:39], v[100:103], v[92:95], v[36:39]
    v_mfma_f32_16x16x32_bf16 v[56:59], v[84:87], v[84:87], v[56:59]
    v_mfma_f32_16x16x32_bf16 v[44:47], v[108:111], v[92:95], v[44:47]
    v_mfma_f32_16x16x32_bf16 v[52:55], v[92:95], v[116:119], v[52:55]
    v_mfma_f32_16x16x32_bf16 v[60:63], v[84:87], v[20:23], v[60:63]
    s_barrier
    v_add_u32 v11, 65536, v8
    v_add_u32 v12, 65536, v9
    v_add_u32 v13, 65536, v10
    v_mfma_f32_16x16x32_bf16 v[32:35], v[136:139], v[120:123], v[32:35]
    ds_read_b128 v[80:83], v11 offset:0
    ds_read_b128 v[88:91], v11 offset:2048
    v_mfma_f32_16x16x32_bf16 v[40:43], v[144:147], v[120:123], v[40:43]
    ds_read_b64_tr_b16 v[96:97], v13 offset:0
    ds_read_b64_tr_b16 v[98:99], v13 offset:512
    v_mfma_f32_16x16x32_bf16 v[48:51], v[120:123], v[152:155], v[48:51]
    ds_read_b64_tr_b16 v[104:105], v13 offset:8192
    ds_read_b64_tr_b16 v[106:107], v13 offset:8704
    v_mfma_f32_16x16x32_bf16 v[64:67], v[20:23], v[136:139], v[64:67]
    ds_read_b64_tr_b16 v[112:113], v13 offset:16384
    ds_read_b64_tr_b16 v[114:115], v13 offset:16896
    v_mfma_f32_16x16x32_bf16 v[36:39], v[136:139], v[128:131], v[36:39]
    ds_read_b128 v[84:87], v12 offset:0
    ds_read_b128 v[92:95], v12 offset:2048
    v_mfma_f32_16x16x32_bf16 v[44:47], v[144:147], v[128:131], v[44:47]
    ds_read_b64_tr_b16 v[100:101], v13 offset:4096
    ds_read_b64_tr_b16 v[102:103], v13 offset:4608
    v_mfma_f32_16x16x32_bf16 v[68:71], v[20:23], v[144:147], v[68:71]
    ds_read_b64_tr_b16 v[108:109], v13 offset:12288
    ds_read_b64_tr_b16 v[110:111], v13 offset:12800
    v_mfma_f32_16x16x32_bf16 v[52:55], v[128:131], v[152:155], v[52:55]
    ds_read_b64_tr_b16 v[116:117], v13 offset:20480
    ds_read_b64_tr_b16 v[118:119], v13 offset:20992
    v_mfma_f32_16x16x32_bf16 v[32:35], v[140:143], v[124:127], v[32:35]
    s_add_u32 s50, s49, 5
    s_and_b32 s50, s50, 7
    s_lshl_b32 s51, s50, 7
    s_add_u32 s51, s51, s45
    s_add_u32 m0, s47, 32768
    s_mul_i32 s50, s50, 196608
    buffer_load_dwordx4 v18, s[28:31], s51 offen lds
    v_mfma_f32_16x16x32_bf16 v[40:43], v[148:151], v[124:127], v[40:43]
    s_add_u32 s50, s50, s46
    s_add_u32 m0, s47, 40960
    s_add_u32 s44, s50, 0
    buffer_load_dwordx4 v19, s[32:35], s44 offen lds
    v_mfma_f32_16x16x32_bf16 v[72:75], v[20:23], v[152:155], v[72:75]
    s_add_u32 m0, s47, 49152
    s_add_u32 s44, s50, 1024
    buffer_load_dwordx4 v19, s[32:35], s44 offen lds
    v_mfma_f32_16x16x32_bf16 v[48:51], v[124:127], v[156:159], v[48:51]
    s_add_u32 m0, s47, 57344
    s_add_u32 s44, s50, 2048
    buffer_load_dwordx4 v19, s[32:35], s44 offen lds
    s_waitcnt vmcnt(8) lgkmcnt(0)
    v_mfma_f32_16x16x32_bf16 v[36:39], v[140:143], v[132:135], v[36:39]
    v_mfma_f32_16x16x32_bf16 v[56:59], v[124:127], v[124:127], v[56:59]
    v_mfma_f32_16x16x32_bf16 v[44:47], v[148:151], v[132:135], v[44:47]
    v_mfma_f32_16x16x32_bf16 v[52:55], v[132:135], v[156:159], v[52:55]
    v_mfma_f32_16x16x32_bf16 v[60:63], v[124:127], v[20:23], v[60:63]
    s_barrier
    v_add_u32 v11, 98304, v8
    v_add_u32 v12, 98304, v9
    v_add_u32 v13, 98304, v10
    v_mfma_f32_16x16x32_bf16 v[32:35], v[96:99], v[80:83], v[32:35]
    ds_read_b128 v[120:123], v11 offset:0
    ds_read_b128 v[128:131], v11 offset:2048
    v_mfma_f32_16x16x32_bf16 v[40:43], v[104:107], v[80:83], v[40:43]
    ds_read_b64_tr_b16 v[136:137], v13 offset:0
    ds_read_b64_tr_b16 v[138:139], v13 offset:512
    v_mfma_f32_16x16x32_bf16 v[48:51], v[80:83], v[112:115], v[48:51]
    ds_read_b64_tr_b16 v[144:145], v13 offset:8192
    ds_read_b64_tr_b16 v[146:147], v13 offset:8704
    v_mfma_f32_16x16x32_bf16 v[64:67], v[20:23], v[96:99], v[64:67]
    ds_read_b64_tr_b16 v[152:153], v13 offset:16384
    ds_read_b64_tr_b16 v[154:155], v13 offset:16896
    v_mfma_f32_16x16x32_bf16 v[36:39], v[96:99], v[88:91], v[36:39]
    ds_read_b128 v[124:127], v12 offset:0
    ds_read_b128 v[132:135], v12 offset:2048
    v_mfma_f32_16x16x32_bf16 v[44:47], v[104:107], v[88:91], v[44:47]
    ds_read_b64_tr_b16 v[140:141], v13 offset:4096
    ds_read_b64_tr_b16 v[142:143], v13 offset:4608
    v_mfma_f32_16x16x32_bf16 v[68:71], v[20:23], v[104:107], v[68:71]
    ds_read_b64_tr_b16 v[148:149], v13 offset:12288
    ds_read_b64_tr_b16 v[150:151], v13 offset:12800
    v_mfma_f32_16x16x32_bf16 v[52:55], v[88:91], v[112:115], v[52:55]
    ds_read_b64_tr_b16 v[156:157], v13 offset:20480
    ds_read_b64_tr_b16 v[158:159], v13 offset:20992
    v_mfma_f32_16x16x32_bf16 v[32:35], v[100:103], v[84:87], v[32:35]
    s_add_u32 s50, s49, 6
    s_and_b32 s50, s50, 7
    s_lshl_b32 s51, s50, 7
    s_add_u32 s51, s51, s45
    s_add_u32 m0, s47, 65536
    s_mul_i32 s50, s50, 196608
    buffer_load_dwordx4 v18, s[28:31], s51 offen lds
    v_mfma_f32_16x16x32_bf16 v[40:43], v[108:111], v[84:87], v[40:43]
    s_add_u32 s50, s50, s46
    s_add_u32 m0, s47, 73728
    s_add_u32 s44, s50, 0
    buffer_load_dwordx4 v19, s[32:35], s44 offen lds
    v_mfma_f32_16x16x32_bf16 v[72:75], v[20:23], v[112:115], v[72:75]
    s_add_u32 m0, s47, 81920
    s_add_u32 s44, s50, 1024
    buffer_load_dwordx4 v19, s[32:35], s44 offen lds
    v_mfma_f32_16x16x32_bf16 v[48:51], v[84:87], v[116:119], v[48:51]
    s_add_u32 m0, s47, 90112
    s_add_u32 s44, s50, 2048
    buffer_load_dwordx4 v19, s[32:35], s44 offen lds
    s_waitcnt vmcnt(8) lgkmcnt(0)
    v_mfma_f32_16x16x32_bf16 v[36:39], v[100:103], v[92:95], v[36:39]
    v_mfma_f32_16x16x32_bf16 v[56:59], v[84:87], v[84:87], v[56:59]
    v_mfma_f32_16x16x32_bf16 v[44:47], v[108:111], v[92:95], v[44:47]
    v_mfma_f32_16x16x32_bf16 v[52:55], v[92:95], v[116:119], v[52:55]
    v_mfma_f32_16x16x32_bf16 v[60:63], v[84:87], v[20:23], v[60:63]
    s_barrier
    v_add_u32 v11, 0, v8
    v_add_u32 v12, 0, v9
    v_add_u32 v13, 0, v10
    v_mfma_f32_16x16x32_bf16 v[32:35], v[136:139], v[120:123], v[32:35]
    ds_read_b128 v[80:83], v11 offset:0
    ds_read_b128 v[88:91], v11 offset:2048
    v_mfma_f32_16x16x32_bf16 v[40:43], v[144:147], v[120:123], v[40:43]
    ds_read_b64_tr_b16 v[96:97], v13 offset:0
    ds_read_b64_tr_b16 v[98:99], v13 offset:512
    v_mfma_f32_16x16x32_bf16 v[48:51], v[120:123], v[152:155], v[48:51]
    ds_read_b64_tr_b16 v[104:105], v13 offset:8192
    ds_read_b64_tr_b16 v[106:107], v13 offset:8704
    v_mfma_f32_16x16x32_bf16 v[64:67], v[20:23], v[136:139], v[64:67]
    ds_read_b64_tr_b16 v[112:113], v13 offset:16384
    ds_read_b64_tr_b16 v[114:115], v13 offset:16896
    v_mfma_f32_16x16x32_bf16 v[36:39], v[136:139], v[128:131], v[36:39]
    ds_read_b128 v[84:87], v12 offset:0
    ds_read_b128 v[92:95], v12 offset:2048
    v_mfma_f32_16x16x32_bf16 v[44:47], v[144:147], v[128:131], v[44:47]
    ds_read_b64_tr_b16 v[100:101], v13 offset:4096
    ds_read_b64_tr_b16 v[102:103], v13 offset:4608
    v_mfma_f32_16x16x32_bf16 v[68:71], v[20:23], v[144:147], v[68:71]
    ds_read_b64_tr_b16 v[108:109], v13 offset:12288
    ds_read_b64_tr_b16 v[110:111], v13 offset:12800
    v_mfma_f32_16x16x32_bf16 v[52:55], v[128:131], v[152:155], v[52:55]
    ds_read_b64_tr_b16 v[116:117], v13 offset:20480
    ds_read_b64_tr_b16 v[118:119], v13 offset:20992
    v_mfma_f32_16x16x32_bf16 v[32:35], v[140:143], v[124:127], v[32:35]
    s_add_u32 s50, s49, 7
    s_and_b32 s50, s50, 7
    s_lshl_b32 s51, s50, 7
    s_add_u32 s51, s51, s45
    s_add_u32 m0, s47, 98304
    s_mul_i32 s50, s50, 196608
    buffer_load_dwordx4 v18, s[28:31], s51 offen lds
    v_mfma_f32_16x16x32_bf16 v[40:43], v[148:151], v[124:127], v[40:43]
    s_add_u32 s50, s50, s46
    s_add_u32 m0, s47, 106496
    s_add_u32 s44, s50, 0
    buffer_load_dwordx4 v19, s[32:35], s44 offen lds
    v_mfma_f32_16x16x32_bf16 v[72:75], v[20:23], v[152:155], v[72:75]
    s_add_u32 m0, s47, 114688
    s_add_u32 s44, s50, 1024
    buffer_load_dwordx4 v19, s[32:35], s44 offen lds
    v_mfma_f32_16x16x32_bf16 v[48:51], v[124:127], v[156:159], v[48:51]
    s_add_u32 m0, s47, 122880
    s_add_u32 s44, s50, 2048
    buffer_load_dwordx4 v19, s[32:35], s44 offen lds
    s_waitcnt vmcnt(8) lgkmcnt(0)
    v_mfma_f32_16x16x32_bf16 v[36:39], v[140:143], v[132:135], v[36:39]
    v_mfma_f32_16x16x32_bf16 v[56:59], v[124:127], v[124:127], v[56:59]
    v_mfma_f32_16x16x32_bf16 v[44:47], v[148:151], v[132:135], v[44:47]
    v_mfma_f32_16x16x32_bf16 v[52:55], v[132:135], v[156:159], v[52:55]
    v_mfma_f32_16x16x32_bf16 v[60:63], v[124:127], v[20:23], v[60:63]
    s_barrier
    s_and_b32 s53, s27, 1
    s_lshl_b32 s53, s53, 2
    s_and_b32 s54, s3, 3
    s_add_u32 s53, s53, s54
    s_lshr_b32 s54, s27, 1
    s_lshl_b32 s54, s54, 3
    s_lshr_b32 s55, s3, 2
    s_add_u32 s54, s54, s55
    s_lshl_b32 s53, s53, 18
    s_lshl_b32 s54, s54, 13
    s_add_u32 s53, s53, s54
    s_lshl_b32 s54, s26, 10
    s_add_u32 s53, s53, s54
    s_add_u32 s53, s53, 10747904
    v_lshlrev_b32 v28, 4, v1
    v_mov_b32 v24, -1
    v_mov_b32 v25, -1
    v_mov_b32 v26, -1
    v_mov_b32 v27, -1
    buffer_store_dwordx4 v[24:27], v28, s[36:39], s53 offen sc1
    v_add_u32 v11, 32768, v8
    v_add_u32 v12, 32768, v9
    v_add_u32 v13, 32768, v10
    v_mfma_f32_16x16x32_bf16 v[32:35], v[96:99], v[80:83], v[32:35]
    ds_read_b128 v[120:123], v11 offset:0
    ds_read_b128 v[128:131], v11 offset:2048
    v_mfma_f32_16x16x32_bf16 v[40:43], v[104:107], v[80:83], v[40:43]
    ds_read_b64_tr_b16 v[136:137], v13 offset:0
    ds_read_b64_tr_b16 v[138:139], v13 offset:512
    v_mfma_f32_16x16x32_bf16 v[48:51], v[80:83], v[112:115], v[48:51]
    ds_read_b64_tr_b16 v[144:145], v13 offset:8192
    ds_read_b64_tr_b16 v[146:147], v13 offset:8704
    v_mfma_f32_16x16x32_bf16 v[64:67], v[20:23], v[96:99], v[64:67]
    ds_read_b64_tr_b16 v[152:153], v13 offset:16384
    ds_read_b64_tr_b16 v[154:155], v13 offset:16896
    v_mfma_f32_16x16x32_bf16 v[36:39], v[96:99], v[88:91], v[36:39]
    ds_read_b128 v[124:127], v12 offset:0
    ds_read_b128 v[132:135], v12 offset:2048
    v_mfma_f32_16x16x32_bf16 v[44:47], v[104:107], v[88:91], v[44:47]
    ds_read_b64_tr_b16 v[140:141], v13 offset:4096
    ds_read_b64_tr_b16 v[142:143], v13 offset:4608
    v_mfma_f32_16x16x32_bf16 v[68:71], v[20:23], v[104:107], v[68:71]
    ds_read_b64_tr_b16 v[148:149], v13 offset:12288
    ds_read_b64_tr_b16 v[150:151], v13 offset:12800
    v_mfma_f32_16x16x32_bf16 v[52:55], v[88:91], v[112:115], v[52:55]
    ds_read_b64_tr_b16 v[156:157], v13 offset:20480
    ds_read_b64_tr_b16 v[158:159], v13 offset:20992
    v_mfma_f32_16x16x32_bf16 v[32:35], v[100:103], v[84:87], v[32:35]
    v_mfma_f32_16x16x32_bf16 v[40:43], v[108:111], v[84:87], v[40:43]
    v_mfma_f32_16x16x32_bf16 v[72:75], v[20:23], v[112:115], v[72:75]
    v_mfma_f32_16x16x32_bf16 v[48:51], v[84:87], v[116:119], v[48:51]
    s_waitcnt vmcnt(5) lgkmcnt(0)
    v_mfma_f32_16x16x32_bf16 v[36:39], v[100:103], v[92:95], v[36:39]
    v_mfma_f32_16x16x32_bf16 v[56:59], v[84:87], v[84:87], v[56:59]
    v_mfma_f32_16x16x32_bf16 v[44:47], v[108:111], v[92:95], v[44:47]
    v_mfma_f32_16x16x32_bf16 v[52:55], v[92:95], v[116:119], v[52:55]
    v_mfma_f32_16x16x32_bf16 v[60:63], v[84:87], v[20:23], v[60:63]
    s_barrier
    v_add_u32 v11, 65536, v8
    v_add_u32 v12, 65536, v9
    v_add_u32 v13, 65536, v10
    v_mfma_f32_16x16x32_bf16 v[32:35], v[136:139], v[120:123], v[32:35]
    ds_read_b128 v[80:83], v11 offset:0
    ds_read_b128 v[88:91], v11 offset:2048
    v_mfma_f32_16x16x32_bf16 v[40:43], v[144:147], v[120:123], v[40:43]
    ds_read_b64_tr_b16 v[96:97], v13 offset:0
    ds_read_b64_tr_b16 v[98:99], v13 offset:512
    v_mfma_f32_16x16x32_bf16 v[48:51], v[120:123], v[152:155], v[48:51]
    ds_read_b64_tr_b16 v[104:105], v13 offset:8192
    ds_read_b64_tr_b16 v[106:107], v13 offset:8704
    v_mfma_f32_16x16x32_bf16 v[64:67], v[20:23], v[136:139], v[64:67]
    ds_read_b64_tr_b16 v[112:113], v13 offset:16384
    ds_read_b64_tr_b16 v[114:115], v13 offset:16896
    v_mfma_f32_16x16x32_bf16 v[36:39], v[136:139], v[128:131], v[36:39]
    ds_read_b128 v[84:87], v12 offset:0
    ds_read_b128 v[92:95], v12 offset:2048
    v_mfma_f32_16x16x32_bf16 v[44:47], v[144:147], v[128:131], v[44:47]
    ds_read_b64_tr_b16 v[100:101], v13 offset:4096
    ds_read_b64_tr_b16 v[102:103], v13 offset:4608
    v_mfma_f32_16x16x32_bf16 v[68:71], v[20:23], v[144:147], v[68:71]
    ds_read_b64_tr_b16 v[108:109], v13 offset:12288
    ds_read_b64_tr_b16 v[110:111], v13 offset:12800
    v_mfma_f32_16x16x32_bf16 v[52:55], v[128:131], v[152:155], v[52:55]
    ds_read_b64_tr_b16 v[116:117], v13 offset:20480
    ds_read_b64_tr_b16 v[118:119], v13 offset:20992
    v_mfma_f32_16x16x32_bf16 v[32:35], v[140:143], v[124:127], v[32:35]
    v_mfma_f32_16x16x32_bf16 v[40:43], v[148:151], v[124:127], v[40:43]
    v_mfma_f32_16x16x32_bf16 v[72:75], v[20:23], v[152:155], v[72:75]
    v_mfma_f32_16x16x32_bf16 v[48:51], v[124:127], v[156:159], v[48:51]
    s_waitcnt vmcnt(1) lgkmcnt(0)
    v_mfma_f32_16x16x32_bf16 v[36:39], v[140:143], v[132:135], v[36:39]
    v_mfma_f32_16x16x32_bf16 v[56:59], v[124:127], v[124:127], v[56:59]
    v_mfma_f32_16x16x32_bf16 v[44:47], v[148:151], v[132:135], v[44:47]
    v_mfma_f32_16x16x32_bf16 v[52:55], v[132:135], v[156:159], v[52:55]
    v_mfma_f32_16x16x32_bf16 v[60:63], v[124:127], v[20:23], v[60:63]
    s_barrier
    v_add_u32 v11, 98304, v8
    v_add_u32 v12, 98304, v9
    v_add_u32 v13, 98304, v10
    v_mfma_f32_16x16x32_bf16 v[32:35], v[96:99], v[80:83], v[32:35]
    ds_read_b128 v[120:123], v11 offset:0
    v_mfma_f32_16x16x32_bf16 v[40:43], v[104:107], v[80:83], v[40:43]
    ds_read_b128 v[128:131], v11 offset:2048
    v_mfma_f32_16x16x32_bf16 v[48:51], v[80:83], v[112:115], v[48:51]
    ds_read_b64_tr_b16 v[136:137], v13 offset:0
    ds_read_b64_tr_b16 v[138:139], v13 offset:512
    v_mfma_f32_16x16x32_bf16 v[64:67], v[20:23], v[96:99], v[64:67]
    ds_read_b64_tr_b16 v[144:145], v13 offset:8192
    v_mfma_f32_16x16x32_bf16 v[36:39], v[96:99], v[88:91], v[36:39]
    ds_read_b64_tr_b16 v[146:147], v13 offset:8704
    ds_read_b64_tr_b16 v[152:153], v13 offset:16384
    v_mfma_f32_16x16x32_bf16 v[44:47], v[104:107], v[88:91], v[44:47]
    ds_read_b64_tr_b16 v[154:155], v13 offset:16896
    v_mfma_f32_16x16x32_bf16 v[68:71], v[20:23], v[104:107], v[68:71]
    ds_read_b128 v[124:127], v12 offset:0
    ds_read_b128 v[132:135], v12 offset:2048
    v_mfma_f32_16x16x32_bf16 v[52:55], v[88:91], v[112:115], v[52:55]
    ds_read_b64_tr_b16 v[140:141], v13 offset:4096
    v_mfma_f32_16x16x32_bf16 v[32:35], v[100:103], v[84:87], v[32:35]
    ds_read_b64_tr_b16 v[142:143], v13 offset:4608
    ds_read_b64_tr_b16 v[148:149], v13 offset:12288
    v_mfma_f32_16x16x32_bf16 v[40:43], v[108:111], v[84:87], v[40:43]
    ds_read_b64_tr_b16 v[150:151], v13 offset:12800
    v_mfma_f32_16x16x32_bf16 v[72:75], v[20:23], v[112:115], v[72:75]
    ds_read_b64_tr_b16 v[156:157], v13 offset:20480
    ds_read_b64_tr_b16 v[158:159], v13 offset:20992
    v_mfma_f32_16x16x32_bf16 v[48:51], v[84:87], v[116:119], v[48:51]
    v_mfma_f32_16x16x32_bf16 v[36:39], v[100:103], v[92:95], v[36:39]
    v_mfma_f32_16x16x32_bf16 v[56:59], v[84:87], v[84:87], v[56:59]
    v_mfma_f32_16x16x32_bf16 v[44:47], v[108:111], v[92:95], v[44:47]
    v_mfma_f32_16x16x32_bf16 v[52:55], v[92:95], v[116:119], v[52:55]
    v_mfma_f32_16x16x32_bf16 v[60:63], v[84:87], v[20:23], v[60:63]
    s_waitcnt lgkmcnt(0)
    v_mfma_f32_16x16x32_bf16 v[32:35], v[136:139], v[120:123], v[32:35]
    v_mfma_f32_16x16x32_bf16 v[40:43], v[144:147], v[120:123], v[40:43]
    v_mfma_f32_16x16x32_bf16 v[48:51], v[120:123], v[152:155], v[48:51]
    v_mfma_f32_16x16x32_bf16 v[64:67], v[20:23], v[136:139], v[64:67]
    v_mfma_f32_16x16x32_bf16 v[36:39], v[136:139], v[128:131], v[36:39]
    v_mfma_f32_16x16x32_bf16 v[44:47], v[144:147], v[128:131], v[44:47]
    v_mfma_f32_16x16x32_bf16 v[68:71], v[20:23], v[144:147], v[68:71]
    v_mfma_f32_16x16x32_bf16 v[52:55], v[128:131], v[152:155], v[52:55]
    v_mfma_f32_16x16x32_bf16 v[32:35], v[140:143], v[124:127], v[32:35]
    v_mfma_f32_16x16x32_bf16 v[40:43], v[148:151], v[124:127], v[40:43]
    v_mfma_f32_16x16x32_bf16 v[72:75], v[20:23], v[152:155], v[72:75]
    v_mfma_f32_16x16x32_bf16 v[48:51], v[124:127], v[156:159], v[48:51]
    v_mfma_f32_16x16x32_bf16 v[36:39], v[140:143], v[132:135], v[36:39]
    v_mfma_f32_16x16x32_bf16 v[56:59], v[124:127], v[124:127], v[56:59]
    v_mfma_f32_16x16x32_bf16 v[44:47], v[148:151], v[132:135], v[44:47]
    v_mfma_f32_16x16x32_bf16 v[52:55], v[132:135], v[156:159], v[52:55]
    v_mfma_f32_16x16x32_bf16 v[60:63], v[124:127], v[20:23], v[60:63]
    s_branch L_k1_cj
L_k1_c2:
    s_waitcnt vmcnt(4) lgkmcnt(0)
    s_barrier
    v_add_u32 v11, 0, v8
    v_add_u32 v12, 0, v9
    v_add_u32 v13, 0, v10
    ds_read_b128 v[80:83], v11 offset:0
    ds_read_b128 v[88:91], v11 offset:2048
    ds_read_b64_tr_b16 v[96:97], v13 offset:0
    ds_read_b64_tr_b16 v[98:99], v13 offset:512
    ds_read_b64_tr_b16 v[104:105], v13 offset:8192
    ds_read_b64_tr_b16 v[106:107], v13 offset:8704
    ds_read_b64_tr_b16 v[112:113], v13 offset:16384
    ds_read_b64_tr_b16 v[114:115], v13 offset:16896
    ds_read_b128 v[84:87], v12 offset:0
    ds_read_b128 v[92:95], v12 offset:2048
    ds_read_b64_tr_b16 v[100:101], v13 offset:4096
    ds_read_b64_tr_b16 v[102:103], v13 offset:4608
    ds_read_b64_tr_b16 v[108:109], v13 offset:12288
    ds_read_b64_tr_b16 v[110:111], v13 offset:12800
    ds_read_b64_tr_b16 v[116:117], v13 offset:20480
    ds_read_b64_tr_b16 v[118:119], v13 offset:20992
    s_add_u32 s50, s49, 2
    s_and_b32 s50, s50, 7
    s_lshl_b32 s51, s50, 7
    s_add_u32 s51, s51, s45
    s_add_u32 m0, s47, 65536
    s_mul_i32 s50, s50, 196608
    buffer_load_dwordx4 v18, s[28:31], s51 offen lds
    s_add_u32 s50, s50, s46
    s_add_u32 m0, s47, 73728
    s_add_u32 s44, s50, 0
    buffer_load_dwordx4 v19, s[32:35], s44 offen lds
    s_add_u32 m0, s47, 81920
    s_add_u32 s44, s50, 1024
    buffer_load_dwordx4 v19, s[32:35], s44 offen lds
    s_add_u32 m0, s47, 90112
    s_add_u32 s44, s50, 2048
    buffer_load_dwordx4 v19, s[32:35], s44 offen lds
    s_add_u32 s50, s49, 3
    s_and_b32 s50, s50, 7
    s_lshl_b32 s51, s50, 7
    s_add_u32 s51, s51, s45
    s_add_u32 m0, s47, 98304
    s_mul_i32 s50, s50, 196608
    buffer_load_dwordx4 v18, s[28:31], s51 offen lds
    s_add_u32 s50, s50, s46
    s_add_u32 m0, s47, 106496
    s_add_u32 s44, s50, 0
    buffer_load_dwordx4 v19, s[32:35], s44 offen lds
    s_add_u32 m0, s47, 114688
    s_add_u32 s44, s50, 1024
    buffer_load_dwordx4 v19, s[32:35], s44 offen lds
    s_add_u32 m0, s47, 122880
    s_add_u32 s44, s50, 2048
    buffer_load_dwordx4 v19, s[32:35], s44 offen lds
    s_waitcnt vmcnt(8) lgkmcnt(0)
    s_barrier
    v_add_u32 v11, 32768, v8
    v_add_u32 v12, 32768, v9
    v_add_u32 v13, 32768, v10
    v_mfma_f32_16x16x32_bf16 v[32:35], v[96:99], v[80:83], v[32:35]
    ds_read_b128 v[120:123], v11 offset:0
    ds_read_b128 v[128:131], v11 offset:2048
    v_mfma_f32_16x16x32_bf16 v[40:43], v[104:107], v[80:83], v[40:43]
    ds_read_b64_tr_b16 v[136:137], v13 offset:0
    ds_read_b64_tr_b16 v[138:139], v13 offset:512
    v_mfma_f32_16x16x32_bf16 v[48:51], v[80:83], v[112:115], v[48:51]
    ds_read_b64_tr_b16 v[144:145], v13 offset:8192
    ds_read_b64_tr_b16 v[146:147], v13 offset:8704
    v_mfma_f32_16x16x32_bf16 v[64:67], v[20:23], v[96:99], v[64:67]
    ds_read_b64_tr_b16 v[152:153], v13 offset:16384
    ds_read_b64_tr_b16 v[154:155], v13 offset:16896
    v_mfma_f32_16x16x32_bf16 v[36:39], v[96:99], v[88:91], v[36:39]
    ds_read_b128 v[124:127], v12 offset:0
    ds_read_b128 v[132:135], v12 offset:2048
    v_mfma_f32_16x16x32_bf16 v[44:47], v[104:107], v[88:91], v[44:47]
    ds_read_b64_tr_b16 v[140:141], v13 offset:4096
    ds_read_b64_tr_b16 v[142:143], v13 offset:4608
    v_mfma_f32_16x16x32_bf16 v[68:71], v[20:23], v[104:107], v[68:71]
    ds_read_b64_tr_b16 v[148:149], v13 offset:12288
    ds_read_b64_tr_b16 v[150:151], v13 offset:12800
    v_mfma_f32_16x16x32_bf16 v[52:55], v[88:91], v[112:115], v[52:55]
    ds_read_b64_tr_b16 v[156:157], v13 offset:20480
    ds_read_b64_tr_b16 v[158:159], v13 offset:20992
    v_mfma_f32_16x16x32_bf16 v[32:35], v[100:103], v[84:87], v[32:35]
    s_add_u32 s50, s49, 4
    s_and_b32 s50, s50, 7
    s_lshl_b32 s51, s50, 7
    s_add_u32 s51, s51, s45
    s_add_u32 m0, s47, 0
    s_mul_i32 s50, s50, 196608
    buffer_load_dwordx4 v18, s[28:31], s51 offen lds
    v_mfma_f32_16x16x32_bf16 v[40:43], v[108:111], v[84:87], v[40:43]
    s_add_u32 s50, s50, s46
    s_add_u32 m0, s47, 8192
    s_add_u32 s44, s50, 0
    buffer_load_dwordx4 v19, s[32:35], s44 offen lds
    v_mfma_f32_16x16x32_bf16 v[72:75], v[20:23], v[112:115], v[72:75]
    s_add_u32 m0, s47, 16384
    s_add_u32 s44, s50, 1024
    buffer_load_dwordx4 v19, s[32:35], s44 offen lds
    v_mfma_f32_16x16x32_bf16 v[48:51], v[84:87], v[116:119], v[48:51]
    s_add_u32 m0, s47, 24576
    s_add_u32 s44, s50, 2048
    buffer_load_dwordx4 v19, s[32:35], s44 offen lds
    s_waitcnt vmcnt(8) lgkmcnt(0)
    v_mfma_f32_16x16x32_bf16 v[36:39], v[100:103], v[92:95], v[36:39]
    v_mfma_f32_16x16x32_bf16 v[56:59], v[88:91], v[88:91], v[56:59]
    v_mfma_f32_16x16x32_bf16 v[44:47], v[108:111], v[92:95], v[44:47]
    v_mfma_f32_16x16x32_bf16 v[52:55], v[92:95], v[116:119], v[52:55]
    v_mfma_f32_16x16x32_bf16 v[60:63], v[88:91], v[20:23], v[60:63]
    s_barrier
    v_add_u32 v11, 65536, v8
    v_add_u32 v12, 65536, v9
    v_add_u32 v13, 65536, v10
    v_mfma_f32_16x16x32_bf16 v[32:35], v[136:139], v[120:123], v[32:35]
    ds_read_b128 v[80:83], v11 offset:0
    ds_read_b128 v[88:91], v11 offset:2048
    v_mfma_f32_16x16x32_bf16 v[40:43], v[144:147], v[120:123], v[40:43]
    ds_read_b64_tr_b16 v[96:97], v13 offset:0
    ds_read_b64_tr_b16 v[98:99], v13 offset:512
    v_mfma_f32_16x16x32_bf16 v[48:51], v[120:123], v[152:155], v[48:51]
    ds_read_b64_tr_b16 v[104:105], v13 offset:8192
    ds_read_b64_tr_b16 v[106:107], v13 offset:8704
    v_mfma_f32_16x16x32_bf16 v[64:67], v[20:23], v[136:139], v[64:67]
    ds_read_b64_tr_b16 v[112:113], v13 offset:16384
    ds_read_b64_tr_b16 v[114:115], v13 offset:16896
    v_mfma_f32_16x16x32_bf16 v[36:39], v[136:139], v[128:131], v[36:39]
    ds_read_b128 v[84:87], v12 offset:0
    ds_read_b128 v[92:95], v12 offset:2048
    v_mfma_f32_16x16x32_bf16 v[44:47], v[144:147], v[128:131], v[44:47]
    ds_read_b64_tr_b16 v[100:101], v13 offset:4096
    ds_read_b64_tr_b16 v[102:103], v13 offset:4608
    v_mfma_f32_16x16x32_bf16 v[68:71], v[20:23], v[144:147], v[68:71]
    ds_read_b64_tr_b16 v[108:109], v13 offset:12288
    ds_read_b64_tr_b16 v[110:111], v13 offset:12800
    v_mfma_f32_16x16x32_bf16 v[52:55], v[128:131], v[152:155], v[52:55]
    ds_read_b64_tr_b16 v[116:117], v13 offset:20480
    ds_read_b64_tr_b16 v[118:119], v13 offset:20992
    v_mfma_f32_16x16x32_bf16 v[32:35], v[140:143], v[124:127], v[32:35]
    s_add_u32 s50, s49, 5
    s_and_b32 s50, s50, 7
    s_lshl_b32 s51, s50, 7
    s_add_u32 s51, s51, s45
    s_add_u32 m0, s47, 32768
    s_mul_i32 s50, s50, 196608
    buffer_load_dwordx4 v18, s[28:31], s51 offen lds
    v_mfma_f32_16x16x32_bf16 v[40:43], v[148:151], v[124:127], v[40:43]
    s_add_u32 s50, s50, s46
    s_add_u32 m0, s47, 40960
    s_add_u32 s44, s50, 0
    buffer_load_dwordx4 v19, s[32:35], s44 offen lds
    v_mfma_f32_16x16x32_bf16 v[72:75], v[20:23], v[152:155], v[72:75]
    s_add_u32 m0, s47, 49152
    s_add_u32 s44, s50, 1024
    buffer_load_dwordx4 v19, s[32:35], s44 offen lds
    v_mfma_f32_16x16x32_bf16 v[48:51], v[124:127], v[156:159], v[48:51]
    s_add_u32 m0, s47, 57344
    s_add_u32 s44, s50, 2048
    buffer_load_dwordx4 v19, s[32:35], s44 offen lds
    s_waitcnt vmcnt(8) lgkmcnt(0)
    v_mfma_f32_16x16x32_bf16 v[36:39], v[140:143], v[132:135], v[36:39]
    v_mfma_f32_16x16x32_bf16 v[56:59], v[128:131], v[128:131], v[56:59]
    v_mfma_f32_16x16x32_bf16 v[44:47], v[148:151], v[132:135], v[44:47]
    v_mfma_f32_16x16x32_bf16 v[52:55], v[132:135], v[156:159], v[52:55]
    v_mfma_f32_16x16x32_bf16 v[60:63], v[128:131], v[20:23], v[60:63]
    s_barrier
    v_add_u32 v11, 98304, v8
    v_add_u32 v12, 98304, v9
    v_add_u32 v13, 98304, v10
    v_mfma_f32_16x16x32_bf16 v[32:35], v[96:99], v[80:83], v[32:35]
    ds_read_b128 v[120:123], v11 offset:0
    ds_read_b128 v[128:131], v11 offset:2048
    v_mfma_f32_16x16x32_bf16 v[40:43], v[104:107], v[80:83], v[40:43]
    ds_read_b64_tr_b16 v[136:137], v13 offset:0
    ds_read_b64_tr_b16 v[138:139], v13 offset:512
    v_mfma_f32_16x16x32_bf16 v[48:51], v[80:83], v[112:115], v[48:51]
    ds_read_b64_tr_b16 v[144:145], v13 offset:8192
    ds_read_b64_tr_b16 v[146:147], v13 offset:8704
    v_mfma_f32_16x16x32_bf16 v[64:67], v[20:23], v[96:99], v[64:67]
    ds_read_b64_tr_b16 v[152:153], v13 offset:16384
    ds_read_b64_tr_b16 v[154:155], v13 offset:16896
    v_mfma_f32_16x16x32_bf16 v[36:39], v[96:99], v[88:91], v[36:39]
    ds_read_b128 v[124:127], v12 offset:0
    ds_read_b128 v[132:135], v12 offset:2048
    v_mfma_f32_16x16x32_bf16 v[44:47], v[104:107], v[88:91], v[44:47]
    ds_read_b64_tr_b16 v[140:141], v13 offset:4096
    ds_read_b64_tr_b16 v[142:143], v13 offset:4608
    v_mfma_f32_16x16x32_bf16 v[68:71], v[20:23], v[104:107], v[68:71]
    ds_read_b64_tr_b16 v[148:149], v13 offset:12288
    ds_read_b64_tr_b16 v[150:151], v13 offset:12800
    v_mfma_f32_16x16x32_bf16 v[52:55], v[88:91], v[112:115], v[52:55]
    ds_read_b64_tr_b16 v[156:157], v13 offset:20480
    ds_read_b64_tr_b16 v[158:159], v13 offset:20992
    v_mfma_f32_16x16x32_bf16 v[32:35], v[100:103], v[84:87], v[32:35]
    s_add_u32 s50, s49, 6
    s_and_b32 s50, s50, 7
    s_lshl_b32 s51, s50, 7
    s_add_u32 s51, s51, s45
    s_add_u32 m0, s47, 65536
    s_mul_i32 s50, s50, 196608
    buffer_load_dwordx4 v18, s[28:31], s51 offen lds
    v_mfma_f32_16x16x32_bf16 v[40:43], v[108:111], v[84:87], v[40:43]
    s_add_u32 s50, s50, s46
    s_add_u32 m0, s47, 73728
    s_add_u32 s44, s50, 0
    buffer_load_dwordx4 v19, s[32:35], s44 offen lds
    v_mfma_f32_16x16x32_bf16 v[72:75], v[20:23], v[112:115], v[72:75]
    s_add_u32 m0, s47, 81920
    s_add_u32 s44, s50, 1024
    buffer_load_dwordx4 v19, s[32:35], s44 offen lds
    v_mfma_f32_16x16x32_bf16 v[48:51], v[84:87], v[116:119], v[48:51]
    s_add_u32 m0, s47, 90112
    s_add_u32 s44, s50, 2048
    buffer_load_dwordx4 v19, s[32:35], s44 offen lds
    s_waitcnt vmcnt(8) lgkmcnt(0)
    v_mfma_f32_16x16x32_bf16 v[36:39], v[100:103], v[92:95], v[36:39]
    v_mfma_f32_16x16x32_bf16 v[56:59], v[88:91], v[88:91], v[56:59]
    v_mfma_f32_16x16x32_bf16 v[44:47], v[108:111], v[92:95], v[44:47]
    v_mfma_f32_16x16x32_bf16 v[52:55], v[92:95], v[116:119], v[52:55]
    v_mfma_f32_16x16x32_bf16 v[60:63], v[88:91], v[20:23], v[60:63]
    s_barrier
    v_add_u32 v11, 0, v8
    v_add_u32 v12, 0, v9
    v_add_u32 v13, 0, v10
    v_mfma_f32_16x16x32_bf16 v[32:35], v[136:139], v[120:123], v[32:35]
    ds_read_b128 v[80:83], v11 offset:0
    ds_read_b128 v[88:91], v11 offset:2048
    v_mfma_f32_16x16x32_bf16 v[40:43], v[144:147], v[120:123], v[40:43]
    ds_read_b64_tr_b16 v[96:97], v13 offset:0
    ds_read_b64_tr_b16 v[98:99], v13 offset:512
    v_mfma_f32_16x16x32_bf16 v[48:51], v[120:123], v[152:155], v[48:51]
    ds_read_b64_tr_b16 v[104:105], v13 offset:8192
    ds_read_b64_tr_b16 v[106:107], v13 offset:8704
    v_mfma_f32_16x16x32_bf16 v[64:67], v[20:23], v[136:139], v[64:67]
    ds_read_b64_tr_b16 v[112:113], v13 offset:16384
    ds_read_b64_tr_b16 v[114:115], v13 offset:16896
    v_mfma_f32_16x16x32_bf16 v[36:39], v[136:139], v[128:131], v[36:39]
    ds_read_b128 v[84:87], v12 offset:0
    ds_read_b128 v[92:95], v12 offset:2048
    v_mfma_f32_16x16x32_bf16 v[44:47], v[144:147], v[128:131], v[44:47]
    ds_read_b64_tr_b16 v[100:101], v13 offset:4096
    ds_read_b64_tr_b16 v[102:103], v13 offset:4608
    v_mfma_f32_16x16x32_bf16 v[68:71], v[20:23], v[144:147], v[68:71]
    ds_read_b64_tr_b16 v[108:109], v13 offset:12288
    ds_read_b64_tr_b16 v[110:111], v13 offset:12800
    v_mfma_f32_16x16x32_bf16 v[52:55], v[128:131], v[152:155], v[52:55]
    ds_read_b64_tr_b16 v[116:117], v13 offset:20480
    ds_read_b64_tr_b16 v[118:119], v13 offset:20992
    v_mfma_f32_16x16x32_bf16 v[32:35], v[140:143], v[124:127], v[32:35]
    s_add_u32 s50, s49, 7
    s_and_b32 s50, s50, 7
    s_lshl_b32 s51, s50, 7
    s_add_u32 s51, s51, s45
    s_add_u32 m0, s47, 98304
    s_mul_i32 s50, s50, 196608
    buffer_load_dwordx4 v18, s[28:31], s51 offen lds
    v_mfma_f32_16x16x32_bf16 v[40:43], v[148:151], v[124:127], v[40:43]
    s_add_u32 s50, s50, s46
    s_add_u32 m0, s47, 106496
    s_add_u32 s44, s50, 0
    buffer_load_dwordx4 v19, s[32:35], s44 offen lds
    v_mfma_f32_16x16x32_bf16 v[72:75], v[20:23], v[152:155], v[72:75]
    s_add_u32 m0, s47, 114688
    s_add_u32 s44, s50, 1024
    buffer_load_dwordx4 v19, s[32:35], s44 offen lds
    v_mfma_f32_16x16x32_bf16 v[48:51], v[124:127], v[156:159], v[48:51]
    s_add_u32 m0, s47, 122880
    s_add_u32 s44, s50, 2048
    buffer_load_dwordx4 v19, s[32:35], s44 offen lds
    s_waitcnt vmcnt(8) lgkmcnt(0)
    v_mfma_f32_16x16x32_bf16 v[36:39], v[140:143], v[132:135], v[36:39]
    v_mfma_f32_16x16x32_bf16 v[56:59], v[128:131], v[128:131], v[56:59]
    v_mfma_f32_16x16x32_bf16 v[44:47], v[148:151], v[132:135], v[44:47]
    v_mfma_f32_16x16x32_bf16 v[52:55], v[132:135], v[156:159], v[52:55]
    v_mfma_f32_16x16x32_bf16 v[60:63], v[128:131], v[20:23], v[60:63]
    s_barrier
    s_and_b32 s53, s27, 1
    s_lshl_b32 s53, s53, 2
    s_and_b32 s54, s3, 3
    s_add_u32 s53, s53, s54
    s_lshr_b32 s54, s27, 1
    s_lshl_b32 s54, s54, 3
    s_lshr_b32 s55, s3, 2
    s_add_u32 s54, s54, s55
    s_lshl_b32 s53, s53, 18
    s_lshl_b32 s54, s54, 13
    s_add_u32 s53, s53, s54
    s_lshl_b32 s54, s26, 10
    s_add_u32 s53, s53, s54
    s_add_u32 s53, s53, 10747904
    v_lshlrev_b32 v28, 4, v1
    v_mov_b32 v24, -1
    v_mov_b32 v25, -1
    v_mov_b32 v26, -1
    v_mov_b32 v27, -1
    buffer_store_dwordx4 v[24:27], v28, s[36:39], s53 offen sc1
    v_add_u32 v11, 32768, v8
    v_add_u32 v12, 32768, v9
    v_add_u32 v13, 32768, v10
    v_mfma_f32_16x16x32_bf16 v[32:35], v[96:99], v[80:83], v[32:35]
    ds_read_b128 v[120:123], v11 offset:0
    ds_read_b128 v[128:131], v11 offset:2048
    v_mfma_f32_16x16x32_bf16 v[40:43], v[104:107], v[80:83], v[40:43]
    ds_read_b64_tr_b16 v[136:137], v13 offset:0
    ds_read_b64_tr_b16 v[138:139], v13 offset:512
    v_mfma_f32_16x16x32_bf16 v[48:51], v[80:83], v[112:115], v[48:51]
    ds_read_b64_tr_b16 v[144:145], v13 offset:8192
    ds_read_b64_tr_b16 v[146:147], v13 offset:8704
    v_mfma_f32_16x16x32_bf16 v[64:67], v[20:23], v[96:99], v[64:67]
    ds_read_b64_tr_b16 v[152:153], v13 offset:16384
    ds_read_b64_tr_b16 v[154:155], v13 offset:16896
    v_mfma_f32_16x16x32_bf16 v[36:39], v[96:99], v[88:91], v[36:39]
    ds_read_b128 v[124:127], v12 offset:0
    ds_read_b128 v[132:135], v12 offset:2048
    v_mfma_f32_16x16x32_bf16 v[44:47], v[104:107], v[88:91], v[44:47]
    ds_read_b64_tr_b16 v[140:141], v13 offset:4096
    ds_read_b64_tr_b16 v[142:143], v13 offset:4608
    v_mfma_f32_16x16x32_bf16 v[68:71], v[20:23], v[104:107], v[68:71]
    ds_read_b64_tr_b16 v[148:149], v13 offset:12288
    ds_read_b64_tr_b16 v[150:151], v13 offset:12800
    v_mfma_f32_16x16x32_bf16 v[52:55], v[88:91], v[112:115], v[52:55]
    ds_read_b64_tr_b16 v[156:157], v13 offset:20480
    ds_read_b64_tr_b16 v[158:159], v13 offset:20992
    v_mfma_f32_16x16x32_bf16 v[32:35], v[100:103], v[84:87], v[32:35]
    v_mfma_f32_16x16x32_bf16 v[40:43], v[108:111], v[84:87], v[40:43]
    v_mfma_f32_16x16x32_bf16 v[72:75], v[20:23], v[112:115], v[72:75]
    v_mfma_f32_16x16x32_bf16 v[48:51], v[84:87], v[116:119], v[48:51]
    s_waitcnt vmcnt(5) lgkmcnt(0)
    v_mfma_f32_16x16x32_bf16 v[36:39], v[100:103], v[92:95], v[36:39]
    v_mfma_f32_16x16x32_bf16 v[56:59], v[88:91], v[88:91], v[56:59]
    v_mfma_f32_16x16x32_bf16 v[44:47], v[108:111], v[92:95], v[44:47]
    v_mfma_f32_16x16x32_bf16 v[52:55], v[92:95], v[116:119], v[52:55]
    v_mfma_f32_16x16x32_bf16 v[60:63], v[88:91], v[20:23], v[60:63]
    s_barrier
    v_add_u32 v11, 65536, v8
    v_add_u32 v12, 65536, v9
    v_add_u32 v13, 65536, v10
    v_mfma_f32_16x16x32_bf16 v[32:35], v[136:139], v[120:123], v[32:35]
    ds_read_b128 v[80:83], v11 offset:0
    ds_read_b128 v[88:91], v11 offset:2048
    v_mfma_f32_16x16x32_bf16 v[40:43], v[144:147], v[120:123], v[40:43]
    ds_read_b64_tr_b16 v[96:97], v13 offset:0
    ds_read_b64_tr_b16 v[98:99], v13 offset:512
    v_mfma_f32_16x16x32_bf16 v[48:51], v[120:123], v[152:155], v[48:51]
    ds_read_b64_tr_b16 v[104:105], v13 offset:8192
    ds_read_b64_tr_b16 v[106:107], v13 offset:8704
    v_mfma_f32_16x16x32_bf16 v[64:67], v[20:23], v[136:139], v[64:67]
    ds_read_b64_tr_b16 v[112:113], v13 offset:16384
    ds_read_b64_tr_b16 v[114:115], v13 offset:16896
    v_mfma_f32_16x16x32_bf16 v[36:39], v[136:139], v[128:131], v[36:39]
    ds_read_b128 v[84:87], v12 offset:0
    ds_read_b128 v[92:95], v12 offset:2048
    v_mfma_f32_16x16x32_bf16 v[44:47], v[144:147], v[128:131], v[44:47]
    ds_read_b64_tr_b16 v[100:101], v13 offset:4096
    ds_read_b64_tr_b16 v[102:103], v13 offset:4608
    v_mfma_f32_16x16x32_bf16 v[68:71], v[20:23], v[144:147], v[68:71]
    ds_read_b64_tr_b16 v[108:109], v13 offset:12288
    ds_read_b64_tr_b16 v[110:111], v13 offset:12800
    v_mfma_f32_16x16x32_bf16 v[52:55], v[128:131], v[152:155], v[52:55]
    ds_read_b64_tr_b16 v[116:117], v13 offset:20480
    ds_read_b64_tr_b16 v[118:119], v13 offset:20992
    v_mfma_f32_16x16x32_bf16 v[32:35], v[140:143], v[124:127], v[32:35]
    v_mfma_f32_16x16x32_bf16 v[40:43], v[148:151], v[124:127], v[40:43]
    v_mfma_f32_16x16x32_bf16 v[72:75], v[20:23], v[152:155], v[72:75]
    v_mfma_f32_16x16x32_bf16 v[48:51], v[124:127], v[156:159], v[48:51]
    s_waitcnt vmcnt(1) lgkmcnt(0)
    v_mfma_f32_16x16x32_bf16 v[36:39], v[140:143], v[132:135], v[36:39]
    v_mfma_f32_16x16x32_bf16 v[56:59], v[128:131], v[128:131], v[56:59]
    v_mfma_f32_16x16x32_bf16 v[44:47], v[148:151], v[132:135], v[44:47]
    v_mfma_f32_16x16x32_bf16 v[52:55], v[132:135], v[156:159], v[52:55]
    v_mfma_f32_16x16x32_bf16 v[60:63], v[128:131], v[20:23], v[60:63]
    s_barrier
    v_add_u32 v11, 98304, v8
    v_add_u32 v12, 98304, v9
    v_add_u32 v13, 98304, v10
    v_mfma_f32_16x16x32_bf16 v[32:35], v[96:99], v[80:83], v[32:35]
    ds_read_b128 v[120:123], v11 offset:0
    v_mfma_f32_16x16x32_bf16 v[40:43], v[104:107], v[80:83], v[40:43]
    ds_read_b128 v[128:131], v11 offset:2048
    v_mfma_f32_16x16x32_bf16 v[48:51], v[80:83], v[112:115], v[48:51]
    ds_read_b64_tr_b16 v[136:137], v13 offset:0
    ds_read_b64_tr_b16 v[138:139], v13 offset:512
    v_mfma_f32_16x16x32_bf16 v[64:67], v[20:23], v[96:99], v[64:67]
    ds_read_b64_tr_b16 v[144:145], v13 offset:8192
    v_mfma_f32_16x16x32_bf16 v[36:39], v[96:99], v[88:91], v[36:39]
    ds_read_b64_tr_b16 v[146:147], v13 offset:8704
    ds_read_b64_tr_b16 v[152:153], v13 offset:16384
    v_mfma_f32_16x16x32_bf16 v[44:47], v[104:107], v[88:91], v[44:47]
    ds_read_b64_tr_b16 v[154:155], v13 offset:16896
    v_mfma_f32_16x16x32_bf16 v[68:71], v[20:23], v[104:107], v[68:71]
    ds_read_b128 v[124:127], v12 offset:0
    ds_read_b128 v[132:135], v12 offset:2048
    v_mfma_f32_16x16x32_bf16 v[52:55], v[88:91], v[112:115], v[52:55]
    ds_read_b64_tr_b16 v[140:141], v13 offset:4096
    v_mfma_f32_16x16x32_bf16 v[32:35], v[100:103], v[84:87], v[32:35]
    ds_read_b64_tr_b16 v[142:143], v13 offset:4608
    ds_read_b64_tr_b16 v[148:149], v13 offset:12288
    v_mfma_f32_16x16x32_bf16 v[40:43], v[108:111], v[84:87], v[40:43]
    ds_read_b64_tr_b16 v[150:151], v13 offset:12800
    v_mfma_f32_16x16x32_bf16 v[72:75], v[20:23], v[112:115], v[72:75]
    ds_read_b64_tr_b16 v[156:157], v13 offset:20480
    ds_read_b64_tr_b16 v[158:159], v13 offset:20992
    v_mfma_f32_16x16x32_bf16 v[48:51], v[84:87], v[116:119], v[48:51]
    v_mfma_f32_16x16x32_bf16 v[36:39], v[100:103], v[92:95], v[36:39]
    v_mfma_f32_16x16x32_bf16 v[56:59], v[88:91], v[88:91], v[56:59]
    v_mfma_f32_16x16x32_bf16 v[44:47], v[108:111], v[92:95], v[44:47]
    v_mfma_f32_16x16x32_bf16 v[52:55], v[92:95], v[116:119], v[52:55]
    v_mfma_f32_16x16x32_bf16 v[60:63], v[88:91], v[20:23], v[60:63]
    s_waitcnt lgkmcnt(0)
    v_mfma_f32_16x16x32_bf16 v[32:35], v[136:139], v[120:123], v[32:35]
    v_mfma_f32_16x16x32_bf16 v[40:43], v[144:147], v[120:123], v[40:43]
    v_mfma_f32_16x16x32_bf16 v[48:51], v[120:123], v[152:155], v[48:51]
    v_mfma_f32_16x16x32_bf16 v[64:67], v[20:23], v[136:139], v[64:67]
    v_mfma_f32_16x16x32_bf16 v[36:39], v[136:139], v[128:131], v[36:39]
    v_mfma_f32_16x16x32_bf16 v[44:47], v[144:147], v[128:131], v[44:47]
    v_mfma_f32_16x16x32_bf16 v[68:71], v[20:23], v[144:147], v[68:71]
    v_mfma_f32_16x16x32_bf16 v[52:55], v[128:131], v[152:155], v[52:55]
    v_mfma_f32_16x16x32_bf16 v[32:35], v[140:143], v[124:127], v[32:35]
    v_mfma_f32_16x16x32_bf16 v[40:43], v[148:151], v[124:127], v[40:43]
    v_mfma_f32_16x16x32_bf16 v[72:75], v[20:23], v[152:155], v[72:75]
    v_mfma_f32_16x16x32_bf16 v[48:51], v[124:127], v[156:159], v[48:51]
    v_mfma_f32_16x16x32_bf16 v[36:39], v[140:143], v[132:135], v[36:39]
    v_mfma_f32_16x16x32_bf16 v[56:59], v[128:131], v[128:131], v[56:59]
    v_mfma_f32_16x16x32_bf16 v[44:47], v[148:151], v[132:135], v[44:47]
    v_mfma_f32_16x16x32_bf16 v[52:55], v[132:135], v[156:159], v[52:55]
    v_mfma_f32_16x16x32_bf16 v[60:63], v[128:131], v[20:23], v[60:63]
    s_branch L_k1_cj
L_k1_c3:
    s_waitcnt vmcnt(4) lgkmcnt(0)
    s_barrier
    v_add_u32 v11, 0, v8
    v_add_u32 v12, 0, v9
    v_add_u32 v13, 0, v10
    ds_read_b128 v[80:83], v11 offset:0
    ds_read_b128 v[88:91], v11 offset:2048
    ds_read_b64_tr_b16 v[96:97], v13 offset:0
    ds_read_b64_tr_b16 v[98:99], v13 offset:512
    ds_read_b64_tr_b16 v[104:105], v13 offset:8192
    ds_read_b64_tr_b16 v[106:107], v13 offset:8704
    ds_read_b64_tr_b16 v[112:113], v13 offset:16384
    ds_read_b64_tr_b16 v[114:115], v13 offset:16896
    ds_read_b128 v[84:87], v12 offset:0
    ds_read_b128 v[92:95], v12 offset:2048
    ds_read_b64_tr_b16 v[100:101], v13 offset:4096
    ds_read_b64_tr_b16 v[102:103], v13 offset:4608
    ds_read_b64_tr_b16 v[108:109], v13 offset:12288
    ds_read_b64_tr_b16 v[110:111], v13 offset:12800
    ds_read_b64_tr_b16 v[116:117], v13 offset:20480
    ds_read_b64_tr_b16 v[118:119], v13 offset:20992
    s_add_u32 s50, s49, 2
    s_and_b32 s50, s50, 7
    s_lshl_b32 s51, s50, 7
    s_add_u32 s51, s51, s45
    s_add_u32 m0, s47, 65536
    s_mul_i32 s50, s50, 196608
    buffer_load_dwordx4 v18, s[28:31], s51 offen lds
    s_add_u32 s50, s50, s46
    s_add_u32 m0, s47, 73728
    s_add_u32 s44, s50, 0
    buffer_load_dwordx4 v19, s[32:35], s44 offen lds
    s_add_u32 m0, s47, 81920
    s_add_u32 s44, s50, 1024
    buffer_load_dwordx4 v19, s[32:35], s44 offen lds
    s_add_u32 m0, s47, 90112
    s_add_u32 s44, s50, 2048
    buffer_load_dwordx4 v19, s[32:35], s44 offen lds
    s_add_u32 s50, s49, 3
    s_and_b32 s50, s50, 7
    s_lshl_b32 s51, s50, 7
    s_add_u32 s51, s51, s45
    s_add_u32 m0, s47, 98304
    s_mul_i32 s50, s50, 196608
    buffer_load_dwordx4 v18, s[28:31], s51 offen lds
    s_add_u32 s50, s50, s46
    s_add_u32 m0, s47, 106496
    s_add_u32 s44, s50, 0
    buffer_load_dwordx4 v19, s[32:35], s44 offen lds
    s_add_u32 m0, s47, 114688
    s_add_u32 s44, s50, 1024
    buffer_load_dwordx4 v19, s[32:35], s44 offen lds
    s_add_u32 m0, s47, 122880
    s_add_u32 s44, s50, 2048
    buffer_load_dwordx4 v19, s[32:35], s44 offen lds
    s_waitcnt vmcnt(8) lgkmcnt(0)
    s_barrier
    v_add_u32 v11, 32768, v8
    v_add_u32 v12, 32768, v9
    v_add_u32 v13, 32768, v10
    v_mfma_f32_16x16x32_bf16 v[32:35], v[96:99], v[80:83], v[32:35]
    ds_read_b128 v[120:123], v11 offset:0
    ds_read_b128 v[128:131], v11 offset:2048
    v_mfma_f32_16x16x32_bf16 v[40:43], v[104:107], v[80:83], v[40:43]
    ds_read_b64_tr_b16 v[136:137], v13 offset:0
    ds_read_b64_tr_b16 v[138:139], v13 offset:512
    v_mfma_f32_16x16x32_bf16 v[48:51], v[80:83], v[112:115], v[48:51]
    ds_read_b64_tr_b16 v[144:145], v13 offset:8192
    ds_read_b64_tr_b16 v[146:147], v13 offset:8704
    v_mfma_f32_16x16x32_bf16 v[64:67], v[20:23], v[96:99], v[64:67]
    ds_read_b64_tr_b16 v[152:153], v13 offset:16384
    ds_read_b64_tr_b16 v[154:155], v13 offset:16896
    v_mfma_f32_16x16x32_bf16 v[36:39], v[96:99], v[88:91], v[36:39]
    ds_read_b128 v[124:127], v12 offset:0
    ds_read_b128 v[132:135], v12 offset:2048
    v_mfma_f32_16x16x32_bf16 v[44:47], v[104:107], v[88:91], v[44:47]
    ds_read_b64_tr_b16 v[140:141], v13 offset:4096
    ds_read_b64_tr_b16 v[142:143], v13 offset:4608
    v_mfma_f32_16x16x32_bf16 v[68:71], v[20:23], v[104:107], v[68:71]
    ds_read_b64_tr_b16 v[148:149], v13 offset:12288
    ds_read_b64_tr_b16 v[150:151], v13 offset:12800
    v_mfma_f32_16x16x32_bf16 v[52:55], v[88:91], v[112:115], v[52:55]
    ds_read_b64_tr_b16 v[156:157], v13 offset:20480
    ds_read_b64_tr_b16 v[158:159], v13 offset:20992
    v_mfma_f32_16x16x32_bf16 v[32:35], v[100:103], v[84:87], v[32:35]
    s_add_u32 s50, s49, 4
    s_and_b32 s50, s50, 7
    s_lshl_b32 s51, s50, 7
    s_add_u32 s51, s51, s45
    s_add_u32 m0, s47, 0
    s_mul_i32 s50, s50, 196608
    buffer_load_dwordx4 v18, s[28:31], s51 offen lds
    v_mfma_f32_16x16x32_bf16 v[40:43], v[108:111], v[84:87], v[40:43]
    s_add_u32 s50, s50, s46
    s_add_u32 m0, s47, 8192
    s_add_u32 s44, s50, 0
    buffer_load_dwordx4 v19, s[32:35], s44 offen lds
    v_mfma_f32_16x16x32_bf16 v[72:75], v[20:23], v[112:115], v[72:75]
    s_add_u32 m0, s47, 16384
    s_add_u32 s44, s50, 1024
    buffer_load_dwordx4 v19, s[32:35], s44 offen lds
    v_mfma_f32_16x16x32_bf16 v[48:51], v[84:87], v[116:119], v[48:51]
    s_add_u32 m0, s47, 24576
    s_add_u32 s44, s50, 2048
    buffer_load_dwordx4 v19, s[32:35], s44 offen lds
    s_waitcnt vmcnt(8) lgkmcnt(0)
    v_mfma_f32_16x16x32_bf16 v[36:39], v[100:103], v[92:95], v[36:39]
    v_mfma_f32_16x16x32_bf16 v[56:59], v[92:95], v[92:95], v[56:59]
    v_mfma_f32_16x16x32_bf16 v[44:47], v[108:111], v[92:95], v[44:47]
    v_mfma_f32_16x16x32_bf16 v[52:55], v[92:95], v[116:119], v[52:55]
    v_mfma_f32_16x16x32_bf16 v[60:63], v[92:95], v[20:23], v[60:63]
    s_barrier
    v_add_u32 v11, 65536, v8
    v_add_u32 v12, 65536, v9
    v_add_u32 v13, 65536, v10
    v_mfma_f32_16x16x32_bf16 v[32:35], v[136:139], v[120:123], v[32:35]
    ds_read_b128 v[80:83], v11 offset:0
    ds_read_b128 v[88:91], v11 offset:2048
    v_mfma_f32_16x16x32_bf16 v[40:43], v[144:147], v[120:123], v[40:43]
    ds_read_b64_tr_b16 v[96:97], v13 offset:0
    ds_read_b64_tr_b16 v[98:99], v13 offset:512
    v_mfma_f32_16x16x32_bf16 v[48:51], v[120:123], v[152:155], v[48:51]
    ds_read_b64_tr_b16 v[104:105], v13 offset:8192
    ds_read_b64_tr_b16 v[106:107], v13 offset:8704
    v_mfma_f32_16x16x32_bf16 v[64:67], v[20:23], v[136:139], v[64:67]
    ds_read_b64_tr_b16 v[112:113], v13 offset:16384
    ds_read_b64_tr_b16 v[114:115], v13 offset:16896
    v_mfma_f32_16x16x32_bf16 v[36:39], v[136:139], v[128:131], v[36:39]
    ds_read_b128 v[84:87], v12 offset:0
    ds_read_b128 v[92:95], v12 offset:2048
    v_mfma_f32_16x16x32_bf16 v[44:47], v[144:147], v[128:131], v[44:47]
    ds_read_b64_tr_b16 v[100:101], v13 offset:4096
    ds_read_b64_tr_b16 v[102:103], v13 offset:4608
    v_mfma_f32_16x16x32_bf16 v[68:71], v[20:23], v[144:147], v[68:71]
    ds_read_b64_tr_b16 v[108:109], v13 offset:12288
    ds_read_b64_tr_b16 v[110:111], v13 offset:12800
    v_mfma_f32_16x16x32_bf16 v[52:55], v[128:131], v[152:155], v[52:55]
    ds_read_b64_tr_b16 v[116:117], v13 offset:20480
    ds_read_b64_tr_b16 v[118:119], v13 offset:20992
    v_mfma_f32_16x16x32_bf16 v[32:35], v[140:143], v[124:127], v[32:35]
    s_add_u32 s50, s49, 5
    s_and_b32 s50, s50, 7
    s_lshl_b32 s51, s50, 7
    s_add_u32 s51, s51, s45
    s_add_u32 m0, s47, 32768
    s_mul_i32 s50, s50, 196608
    buffer_load_dwordx4 v18, s[28:31], s51 offen lds
    v_mfma_f32_16x16x32_bf16 v[40:43], v[148:151], v[124:127], v[40:43]
    s_add_u32 s50, s50, s46
    s_add_u32 m0, s47, 40960
    s_add_u32 s44, s50, 0
    buffer_load_dwordx4 v19, s[32:35], s44 offen lds
    v_mfma_f32_16x16x32_bf16 v[72:75], v[20:23], v[152:155], v[72:75]
    s_add_u32 m0, s47, 49152
    s_add_u32 s44, s50, 1024
    buffer_load_dwordx4 v19, s[32:35], s44 offen lds
    v_mfma_f32_16x16x32_bf16 v[48:51], v[124:127], v[156:159], v[48:51]
    s_add_u32 m0, s47, 57344
    s_add_u32 s44, s50, 2048
    buffer_load_dwordx4 v19, s[32:35], s44 offen lds
    s_waitcnt vmcnt(8) lgkmcnt(0)
    v_mfma_f32_16x16x32_bf16 v[36:39], v[140:143], v[132:135], v[36:39]
    v_mfma_f32_16x16x32_bf16 v[56:59], v[132:135], v[132:135], v[56:59]
    v_mfma_f32_16x16x32_bf16 v[44:47], v[148:151], v[132:135], v[44:47]
    v_mfma_f32_16x16x32_bf16 v[52:55], v[132:135], v[156:159], v[52:55]
    v_mfma_f32_16x16x32_bf16 v[60:63], v[132:135], v[20:23], v[60:63]
    s_barrier
    v_mov_b32 v2, 0
    global_load_dword v30, v2, s[22:23] sc1
    v_add_u32 v11, 98304, v8
    v_add_u32 v12, 98304, v9
    v_add_u32 v13, 98304, v10
    v_mfma_f32_16x16x32_bf16 v[32:35], v[96:99], v[80:83], v[32:35]
    ds_read_b128 v[120:123], v11 offset:0
    ds_read_b128 v[128:131], v11 offset:2048
    v_mfma_f32_16x16x32_bf16 v[40:43], v[104:107], v[80:83], v[40:43]
    ds_read_b64_tr_b16 v[136:137], v13 offset:0
    ds_read_b64_tr_b16 v[138:139], v13 offset:512
    v_mfma_f32_16x16x32_bf16 v[48:51], v[80:83], v[112:115], v[48:51]
    ds_read_b64_tr_b16 v[144:145], v13 offset:8192
    ds_read_b64_tr_b16 v[146:147], v13 offset:8704
    v_mfma_f32_16x16x32_bf16 v[64:67], v[20:23], v[96:99], v[64:67]
    ds_read_b64_tr_b16 v[152:153], v13 offset:16384
    ds_read_b64_tr_b16 v[154:155], v13 offset:16896
    v_mfma_f32_16x16x32_bf16 v[36:39], v[96:99], v[88:91], v[36:39]
    ds_read_b128 v[124:127], v12 offset:0
    ds_read_b128 v[132:135], v12 offset:2048
    v_mfma_f32_16x16x32_bf16 v[44:47], v[104:107], v[88:91], v[44:47]
    ds_read_b64_tr_b16 v[140:141], v13 offset:4096
    ds_read_b64_tr_b16 v[142:143], v13 offset:4608
    v_mfma_f32_16x16x32_bf16 v[68:71], v[20:23], v[104:107], v[68:71]
    ds_read_b64_tr_b16 v[148:149], v13 offset:12288
    ds_read_b64_tr_b16 v[150:151], v13 offset:12800
    v_mfma_f32_16x16x32_bf16 v[52:55], v[88:91], v[112:115], v[52:55]
    ds_read_b64_tr_b16 v[156:157], v13 offset:20480
    ds_read_b64_tr_b16 v[158:159], v13 offset:20992
    v_mfma_f32_16x16x32_bf16 v[32:35], v[100:103], v[84:87], v[32:35]
    s_add_u32 s50, s49, 6
    s_and_b32 s50, s50, 7
    s_lshl_b32 s51, s50, 7
    s_add_u32 s51, s51, s45
    s_add_u32 m0, s47, 65536
    s_mul_i32 s50, s50, 196608
    buffer_load_dwordx4 v18, s[28:31], s51 offen lds
    v_mfma_f32_16x16x32_bf16 v[40:43], v[108:111], v[84:87], v[40:43]
    s_add_u32 s50, s50, s46
    s_add_u32 m0, s47, 73728
    s_add_u32 s44, s50, 0
    buffer_load_dwordx4 v19, s[32:35], s44 offen lds
    v_mfma_f32_16x16x32_bf16 v[72:75], v[20:23], v[112:115], v[72:75]
    s_add_u32 m0, s47, 81920
    s_add_u32 s44, s50, 1024
    buffer_load_dwordx4 v19, s[32:35], s44 offen lds
    v_mfma_f32_16x16x32_bf16 v[48:51], v[84:87], v[116:119], v[48:51]
    s_add_u32 m0, s47, 90112
    s_add_u32 s44, s50, 2048
    buffer_load_dwordx4 v19, s[32:35], s44 offen lds
    s_waitcnt vmcnt(9) lgkmcnt(0)
    v_mfma_f32_16x16x32_bf16 v[36:39], v[100:103], v[92:95], v[36:39]
    v_mfma_f32_16x16x32_bf16 v[56:59], v[92:95], v[92:95], v[56:59]
    v_mfma_f32_16x16x32_bf16 v[44:47], v[108:111], v[92:95], v[44:47]
    v_mfma_f32_16x16x32_bf16 v[52:55], v[92:95], v[116:119], v[52:55]
    v_mfma_f32_16x16x32_bf16 v[60:63], v[92:95], v[20:23], v[60:63]
    s_barrier
    v_add_u32 v11, 0, v8
    v_add_u32 v12, 0, v9
    v_add_u32 v13, 0, v10
    v_mfma_f32_16x16x32_bf16 v[32:35], v[136:139], v[120:123], v[32:35]
    ds_read_b128 v[80:83], v11 offset:0
    ds_read_b128 v[88:91], v11 offset:2048
    v_mfma_f32_16x16x32_bf16 v[40:43], v[144:147], v[120:123], v[40:43]
    ds_read_b64_tr_b16 v[96:97], v13 offset:0
    ds_read_b64_tr_b16 v[98:99], v13 offset:512
    v_mfma_f32_16x16x32_bf16 v[48:51], v[120:123], v[152:155], v[48:51]
    ds_read_b64_tr_b16 v[104:105], v13 offset:8192
    ds_read_b64_tr_b16 v[106:107], v13 offset:8704
    v_mfma_f32_16x16x32_bf16 v[64:67], v[20:23], v[136:139], v[64:67]
    ds_read_b64_tr_b16 v[112:113], v13 offset:16384
    ds_read_b64_tr_b16 v[114:115], v13 offset:16896
    v_mfma_f32_16x16x32_bf16 v[36:39], v[136:139], v[128:131], v[36:39]
    ds_read_b128 v[84:87], v12 offset:0
    ds_read_b128 v[92:95], v12 offset:2048
    v_mfma_f32_16x16x32_bf16 v[44:47], v[144:147], v[128:131], v[44:47]
    ds_read_b64_tr_b16 v[100:101], v13 offset:4096
    ds_read_b64_tr_b16 v[102:103], v13 offset:4608
    v_mfma_f32_16x16x32_bf16 v[68:71], v[20:23], v[144:147], v[68:71]
    ds_read_b64_tr_b16 v[108:109], v13 offset:12288
    ds_read_b64_tr_b16 v[110:111], v13 offset:12800
    v_mfma_f32_16x16x32_bf16 v[52:55], v[128:131], v[152:155], v[52:55]
    ds_read_b64_tr_b16 v[116:117], v13 offset:20480
    ds_read_b64_tr_b16 v[118:119], v13 offset:20992
    v_mfma_f32_16x16x32_bf16 v[32:35], v[140:143], v[124:127], v[32:35]
    s_add_u32 s50, s49, 7
    s_and_b32 s50, s50, 7
    s_lshl_b32 s51, s50, 7
    s_add_u32 s51, s51, s45
    s_add_u32 m0, s47, 98304
    s_mul_i32 s50, s50, 196608
    buffer_load_dwordx4 v18, s[28:31], s51 offen lds
    v_mfma_f32_16x16x32_bf16 v[40:43], v[148:151], v[124:127], v[40:43]
    s_add_u32 s50, s50, s46
    s_add_u32 m0, s47, 106496
    s_add_u32 s44, s50, 0
    buffer_load_dwordx4 v19, s[32:35], s44 offen lds
    v_mfma_f32_16x16x32_bf16 v[72:75], v[20:23], v[152:155], v[72:75]
    s_add_u32 m0, s47, 114688
    s_add_u32 s44, s50, 1024
    buffer_load_dwordx4 v19, s[32:35], s44 offen lds
    v_mfma_f32_16x16x32_bf16 v[48:51], v[124:127], v[156:159], v[48:51]
    s_add_u32 m0, s47, 122880
    s_add_u32 s44, s50, 2048
    buffer_load_dwordx4 v19, s[32:35], s44 offen lds
    s_waitcnt vmcnt(9) lgkmcnt(0)
    v_mfma_f32_16x16x32_bf16 v[36:39], v[140:143], v[132:135], v[36:39]
    v_mfma_f32_16x16x32_bf16 v[56:59], v[132:135], v[132:135], v[56:59]
    v_mfma_f32_16x16x32_bf16 v[44:47], v[148:151], v[132:135], v[44:47]
    v_mfma_f32_16x16x32_bf16 v[52:55], v[132:135], v[156:159], v[52:55]
    v_mfma_f32_16x16x32_bf16 v[60:63], v[132:135], v[20:23], v[60:63]
    s_barrier
    s_and_b32 s53, s27, 1
    s_lshl_b32 s53, s53, 2
    s_and_b32 s54, s3, 3
    s_add_u32 s53, s53, s54
    s_lshr_b32 s54, s27, 1
    s_lshl_b32 s54, s54, 3
    s_lshr_b32 s55, s3, 2
    s_add_u32 s54, s54, s55
    s_lshl_b32 s53, s53, 18
    s_lshl_b32 s54, s54, 13
    s_add_u32 s53, s53, s54
    s_lshl_b32 s54, s26, 10
    s_add_u32 s53, s53, s54
    s_add_u32 s53, s53, 10747904
    v_lshlrev_b32 v28, 4, v1
    v_mov_b32 v24, -1
    v_mov_b32 v25, -1
    v_mov_b32 v26, -1
    v_mov_b32 v27, -1
    buffer_store_dwordx4 v[24:27], v28, s[36:39], s53 offen sc1
    v_add_u32 v11, 32768, v8
    v_add_u32 v12, 32768, v9
    v_add_u32 v13, 32768, v10
    v_mfma_f32_16x16x32_bf16 v[32:35], v[96:99], v[80:83], v[32:35]
    ds_read_b128 v[120:123], v11 offset:0
    ds_read_b128 v[128:131], v11 offset:2048
    v_mfma_f32_16x16x32_bf16 v[40:43], v[104:107], v[80:83], v[40:43]
    ds_read_b64_tr_b16 v[136:137], v13 offset:0
    ds_read_b64_tr_b16 v[138:139], v13 offset:512
    v_mfma_f32_16x16x32_bf16 v[48:51], v[80:83], v[112:115], v[48:51]
    ds_read_b64_tr_b16 v[144:145], v13 offset:8192
    ds_read_b64_tr_b16 v[146:147], v13 offset:8704
    v_mfma_f32_16x16x32_bf16 v[64:67], v[20:23], v[96:99], v[64:67]
    ds_read_b64_tr_b16 v[152:153], v13 offset:16384
    ds_read_b64_tr_b16 v[154:155], v13 offset:16896
    v_mfma_f32_16x16x32_bf16 v[36:39], v[96:99], v[88:91], v[36:39]
    ds_read_b128 v[124:127], v12 offset:0
    ds_read_b128 v[132:135], v12 offset:2048
    v_mfma_f32_16x16x32_bf16 v[44:47], v[104:107], v[88:91], v[44:47]
    ds_read_b64_tr_b16 v[140:141], v13 offset:4096
    ds_read_b64_tr_b16 v[142:143], v13 offset:4608
    v_mfma_f32_16x16x32_bf16 v[68:71], v[20:23], v[104:107], v[68:71]
    ds_read_b64_tr_b16 v[148:149], v13 offset:12288
    ds_read_b64_tr_b16 v[150:151], v13 offset:12800
    v_mfma_f32_16x16x32_bf16 v[52:55], v[88:91], v[112:115], v[52:55]
    ds_read_b64_tr_b16 v[156:157], v13 offset:20480
    ds_read_b64_tr_b16 v[158:159], v13 offset:20992
    v_mfma_f32_16x16x32_bf16 v[32:35], v[100:103], v[84:87], v[32:35]
    v_mfma_f32_16x16x32_bf16 v[40:43], v[108:111], v[84:87], v[40:43]
    v_mfma_f32_16x16x32_bf16 v[72:75], v[20:23], v[112:115], v[72:75]
    v_mfma_f32_16x16x32_bf16 v[48:51], v[84:87], v[116:119], v[48:51]
    s_waitcnt vmcnt(5) lgkmcnt(0)
    v_mfma_f32_16x16x32_bf16 v[36:39], v[100:103], v[92:95], v[36:39]
    v_mfma_f32_16x16x32_bf16 v[56:59], v[92:95], v[92:95], v[56:59]
    v_mfma_f32_16x16x32_bf16 v[44:47], v[108:111], v[92:95], v[44:47]
    v_mfma_f32_16x16x32_bf16 v[52:55], v[92:95], v[116:119], v[52:55]
    v_mfma_f32_16x16x32_bf16 v[60:63], v[92:95], v[20:23], v[60:63]
    s_barrier
    v_add_u32 v11, 65536, v8
    v_add_u32 v12, 65536, v9
    v_add_u32 v13, 65536, v10
    v_mfma_f32_16x16x32_bf16 v[32:35], v[136:139], v[120:123], v[32:35]
    ds_read_b128 v[80:83], v11 offset:0
    ds_read_b128 v[88:91], v11 offset:2048
    v_mfma_f32_16x16x32_bf16 v[40:43], v[144:147], v[120:123], v[40:43]
    ds_read_b64_tr_b16 v[96:97], v13 offset:0
    ds_read_b64_tr_b16 v[98:99], v13 offset:512
    v_mfma_f32_16x16x32_bf16 v[48:51], v[120:123], v[152:155], v[48:51]
    ds_read_b64_tr_b16 v[104:105], v13 offset:8192
    ds_read_b64_tr_b16 v[106:107], v13 offset:8704
    v_mfma_f32_16x16x32_bf16 v[64:67], v[20:23], v[136:139], v[64:67]
    ds_read_b64_tr_b16 v[112:113], v13 offset:16384
    ds_read_b64_tr_b16 v[114:115], v13 offset:16896
    v_mfma_f32_16x16x32_bf16 v[36:39], v[136:139], v[128:131], v[36:39]
    ds_read_b128 v[84:87], v12 offset:0
    ds_read_b128 v[92:95], v12 offset:2048
    v_mfma_f32_16x16x32_bf16 v[44:47], v[144:147], v[128:131], v[44:47]
    ds_read_b64_tr_b16 v[100:101], v13 offset:4096
    ds_read_b64_tr_b16 v[102:103], v13 offset:4608
    v_mfma_f32_16x16x32_bf16 v[68:71], v[20:23], v[144:147], v[68:71]
    ds_read_b64_tr_b16 v[108:109], v13 offset:12288
    ds_read_b64_tr_b16 v[110:111], v13 offset:12800
    v_mfma_f32_16x16x32_bf16 v[52:55], v[128:131], v[152:155], v[52:55]
    ds_read_b64_tr_b16 v[116:117], v13 offset:20480
    ds_read_b64_tr_b16 v[118:119], v13 offset:20992
    v_mfma_f32_16x16x32_bf16 v[32:35], v[140:143], v[124:127], v[32:35]
    v_mfma_f32_16x16x32_bf16 v[40:43], v[148:151], v[124:127], v[40:43]
    v_mfma_f32_16x16x32_bf16 v[72:75], v[20:23], v[152:155], v[72:75]
    v_mfma_f32_16x16x32_bf16 v[48:51], v[124:127], v[156:159], v[48:51]
    s_waitcnt vmcnt(1) lgkmcnt(0)
    v_mfma_f32_16x16x32_bf16 v[36:39], v[140:143], v[132:135], v[36:39]
    v_mfma_f32_16x16x32_bf16 v[56:59], v[132:135], v[132:135], v[56:59]
    v_mfma_f32_16x16x32_bf16 v[44:47], v[148:151], v[132:135], v[44:47]
    v_mfma_f32_16x16x32_bf16 v[52:55], v[132:135], v[156:159], v[52:55]
    v_mfma_f32_16x16x32_bf16 v[60:63], v[132:135], v[20:23], v[60:63]
    s_barrier
    v_add_u32 v11, 98304, v8
    v_add_u32 v12, 98304, v9
    v_add_u32 v13, 98304, v10
    v_mfma_f32_16x16x32_bf16 v[32:35], v[96:99], v[80:83], v[32:35]
    ds_read_b128 v[120:123], v11 offset:0
    v_mfma_f32_16x16x32_bf16 v[40:43], v[104:107], v[80:83], v[40:43]
    ds_read_b128 v[128:131], v11 offset:2048
    v_mfma_f32_16x16x32_bf16 v[48:51], v[80:83], v[112:115], v[48:51]
    ds_read_b64_tr_b16 v[136:137], v13 offset:0
    ds_read_b64_tr_b16 v[138:139], v13 offset:512
    v_mfma_f32_16x16x32_bf16 v[64:67], v[20:23], v[96:99], v[64:67]
    ds_read_b64_tr_b16 v[144:145], v13 offset:8192
    v_mfma_f32_16x16x32_bf16 v[36:39], v[96:99], v[88:91], v[36:39]
    ds_read_b64_tr_b16 v[146:147], v13 offset:8704
    ds_read_b64_tr_b16 v[152:153], v13 offset:16384
    v_mfma_f32_16x16x32_bf16 v[44:47], v[104:107], v[88:91], v[44:47]
    ds_read_b64_tr_b16 v[154:155], v13 offset:16896
    v_mfma_f32_16x16x32_bf16 v[68:71], v[20:23], v[104:107], v[68:71]
    ds_read_b128 v[124:127], v12 offset:0
    ds_read_b128 v[132:135], v12 offset:2048
    v_mfma_f32_16x16x32_bf16 v[52:55], v[88:91], v[112:115], v[52:55]
    ds_read_b64_tr_b16 v[140:141], v13 offset:4096
    v_mfma_f32_16x16x32_bf16 v[32:35], v[100:103], v[84:87], v[32:35]
    ds_read_b64_tr_b16 v[142:143], v13 offset:4608
    ds_read_b64_tr_b16 v[148:149], v13 offset:12288
    v_mfma_f32_16x16x32_bf16 v[40:43], v[108:111], v[84:87], v[40:43]
    ds_read_b64_tr_b16 v[150:151], v13 offset:12800
    v_mfma_f32_16x16x32_bf16 v[72:75], v[20:23], v[112:115], v[72:75]
    ds_read_b64_tr_b16 v[156:157], v13 offset:20480
    ds_read_b64_tr_b16 v[158:159], v13 offset:20992
    v_mfma_f32_16x16x32_bf16 v[48:51], v[84:87], v[116:119], v[48:51]
    v_mfma_f32_16x16x32_bf16 v[36:39], v[100:103], v[92:95], v[36:39]
    v_mfma_f32_16x16x32_bf16 v[56:59], v[92:95], v[92:95], v[56:59]
    v_mfma_f32_16x16x32_bf16 v[44:47], v[108:111], v[92:95], v[44:47]
    v_mfma_f32_16x16x32_bf16 v[52:55], v[92:95], v[116:119], v[52:55]
    v_mfma_f32_16x16x32_bf16 v[60:63], v[92:95], v[20:23], v[60:63]
    s_waitcnt lgkmcnt(0)
    v_mfma_f32_16x16x32_bf16 v[32:35], v[136:139], v[120:123], v[32:35]
    v_mfma_f32_16x16x32_bf16 v[40:43], v[144:147], v[120:123], v[40:43]
    v_mfma_f32_16x16x32_bf16 v[48:51], v[120:123], v[152:155], v[48:51]
    v_mfma_f32_16x16x32_bf16 v[64:67], v[20:23], v[136:139], v[64:67]
    v_mfma_f32_16x16x32_bf16 v[36:39], v[136:139], v[128:131], v[36:39]
    v_mfma_f32_16x16x32_bf16 v[44:47], v[144:147], v[128:131], v[44:47]
    v_mfma_f32_16x16x32_bf16 v[68:71], v[20:23], v[144:147], v[68:71]
    v_mfma_f32_16x16x32_bf16 v[52:55], v[128:131], v[152:155], v[52:55]
    v_mfma_f32_16x16x32_bf16 v[32:35], v[140:143], v[124:127], v[32:35]
    v_mfma_f32_16x16x32_bf16 v[40:43], v[148:151], v[124:127], v[40:43]
    v_mfma_f32_16x16x32_bf16 v[72:75], v[20:23], v[152:155], v[72:75]
    v_mfma_f32_16x16x32_bf16 v[48:51], v[124:127], v[156:159], v[48:51]
    v_mfma_f32_16x16x32_bf16 v[36:39], v[140:143], v[132:135], v[36:39]
    v_mfma_f32_16x16x32_bf16 v[56:59], v[132:135], v[132:135], v[56:59]
    v_mfma_f32_16x16x32_bf16 v[44:47], v[148:151], v[132:135], v[44:47]
    v_mfma_f32_16x16x32_bf16 v[52:55], v[132:135], v[156:159], v[52:55]
    v_mfma_f32_16x16x32_bf16 v[60:63], v[132:135], v[20:23], v[60:63]
    s_mov_b32 s57, 0
L_ip_2:
    s_waitcnt vmcnt(0)
    v_readfirstlane_b32 s56, v30
    s_add_u32 s57, s57, 1
    s_cmp_lg_u32 s56, 0
    s_cbranch_scc1 L_id_3
    s_cmp_gt_u32 s57, 30000
    s_cbranch_scc1 L_id_3
    global_load_dword v30, v2, s[22:23] sc1
    s_branch L_ip_2
L_id_3:
    s_branch L_k1_cj
L_k1_c4:
    s_waitcnt vmcnt(4) lgkmcnt(0)
    s_barrier
    v_add_u32 v11, 0, v8
    v_add_u32 v12, 0, v9
    v_add_u32 v13, 0, v10
    ds_read_b128 v[80:83], v11 offset:0
    ds_read_b128 v[88:91], v11 offset:2048
    ds_read_b64_tr_b16 v[96:97], v13 offset:0
    ds_read_b64_tr_b16 v[98:99], v13 offset:512
    ds_read_b64_tr_b16 v[104:105], v13 offset:8192
    ds_read_b64_tr_b16 v[106:107], v13 offset:8704
    ds_read_b64_tr_b16 v[112:113], v13 offset:16384
    ds_read_b64_tr_b16 v[114:115], v13 offset:16896
    ds_read_b128 v[84:87], v12 offset:0
    ds_read_b128 v[92:95], v12 offset:2048
    ds_read_b64_tr_b16 v[100:101], v13 offset:4096
    ds_read_b64_tr_b16 v[102:103], v13 offset:4608
    ds_read_b64_tr_b16 v[108:109], v13 offset:12288
    ds_read_b64_tr_b16 v[110:111], v13 offset:12800
    ds_read_b64_tr_b16 v[116:117], v13 offset:20480
    ds_read_b64_tr_b16 v[118:119], v13 offset:20992
    s_add_u32 s50, s49, 2
    s_and_b32 s50, s50, 7
    s_lshl_b32 s51, s50, 7
    s_add_u32 s51, s51, s45
    s_add_u32 m0, s47, 65536
    s_mul_i32 s50, s50, 196608
    buffer_load_dwordx4 v18, s[28:31], s51 offen lds
    s_add_u32 s50, s50, s46
    s_add_u32 m0, s47, 73728
    s_add_u32 s44, s50, 0
    buffer_load_dwordx4 v19, s[32:35], s44 offen lds
    s_add_u32 m0, s47, 81920
    s_add_u32 s44, s50, 1024
    buffer_load_dwordx4 v19, s[32:35], s44 offen lds
    s_add_u32 m0, s47, 90112
    s_add_u32 s44, s50, 2048
    buffer_load_dwordx4 v19, s[32:35], s44 offen lds
    s_add_u32 s50, s49, 3
    s_and_b32 s50, s50, 7
    s_lshl_b32 s51, s50, 7
    s_add_u32 s51, s51, s45
    s_add_u32 m0, s47, 98304
    s_mul_i32 s50, s50, 196608
    buffer_load_dwordx4 v18, s[28:31], s51 offen lds
    s_add_u32 s50, s50, s46
    s_add_u32 m0, s47, 106496
    s_add_u32 s44, s50, 0
    buffer_load_dwordx4 v19, s[32:35], s44 offen lds
    s_add_u32 m0, s47, 114688
    s_add_u32 s44, s50, 1024
    buffer_load_dwordx4 v19, s[32:35], s44 offen lds
    s_add_u32 m0, s47, 122880
    s_add_u32 s44, s50, 2048
    buffer_load_dwordx4 v19, s[32:35], s44 offen lds
    s_waitcnt vmcnt(8) lgkmcnt(0)
    s_barrier
    v_add_u32 v11, 32768, v8
    v_add_u32 v12, 32768, v9
    v_add_u32 v13, 32768, v10
    v_mfma_f32_16x16x32_bf16 v[32:35], v[96:99], v[80:83], v[32:35]
    ds_read_b128 v[120:123], v11 offset:0
    ds_read_b128 v[128:131], v11 offset:2048
    v_mfma_f32_16x16x32_bf16 v[40:43], v[104:107], v[80:83], v[40:43]
    ds_read_b64_tr_b16 v[136:137], v13 offset:0
    ds_read_b64_tr_b16 v[138:139], v13 offset:512
    v_mfma_f32_16x16x32_bf16 v[48:51], v[80:83], v[112:115], v[48:51]
    ds_read_b64_tr_b16 v[144:145], v13 offset:8192
    ds_read_b64_tr_b16 v[146:147], v13 offset:8704
    v_mfma_f32_16x16x32_bf16 v[64:67], v[20:23], v[100:103], v[64:67]
    ds_read_b64_tr_b16 v[152:153], v13 offset:16384
    ds_read_b64_tr_b16 v[154:155], v13 offset:16896
    v_mfma_f32_16x16x32_bf16 v[36:39], v[96:99], v[88:91], v[36:39]
    ds_read_b128 v[124:127], v12 offset:0
    ds_read_b128 v[132:135], v12 offset:2048
    v_mfma_f32_16x16x32_bf16 v[44:47], v[104:107], v[88:91], v[44:47]
    ds_read_b64_tr_b16 v[140:141], v13 offset:4096
    ds_read_b64_tr_b16 v[142:143], v13 offset:4608
    v_mfma_f32_16x16x32_bf16 v[68:71], v[20:23], v[108:111], v[68:71]
    ds_read_b64_tr_b16 v[148:149], v13 offset:12288
    ds_read_b64_tr_b16 v[150:151], v13 offset:12800
    v_mfma_f32_16x16x32_bf16 v[52:55], v[88:91], v[112:115], v[52:55]
    ds_read_b64_tr_b16 v[156:157], v13 offset:20480
    ds_read_b64_tr_b16 v[158:159], v13 offset:20992
    v_mfma_f32_16x16x32_bf16 v[32:35], v[100:103], v[84:87], v[32:35]
    s_add_u32 s50, s49, 4
    s_and_b32 s50, s50, 7
    s_lshl_b32 s51, s50, 7
    s_add_u32 s51, s51, s45
    s_add_u32 m0, s47, 0
    s_mul_i32 s50, s50, 196608
    buffer_load_dwordx4 v18, s[28:31], s51 offen lds
    v_mfma_f32_16x16x32_bf16 v[40:43], v[108:111], v[84:87], v[40:43]
    s_add_u32 s50, s50, s46
    s_add_u32 m0, s47, 8192
    s_add_u32 s44, s50, 0
    buffer_load_dwordx4 v19, s[32:35], s44 offen lds
    v_mfma_f32_16x16x32_bf16 v[72:75], v[20:23], v[116:119], v[72:75]
    s_add_u32 m0, s47, 16384
    s_add_u32 s44, s50, 1024
    buffer_load_dwordx4 v19, s[32:35], s44 offen lds
    v_mfma_f32_16x16x32_bf16 v[48:51], v[84:87], v[116:119], v[48:51]
    s_add_u32 m0, s47, 24576
    s_add_u32 s44, s50, 2048
    buffer_load_dwordx4 v19, s[32:35], s44 offen lds
    s_waitcnt vmcnt(8) lgkmcnt(0)
    v_mfma_f32_16x16x32_bf16 v[36:39], v[100:103], v[92:95], v[36:39]
    v_mfma_f32_16x16x32_bf16 v[56:59], v[80:83], v[80:83], v[56:59]
    v_mfma_f32_16x16x32_bf16 v[44:47], v[108:111], v[92:95], v[44:47]
    v_mfma_f32_16x16x32_bf16 v[52:55], v[92:95], v[116:119], v[52:55]
    v_mfma_f32_16x16x32_bf16 v[60:63], v[80:83], v[20:23], v[60:63]
    s_barrier
    v_add_u32 v11, 65536, v8
    v_add_u32 v12, 65536, v9
    v_add_u32 v13, 65536, v10
    v_mfma_f32_16x16x32_bf16 v[32:35], v[136:139], v[120:123], v[32:35]
    ds_read_b128 v[80:83], v11 offset:0
    ds_read_b128 v[88:91], v11 offset:2048
    v_mfma_f32_16x16x32_bf16 v[40:43], v[144:147], v[120:123], v[40:43]
    ds_read_b64_tr_b16 v[96:97], v13 offset:0
    ds_read_b64_tr_b16 v[98:99], v13 offset:512
    v_mfma_f32_16x16x32_bf16 v[48:51], v[120:123], v[152:155], v[48:51]
    ds_read_b64_tr_b16 v[104:105], v13 offset:8192
    ds_read_b64_tr_b16 v[106:107], v13 offset:8704
    v_mfma_f32_16x16x32_bf16 v[64:67], v[20:23], v[140:143], v[64:67]
    ds_read_b64_tr_b16 v[112:113], v13 offset:16384
    ds_read_b64_tr_b16 v[114:115], v13 offset:16896
    v_mfma_f32_16x16x32_bf16 v[36:39], v[136:139], v[128:131], v[36:39]
    ds_read_b128 v[84:87], v12 offset:0
    ds_read_b128 v[92:95], v12 offset:2048
    v_mfma_f32_16x16x32_bf16 v[44:47], v[144:147], v[128:131], v[44:47]
    ds_read_b64_tr_b16 v[100:101], v13 offset:4096
    ds_read_b64_tr_b16 v[102:103], v13 offset:4608
    v_mfma_f32_16x16x32_bf16 v[68:71], v[20:23], v[148:151], v[68:71]
    ds_read_b64_tr_b16 v[108:109], v13 offset:12288
    ds_read_b64_tr_b16 v[110:111], v13 offset:12800
    v_mfma_f32_16x16x32_bf16 v[52:55], v[128:131], v[152:155], v[52:55]
    ds_read_b64_tr_b16 v[116:117], v13 offset:20480
    ds_read_b64_tr_b16 v[118:119], v13 offset:20992
    v_mfma_f32_16x16x32_bf16 v[32:35], v[140:143], v[124:127], v[32:35]
    s_add_u32 s50, s49, 5
    s_and_b32 s50, s50, 7
    s_lshl_b32 s51, s50, 7
    s_add_u32 s51, s51, s45
    s_add_u32 m0, s47, 32768
    s_mul_i32 s50, s50, 196608
    buffer_load_dwordx4 v18, s[28:31], s51 offen lds
    v_mfma_f32_16x16x32_bf16 v[40:43], v[148:151], v[124:127], v[40:43]
    s_add_u32 s50, s50, s46
    s_add_u32 m0, s47, 40960
    s_add_u32 s44, s50, 0
    buffer_load_dwordx4 v19, s[32:35], s44 offen lds
    v_mfma_f32_16x16x32_bf16 v[72:75], v[20:23], v[156:159], v[72:75]
    s_add_u32 m0, s47, 49152
    s_add_u32 s44, s50, 1024
    buffer_load_dwordx4 v19, s[32:35], s44 offen lds
    v_mfma_f32_16x16x32_bf16 v[48:51], v[124:127], v[156:159], v[48:51]
    s_add_u32 m0, s47, 57344
    s_add_u32 s44, s50, 2048
    buffer_load_dwordx4 v19, s[32:35], s44 offen lds
    s_waitcnt vmcnt(8) lgkmcnt(0)
    v_mfma_f32_16x16x32_bf16 v[36:39], v[140:143], v[132:135], v[36:39]
    v_mfma_f32_16x16x32_bf16 v[56:59], v[120:123], v[120:123], v[56:59]
    v_mfma_f32_16x16x32_bf16 v[44:47], v[148:151], v[132:135], v[44:47]
    v_mfma_f32_16x16x32_bf16 v[52:55], v[132:135], v[156:159], v[52:55]
    v_mfma_f32_16x16x32_bf16 v[60:63], v[120:123], v[20:23], v[60:63]
    s_barrier
    v_add_u32 v11, 98304, v8
    v_add_u32 v12, 98304, v9
    v_add_u32 v13, 98304, v10
    v_mfma_f32_16x16x32_bf16 v[32:35], v[96:99], v[80:83], v[32:35]
    ds_read_b128 v[120:123], v11 offset:0
    ds_read_b128 v[128:131], v11 offset:2048
    v_mfma_f32_16x16x32_bf16 v[40:43], v[104:107], v[80:83], v[40:43]
    ds_read_b64_tr_b16 v[136:137], v13 offset:0
    ds_read_b64_tr_b16 v[138:139], v13 offset:512
    v_mfma_f32_16x16x32_bf16 v[48:51], v[80:83], v[112:115], v[48:51]
    ds_read_b64_tr_b16 v[144:145], v13 offset:8192
    ds_read_b64_tr_b16 v[146:147], v13 offset:8704
    v_mfma_f32_16x16x32_bf16 v[64:67], v[20:23], v[100:103], v[64:67]
    ds_read_b64_tr_b16 v[152:153], v13 offset:16384
    ds_read_b64_tr_b16 v[154:155], v13 offset:16896
    v_mfma_f32_16x16x32_bf16 v[36:39], v[96:99], v[88:91], v[36:39]
    ds_read_b128 v[124:127], v12 offset:0
    ds_read_b128 v[132:135], v12 offset:2048
    v_mfma_f32_16x16x32_bf16 v[44:47], v[104:107], v[88:91], v[44:47]
    ds_read_b64_tr_b16 v[140:141], v13 offset:4096
    ds_read_b64_tr_b16 v[142:143], v13 offset:4608
    v_mfma_f32_16x16x32_bf16 v[68:71], v[20:23], v[108:111], v[68:71]
    ds_read_b64_tr_b16 v[148:149], v13 offset:12288
    ds_read_b64_tr_b16 v[150:151], v13 offset:12800
    v_mfma_f32_16x16x32_bf16 v[52:55], v[88:91], v[112:115], v[52:55]
    ds_read_b64_tr_b16 v[156:157], v13 offset:20480
    ds_read_b64_tr_b16 v[158:159], v13 offset:20992
    v_mfma_f32_16x16x32_bf16 v[32:35], v[100:103], v[84:87], v[32:35]
    s_add_u32 s50, s49, 6
    s_and_b32 s50, s50, 7
    s_lshl_b32 s51, s50, 7
    s_add_u32 s51, s51, s45
    s_add_u32 m0, s47, 65536
    s_mul_i32 s50, s50, 196608
    buffer_load_dwordx4 v18, s[28:31], s51 offen lds
    v_mfma_f32_16x16x32_bf16 v[40:43], v[108:111], v[84:87], v[40:43]
    s_add_u32 s50, s50, s46
    s_add_u32 m0, s47, 73728
    s_add_u32 s44, s50, 0
    buffer_load_dwordx4 v19, s[32:35], s44 offen lds
    v_mfma_f32_16x16x32_bf16 v[72:75], v[20:23], v[116:119], v[72:75]
    s_add_u32 m0, s47, 81920
    s_add_u32 s44, s50, 1024
    buffer_load_dwordx4 v19, s[32:35], s44 offen lds
    v_mfma_f32_16x16x32_bf16 v[48:51], v[84:87], v[116:119], v[48:51]
    s_add_u32 m0, s47, 90112
    s_add_u32 s44, s50, 2048
    buffer_load_dwordx4 v19, s[32:35], s44 offen lds
    s_waitcnt vmcnt(8) lgkmcnt(0)
    v_mfma_f32_16x16x32_bf16 v[36:39], v[100:103], v[92:95], v[36:39]
    v_mfma_f32_16x16x32_bf16 v[56:59], v[80:83], v[80:83], v[56:59]
    v_mfma_f32_16x16x32_bf16 v[44:47], v[108:111], v[92:95], v[44:47]
    v_mfma_f32_16x16x32_bf16 v[52:55], v[92:95], v[116:119], v[52:55]
    v_mfma_f32_16x16x32_bf16 v[60:63], v[80:83], v[20:23], v[60:63]
    s_barrier
    v_add_u32 v11, 0, v8
    v_add_u32 v12, 0, v9
    v_add_u32 v13, 0, v10
    v_mfma_f32_16x16x32_bf16 v[32:35], v[136:139], v[120:123], v[32:35]
    ds_read_b128 v[80:83], v11 offset:0
    ds_read_b128 v[88:91], v11 offset:2048
    v_mfma_f32_16x16x32_bf16 v[40:43], v[144:147], v[120:123], v[40:43]
    ds_read_b64_tr_b16 v[96:97], v13 offset:0
    ds_read_b64_tr_b16 v[98:99], v13 offset:512
    v_mfma_f32_16x16x32_bf16 v[48:51], v[120:123], v[152:155], v[48:51]
    ds_read_b64_tr_b16 v[104:105], v13 offset:8192
    ds_read_b64_tr_b16 v[106:107], v13 offset:8704
    v_mfma_f32_16x16x32_bf16 v[64:67], v[20:23], v[140:143], v[64:67]
    ds_read_b64_tr_b16 v[112:113], v13 offset:16384
    ds_read_b64_tr_b16 v[114:115], v13 offset:16896
    v_mfma_f32_16x16x32_bf16 v[36:39], v[136:139], v[128:131], v[36:39]
    ds_read_b128 v[84:87], v12 offset:0
    ds_read_b128 v[92:95], v12 offset:2048
    v_mfma_f32_16x16x32_bf16 v[44:47], v[144:147], v[128:131], v[44:47]
    ds_read_b64_tr_b16 v[100:101], v13 offset:4096
    ds_read_b64_tr_b16 v[102:103], v13 offset:4608
    v_mfma_f32_16x16x32_bf16 v[68:71], v[20:23], v[148:151], v[68:71]
    ds_read_b64_tr_b16 v[108:109], v13 offset:12288
    ds_read_b64_tr_b16 v[110:111], v13 offset:12800
    v_mfma_f32_16x16x32_bf16 v[52:55], v[128:131], v[152:155], v[52:55]
    ds_read_b64_tr_b16 v[116:117], v13 offset:20480
    ds_read_b64_tr_b16 v[118:119], v13 offset:20992
    v_mfma_f32_16x16x32_bf16 v[32:35], v[140:143], v[124:127], v[32:35]
    s_add_u32 s50, s49, 7
    s_and_b32 s50, s50, 7
    s_lshl_b32 s51, s50, 7
    s_add_u32 s51, s51, s45
    s_add_u32 m0, s47, 98304
    s_mul_i32 s50, s50, 196608
    buffer_load_dwordx4 v18, s[28:31], s51 offen lds
    v_mfma_f32_16x16x32_bf16 v[40:43], v[148:151], v[124:127], v[40:43]
    s_add_u32 s50, s50, s46
    s_add_u32 m0, s47, 106496
    s_add_u32 s44, s50, 0
    buffer_load_dwordx4 v19, s[32:35], s44 offen lds
    v_mfma_f32_16x16x32_bf16 v[72:75], v[20:23], v[156:159], v[72:75]
    s_add_u32 m0, s47, 114688
    s_add_u32 s44, s50, 1024
    buffer_load_dwordx4 v19, s[32:35], s44 offen lds
    v_mfma_f32_16x16x32_bf16 v[48:51], v[124:127], v[156:159], v[48:51]
    s_add_u32 m0, s47, 122880
    s_add_u32 s44, s50, 2048
    buffer_load_dwordx4 v19, s[32:35], s44 offen lds
    s_waitcnt vmcnt(8) lgkmcnt(0)
    v_mfma_f32_16x16x32_bf16 v[36:39], v[140:143], v[132:135], v[36:39]
    v_mfma_f32_16x16x32_bf16 v[56:59], v[120:123], v[120:123], v[56:59]
    v_mfma_f32_16x16x32_bf16 v[44:47], v[148:151], v[132:135], v[44:47]
    v_mfma_f32_16x16x32_bf16 v[52:55], v[132:135], v[156:159], v[52:55]
    v_mfma_f32_16x16x32_bf16 v[60:63], v[120:123], v[20:23], v[60:63]
    s_barrier
    s_and_b32 s53, s27, 1
    s_lshl_b32 s53, s53, 2
    s_and_b32 s54, s3, 3
    s_add_u32 s53, s53, s54
    s_lshr_b32 s54, s27, 1
    s_lshl_b32 s54, s54, 3
    s_lshr_b32 s55, s3, 2
    s_add_u32 s54, s54, s55
    s_lshl_b32 s53, s53, 18
    s_lshl_b32 s54, s54, 13
    s_add_u32 s53, s53, s54
    s_lshl_b32 s54, s26, 10
    s_add_u32 s53, s53, s54
    s_add_u32 s53, s53, 10747904
    v_lshlrev_b32 v28, 4, v1
    v_mov_b32 v24, -1
    v_mov_b32 v25, -1
    v_mov_b32 v26, -1
    v_mov_b32 v27, -1
    buffer_store_dwordx4 v[24:27], v28, s[36:39], s53 offen sc1
    v_add_u32 v11, 32768, v8
    v_add_u32 v12, 32768, v9
    v_add_u32 v13, 32768, v10
    v_mfma_f32_16x16x32_bf16 v[32:35], v[96:99], v[80:83], v[32:35]
    ds_read_b128 v[120:123], v11 offset:0
    ds_read_b128 v[128:131], v11 offset:2048
    v_mfma_f32_16x16x32_bf16 v[40:43], v[104:107], v[80:83], v[40:43]
    ds_read_b64_tr_b16 v[136:137], v13 offset:0
    ds_read_b64_tr_b16 v[138:139], v13 offset:512
    v_mfma_f32_16x16x32_bf16 v[48:51], v[80:83], v[112:115], v[48:51]
    ds_read_b64_tr_b16 v[144:145], v13 offset:8192
    ds_read_b64_tr_b16 v[146:147], v13 offset:8704
    v_mfma_f32_16x16x32_bf16 v[64:67], v[20:23], v[100:103], v[64:67]
    ds_read_b64_tr_b16 v[152:153], v13 offset:16384
    ds_read_b64_tr_b16 v[154:155], v13 offset:16896
    v_mfma_f32_16x16x32_bf16 v[36:39], v[96:99], v[88:91], v[36:39]
    ds_read_b128 v[124:127], v12 offset:0
    ds_read_b128 v[132:135], v12 offset:2048
    v_mfma_f32_16x16x32_bf16 v[44:47], v[104:107], v[88:91], v[44:47]
    ds_read_b64_tr_b16 v[140:141], v13 offset:4096
    ds_read_b64_tr_b16 v[142:143], v13 offset:4608
    v_mfma_f32_16x16x32_bf16 v[68:71], v[20:23], v[108:111], v[68:71]
    ds_read_b64_tr_b16 v[148:149], v13 offset:12288
    ds_read_b64_tr_b16 v[150:151], v13 offset:12800
    v_mfma_f32_16x16x32_bf16 v[52:55], v[88:91], v[112:115], v[52:55]
    ds_read_b64_tr_b16 v[156:157], v13 offset:20480
    ds_read_b64_tr_b16 v[158:159], v13 offset:20992
    v_mfma_f32_16x16x32_bf16 v[32:35], v[100:103], v[84:87], v[32:35]
    v_mfma_f32_16x16x32_bf16 v[40:43], v[108:111], v[84:87], v[40:43]
    v_mfma_f32_16x16x32_bf16 v[72:75], v[20:23], v[116:119], v[72:75]
    v_mfma_f32_16x16x32_bf16 v[48:51], v[84:87], v[116:119], v[48:51]
    s_waitcnt vmcnt(5) lgkmcnt(0)
    v_mfma_f32_16x16x32_bf16 v[36:39], v[100:103], v[92:95], v[36:39]
    v_mfma_f32_16x16x32_bf16 v[56:59], v[80:83], v[80:83], v[56:59]
    v_mfma_f32_16x16x32_bf16 v[44:47], v[108:111], v[92:95], v[44:47]
    v_mfma_f32_16x16x32_bf16 v[52:55], v[92:95], v[116:119], v[52:55]
    v_mfma_f32_16x16x32_bf16 v[60:63], v[80:83], v[20:23], v[60:63]
    s_barrier
    v_add_u32 v11, 65536, v8
    v_add_u32 v12, 65536, v9
    v_add_u32 v13, 65536, v10
    v_mfma_f32_16x16x32_bf16 v[32:35], v[136:139], v[120:123], v[32:35]
    ds_read_b128 v[80:83], v11 offset:0
    ds_read_b128 v[88:91], v11 offset:2048
    v_mfma_f32_16x16x32_bf16 v[40:43], v[144:147], v[120:123], v[40:43]
    ds_read_b64_tr_b16 v[96:97], v13 offset:0
    ds_read_b64_tr_b16 v[98:99], v13 offset:512
    v_mfma_f32_16x16x32_bf16 v[48:51], v[120:123], v[152:155], v[48:51]
    ds_read_b64_tr_b16 v[104:105], v13 offset:8192
    ds_read_b64_tr_b16 v[106:107], v13 offset:8704
    v_mfma_f32_16x16x32_bf16 v[64:67], v[20:23], v[140:143], v[64:67]
    ds_read_b64_tr_b16 v[112:113], v13 offset:16384
    ds_read_b64_tr_b16 v[114:115], v13 offset:16896
    v_mfma_f32_16x16x32_bf16 v[36:39], v[136:139], v[128:131], v[36:39]
    ds_read_b128 v[84:87], v12 offset:0
    ds_read_b128 v[92:95], v12 offset:2048
    v_mfma_f32_16x16x32_bf16 v[44:47], v[144:147], v[128:131], v[44:47]
    ds_read_b64_tr_b16 v[100:101], v13 offset:4096
    ds_read_b64_tr_b16 v[102:103], v13 offset:4608
    v_mfma_f32_16x16x32_bf16 v[68:71], v[20:23], v[148:151], v[68:71]
    ds_read_b64_tr_b16 v[108:109], v13 offset:12288
    ds_read_b64_tr_b16 v[110:111], v13 offset:12800
    v_mfma_f32_16x16x32_bf16 v[52:55], v[128:131], v[152:155], v[52:55]
    ds_read_b64_tr_b16 v[116:117], v13 offset:20480
    ds_read_b64_tr_b16 v[118:119], v13 offset:20992
    v_mfma_f32_16x16x32_bf16 v[32:35], v[140:143], v[124:127], v[32:35]
    v_mfma_f32_16x16x32_bf16 v[40:43], v[148:151], v[124:127], v[40:43]
    v_mfma_f32_16x16x32_bf16 v[72:75], v[20:23], v[156:159], v[72:75]
    v_mfma_f32_16x16x32_bf16 v[48:51], v[124:127], v[156:159], v[48:51]
    s_waitcnt vmcnt(1) lgkmcnt(0)
    v_mfma_f32_16x16x32_bf16 v[36:39], v[140:143], v[132:135], v[36:39]
    v_mfma_f32_16x16x32_bf16 v[56:59], v[120:123], v[120:123], v[56:59]
    v_mfma_f32_16x16x32_bf16 v[44:47], v[148:151], v[132:135], v[44:47]
    v_mfma_f32_16x16x32_bf16 v[52:55], v[132:135], v[156:159], v[52:55]
    v_mfma_f32_16x16x32_bf16 v[60:63], v[120:123], v[20:23], v[60:63]
    s_barrier
    v_add_u32 v11, 98304, v8
    v_add_u32 v12, 98304, v9
    v_add_u32 v13, 98304, v10
    v_mfma_f32_16x16x32_bf16 v[32:35], v[96:99], v[80:83], v[32:35]
    ds_read_b128 v[120:123], v11 offset:0
    v_mfma_f32_16x16x32_bf16 v[40:43], v[104:107], v[80:83], v[40:43]
    ds_read_b128 v[128:131], v11 offset:2048
    v_mfma_f32_16x16x32_bf16 v[48:51], v[80:83], v[112:115], v[48:51]
    ds_read_b64_tr_b16 v[136:137], v13 offset:0
    ds_read_b64_tr_b16 v[138:139], v13 offset:512
    v_mfma_f32_16x16x32_bf16 v[64:67], v[20:23], v[100:103], v[64:67]
    ds_read_b64_tr_b16 v[144:145], v13 offset:8192
    v_mfma_f32_16x16x32_bf16 v[36:39], v[96:99], v[88:91], v[36:39]
    ds_read_b64_tr_b16 v[146:147], v13 offset:8704
    ds_read_b64_tr_b16 v[152:153], v13 offset:16384
    v_mfma_f32_16x16x32_bf16 v[44:47], v[104:107], v[88:91], v[44:47]
    ds_read_b64_tr_b16 v[154:155], v13 offset:16896
    v_mfma_f32_16x16x32_bf16 v[68:71], v[20:23], v[108:111], v[68:71]
    ds_read_b128 v[124:127], v12 offset:0
    ds_read_b128 v[132:135], v12 offset:2048
    v_mfma_f32_16x16x32_bf16 v[52:55], v[88:91], v[112:115], v[52:55]
    ds_read_b64_tr_b16 v[140:141], v13 offset:4096
    v_mfma_f32_16x16x32_bf16 v[32:35], v[100:103], v[84:87], v[32:35]
    ds_read_b64_tr_b16 v[142:143], v13 offset:4608
    ds_read_b64_tr_b16 v[148:149], v13 offset:12288
    v_mfma_f32_16x16x32_bf16 v[40:43], v[108:111], v[84:87], v[40:43]
    ds_read_b64_tr_b16 v[150:151], v13 offset:12800
    v_mfma_f32_16x16x32_bf16 v[72:75], v[20:23], v[116:119], v[72:75]
    ds_read_b64_tr_b16 v[156:157], v13 offset:20480
    ds_read_b64_tr_b16 v[158:159], v13 offset:20992
    v_mfma_f32_16x16x32_bf16 v[48:51], v[84:87], v[116:119], v[48:51]
    v_mfma_f32_16x16x32_bf16 v[36:39], v[100:103], v[92:95], v[36:39]
    v_mfma_f32_16x16x32_bf16 v[56:59], v[80:83], v[80:83], v[56:59]
    v_mfma_f32_16x16x32_bf16 v[44:47], v[108:111], v[92:95], v[44:47]
    v_mfma_f32_16x16x32_bf16 v[52:55], v[92:95], v[116:119], v[52:55]
    v_mfma_f32_16x16x32_bf16 v[60:63], v[80:83], v[20:23], v[60:63]
    s_waitcnt lgkmcnt(0)
    v_mfma_f32_16x16x32_bf16 v[32:35], v[136:139], v[120:123], v[32:35]
    v_mfma_f32_16x16x32_bf16 v[40:43], v[144:147], v[120:123], v[40:43]
    v_mfma_f32_16x16x32_bf16 v[48:51], v[120:123], v[152:155], v[48:51]
    v_mfma_f32_16x16x32_bf16 v[64:67], v[20:23], v[140:143], v[64:67]
    v_mfma_f32_16x16x32_bf16 v[36:39], v[136:139], v[128:131], v[36:39]
    v_mfma_f32_16x16x32_bf16 v[44:47], v[144:147], v[128:131], v[44:47]
    v_mfma_f32_16x16x32_bf16 v[68:71], v[20:23], v[148:151], v[68:71]
    v_mfma_f32_16x16x32_bf16 v[52:55], v[128:131], v[152:155], v[52:55]
    v_mfma_f32_16x16x32_bf16 v[32:35], v[140:143], v[124:127], v[32:35]
    v_mfma_f32_16x16x32_bf16 v[40:43], v[148:151], v[124:127], v[40:43]
    v_mfma_f32_16x16x32_bf16 v[72:75], v[20:23], v[156:159], v[72:75]
    v_mfma_f32_16x16x32_bf16 v[48:51], v[124:127], v[156:159], v[48:51]
    v_mfma_f32_16x16x32_bf16 v[36:39], v[140:143], v[132:135], v[36:39]
    v_mfma_f32_16x16x32_bf16 v[56:59], v[120:123], v[120:123], v[56:59]
    v_mfma_f32_16x16x32_bf16 v[44:47], v[148:151], v[132:135], v[44:47]
    v_mfma_f32_16x16x32_bf16 v[52:55], v[132:135], v[156:159], v[52:55]
    v_mfma_f32_16x16x32_bf16 v[60:63], v[120:123], v[20:23], v[60:63]
    s_branch L_k1_cj
L_k1_c5:
    s_waitcnt vmcnt(4) lgkmcnt(0)
    s_barrier
    v_add_u32 v11, 0, v8
    v_add_u32 v12, 0, v9
    v_add_u32 v13, 0, v10
    ds_read_b128 v[80:83], v11 offset:0
    ds_read_b128 v[88:91], v11 offset:2048
    ds_read_b64_tr_b16 v[96:97], v13 offset:0
    ds_read_b64_tr_b16 v[98:99], v13 offset:512
    ds_read_b64_tr_b16 v[104:105], v13 offset:8192
    ds_read_b64_tr_b16 v[106:107], v13 offset:8704
    ds_read_b64_tr_b16 v[112:113], v13 offset:16384
    ds_read_b64_tr_b16 v[114:115], v13 offset:16896
    ds_read_b128 v[84:87], v12 offset:0
    ds_read_b128 v[92:95], v12 offset:2048
    ds_read_b64_tr_b16 v[100:101], v13 offset:4096
    ds_read_b64_tr_b16 v[102:103], v13 offset:4608
    ds_read_b64_tr_b16 v[108:109], v13 offset:12288
    ds_read_b64_tr_b16 v[110:111], v13 offset:12800
    ds_read_b64_tr_b16 v[116:117], v13 offset:20480
    ds_read_b64_tr_b16 v[118:119], v13 offset:20992
    s_add_u32 s50, s49, 2
    s_and_b32 s50, s50, 7
    s_lshl_b32 s51, s50, 7
    s_add_u32 s51, s51, s45
    s_add_u32 m0, s47, 65536
    s_mul_i32 s50, s50, 196608
    buffer_load_dwordx4 v18, s[28:31], s51 offen lds
    s_add_u32 s50, s50, s46
    s_add_u32 m0, s47, 73728
    s_add_u32 s44, s50, 0
    buffer_load_dwordx4 v19, s[32:35], s44 offen lds
    s_add_u32 m0, s47, 81920
    s_add_u32 s44, s50, 1024
    buffer_load_dwordx4 v19, s[32:35], s44 offen lds
    s_add_u32 m0, s47, 90112
    s_add_u32 s44, s50, 2048
    buffer_load_dwordx4 v19, s[32:35], s44 offen lds
    s_add_u32 s50, s49, 3
    s_and_b32 s50, s50, 7
    s_lshl_b32 s51, s50, 7
    s_add_u32 s51, s51, s45
    s_add_u32 m0, s47, 98304
    s_mul_i32 s50, s50, 196608
    buffer_load_dwordx4 v18, s[28:31], s51 offen lds
    s_add_u32 s50, s50, s46
    s_add_u32 m0, s47, 106496
    s_add_u32 s44, s50, 0
    buffer_load_dwordx4 v19, s[32:35], s44 offen lds
    s_add_u32 m0, s47, 114688
    s_add_u32 s44, s50, 1024
    buffer_load_dwordx4 v19, s[32:35], s44 offen lds
    s_add_u32 m0, s47, 122880
    s_add_u32 s44, s50, 2048
    buffer_load_dwordx4 v19, s[32:35], s44 offen lds
    s_waitcnt vmcnt(8) lgkmcnt(0)
    s_barrier
    v_add_u32 v11, 32768, v8
    v_add_u32 v12, 32768, v9
    v_add_u32 v13, 32768, v10
    v_mfma_f32_16x16x32_bf16 v[32:35], v[96:99], v[80:83], v[32:35]
    ds_read_b128 v[120:123], v11 offset:0
    ds_read_b128 v[128:131], v11 offset:2048
    v_mfma_f32_16x16x32_bf16 v[40:43], v[104:107], v[80:83], v[40:43]
    ds_read_b64_tr_b16 v[136:137], v13 offset:0
    ds_read_b64_tr_b16 v[138:139], v13 offset:512
    v_mfma_f32_16x16x32_bf16 v[48:51], v[80:83], v[112:115], v[48:51]
    ds_read_b64_tr_b16 v[144:145], v13 offset:8192
    ds_read_b64_tr_b16 v[146:147], v13 offset:8704
    v_mfma_f32_16x16x32_bf16 v[64:67], v[20:23], v[100:103], v[64:67]
    ds_read_b64_tr_b16 v[152:153], v13 offset:16384
    ds_read_b64_tr_b16 v[154:155], v13 offset:16896
    v_mfma_f32_16x16x32_bf16 v[36:39], v[96:99], v[88:91], v[36:39]
    ds_read_b128 v[124:127], v12 offset:0
    ds_read_b128 v[132:135], v12 offset:2048
    v_mfma_f32_16x16x32_bf16 v[44:47], v[104:107], v[88:91], v[44:47]
    ds_read_b64_tr_b16 v[140:141], v13 offset:4096
    ds_read_b64_tr_b16 v[142:143], v13 offset:4608
    v_mfma_f32_16x16x32_bf16 v[68:71], v[20:23], v[108:111], v[68:71]
    ds_read_b64_tr_b16 v[148:149], v13 offset:12288
    ds_read_b64_tr_b16 v[150:151], v13 offset:12800
    v_mfma_f32_16x16x32_bf16 v[52:55], v[88:91], v[112:115], v[52:55]
    ds_read_b64_tr_b16 v[156:157], v13 offset:20480
    ds_read_b64_tr_b16 v[158:159], v13 offset:20992
    v_mfma_f32_16x16x32_bf16 v[32:35], v[100:103], v[84:87], v[32:35]
    s_add_u32 s50, s49, 4
    s_and_b32 s50, s50, 7
    s_lshl_b32 s51, s50, 7
    s_add_u32 s51, s51, s45
    s_add_u32 m0, s47, 0
    s_mul_i32 s50, s50, 196608
    buffer_load_dwordx4 v18, s[28:31], s51 offen lds
    v_mfma_f32_16x16x32_bf16 v[40:43], v[108:111], v[84:87], v[40:43]
    s_add_u32 s50, s50, s46
    s_add_u32 m0, s47, 8192
    s_add_u32 s44, s50, 0
    buffer_load_dwordx4 v19, s[32:35], s44 offen lds
    v_mfma_f32_16x16x32_bf16 v[72:75], v[20:23], v[116:119], v[72:75]
    s_add_u32 m0, s47, 16384
    s_add_u32 s44, s50, 1024
    buffer_load_dwordx4 v19, s[32:35], s44 offen lds
    v_mfma_f32_16x16x32_bf16 v[48:51], v[84:87], v[116:119], v[48:51]
    s_add_u32 m0, s47, 24576
    s_add_u32 s44, s50, 2048
    buffer_load_dwordx4 v19, s[32:35], s44 offen lds
    s_waitcnt vmcnt(8) lgkmcnt(0)
    v_mfma_f32_16x16x32_bf16 v[36:39], v[100:103], v[92:95], v[36:39]
    v_mfma_f32_16x16x32_bf16 v[56:59], v[84:87], v[84:87], v[56:59]
    v_mfma_f32_16x16x32_bf16 v[44:47], v[108:111], v[92:95], v[44:47]
    v_mfma_f32_16x16x32_bf16 v[52:55], v[92:95], v[116:119], v[52:55]
    v_mfma_f32_16x16x32_bf16 v[60:63], v[84:87], v[20:23], v[60:63]
    s_barrier
    v_add_u32 v11, 65536, v8
    v_add_u32 v12, 65536, v9
    v_add_u32 v13, 65536, v10
    v_mfma_f32_16x16x32_bf16 v[32:35], v[136:139], v[120:123], v[32:35]
    ds_read_b128 v[80:83], v11 offset:0
    ds_read_b128 v[88:91], v11 offset:2048
    v_mfma_f32_16x16x32_bf16 v[40:43], v[144:147], v[120:123], v[40:43]
    ds_read_b64_tr_b16 v[96:97], v13 offset:0
    ds_read_b64_tr_b16 v[98:99], v13 offset:512
    v_mfma_f32_16x16x32_bf16 v[48:51], v[120:123], v[152:155], v[48:51]
    ds_read_b64_tr_b16 v[104:105], v13 offset:8192
    ds_read_b64_tr_b16 v[106:107], v13 offset:8704
    v_mfma_f32_16x16x32_bf16 v[64:67], v[20:23], v[140:143], v[64:67]
    ds_read_b64_tr_b16 v[112:113], v13 offset:16384
    ds_read_b64_tr_b16 v[114:115], v13 offset:16896
    v_mfma_f32_16x16x32_bf16 v[36:39], v[136:139], v[128:131], v[36:39]
    ds_read_b128 v[84:87], v12 offset:0
    ds_read_b128 v[92:95], v12 offset:2048
    v_mfma_f32_16x16x32_bf16 v[44:47], v[144:147], v[128:131], v[44:47]
    ds_read_b64_tr_b16 v[100:101], v13 offset:4096
    ds_read_b64_tr_b16 v[102:103], v13 offset:4608
    v_mfma_f32_16x16x32_bf16 v[68:71], v[20:23], v[148:151], v[68:71]
    ds_read_b64_tr_b16 v[108:109], v13 offset:12288
    ds_read_b64_tr_b16 v[110:111], v13 offset:12800
    v_mfma_f32_16x16x32_bf16 v[52:55], v[128:131], v[152:155], v[52:55]
    ds_read_b64_tr_b16 v[116:117], v13 offset:20480
    ds_read_b64_tr_b16 v[118:119], v13 offset:20992
    v_mfma_f32_16x16x32_bf16 v[32:35], v[140:143], v[124:127], v[32:35]
    s_add_u32 s50, s49, 5
    s_and_b32 s50, s50, 7
    s_lshl_b32 s51, s50, 7
    s_add_u32 s51, s51, s45
    s_add_u32 m0, s47, 32768
    s_mul_i32 s50, s50, 196608
    buffer_load_dwordx4 v18, s[28:31], s51 offen lds
    v_mfma_f32_16x16x32_bf16 v[40:43], v[148:151], v[124:127], v[40:43]
    s_add_u32 s50, s50, s46
    s_add_u32 m0, s47, 40960
    s_add_u32 s44, s50, 0
    buffer_load_dwordx4 v19, s[32:35], s44 offen lds
    v_mfma_f32_16x16x32_bf16 v[72:75], v[20:23], v[156:159], v[72:75]
    s_add_u32 m0, s47, 49152
    s_add_u32 s44, s50, 1024
    buffer_load_dwordx4 v19, s[32:35], s44 offen lds
    v_mfma_f32_16x16x32_bf16 v[48:51], v[124:127], v[156:159], v[48:51]
    s_add_u32 m0, s47, 57344
    s_add_u32 s44, s50, 2048
    buffer_load_dwordx4 v19, s[32:35], s44 offen lds
    s_waitcnt vmcnt(8) lgkmcnt(0)
    v_mfma_f32_16x16x32_bf16 v[36:39], v[140:143], v[132:135], v[36:39]
    v_mfma_f32_16x16x32_bf16 v[56:59], v[124:127], v[124:127], v[56:59]
    v_mfma_f32_16x16x32_bf16 v[44:47], v[148:151], v[132:135], v[44:47]
    v_mfma_f32_16x16x32_bf16 v[52:55], v[132:135], v[156:159], v[52:55]
    v_mfma_f32_16x16x32_bf16 v[60:63], v[124:127], v[20:23], v[60:63]
    s_barrier
    v_add_u32 v11, 98304, v8
    v_add_u32 v12, 98304, v9
    v_add_u32 v13, 98304, v10
    v_mfma_f32_16x16x32_bf16 v[32:35], v[96:99], v[80:83], v[32:35]
    ds_read_b128 v[120:123], v11 offset:0
    ds_read_b128 v[128:131], v11 offset:2048
    v_mfma_f32_16x16x32_bf16 v[40:43], v[104:107], v[80:83], v[40:43]
    ds_read_b64_tr_b16 v[136:137], v13 offset:0
    ds_read_b64_tr_b16 v[138:139], v13 offset:512
    v_mfma_f32_16x16x32_bf16 v[48:51], v[80:83], v[112:115], v[48:51]
    ds_read_b64_tr_b16 v[144:145], v13 offset:8192
    ds_read_b64_tr_b16 v[146:147], v13 offset:8704
    v_mfma_f32_16x16x32_bf16 v[64:67], v[20:23], v[100:103], v[64:67]
    ds_read_b64_tr_b16 v[152:153], v13 offset:16384
    ds_read_b64_tr_b16 v[154:155], v13 offset:16896
    v_mfma_f32_16x16x32_bf16 v[36:39], v[96:99], v[88:91], v[36:39]
    ds_read_b128 v[124:127], v12 offset:0
    ds_read_b128 v[132:135], v12 offset:2048
    v_mfma_f32_16x16x32_bf16 v[44:47], v[104:107], v[88:91], v[44:47]
    ds_read_b64_tr_b16 v[140:141], v13 offset:4096
    ds_read_b64_tr_b16 v[142:143], v13 offset:4608
    v_mfma_f32_16x16x32_bf16 v[68:71], v[20:23], v[108:111], v[68:71]
    ds_read_b64_tr_b16 v[148:149], v13 offset:12288
    ds_read_b64_tr_b16 v[150:151], v13 offset:12800
    v_mfma_f32_16x16x32_bf16 v[52:55], v[88:91], v[112:115], v[52:55]
    ds_read_b64_tr_b16 v[156:157], v13 offset:20480
    ds_read_b64_tr_b16 v[158:159], v13 offset:20992
    v_mfma_f32_16x16x32_bf16 v[32:35], v[100:103], v[84:87], v[32:35]
    s_add_u32 s50, s49, 6
    s_and_b32 s50, s50, 7
    s_lshl_b32 s51, s50, 7
    s_add_u32 s51, s51, s45
    s_add_u32 m0, s47, 65536
    s_mul_i32 s50, s50, 196608
    buffer_load_dwordx4 v18, s[28:31], s51 offen lds
    v_mfma_f32_16x16x32_bf16 v[40:43], v[108:111], v[84:87], v[40:43]
    s_add_u32 s50, s50, s46
    s_add_u32 m0, s47, 73728
    s_add_u32 s44, s50, 0
    buffer_load_dwordx4 v19, s[32:35], s44 offen lds
    v_mfma_f32_16x16x32_bf16 v[72:75], v[20:23], v[116:119], v[72:75]
    s_add_u32 m0, s47, 81920
    s_add_u32 s44, s50, 1024
    buffer_load_dwordx4 v19, s[32:35], s44 offen lds
    v_mfma_f32_16x16x32_bf16 v[48:51], v[84:87], v[116:119], v[48:51]
    s_add_u32 m0, s47, 90112
    s_add_u32 s44, s50, 2048
    buffer_load_dwordx4 v19, s[32:35], s44 offen lds
    s_waitcnt vmcnt(8) lgkmcnt(0)
    v_mfma_f32_16x16x32_bf16 v[36:39], v[100:103], v[92:95], v[36:39]
    v_mfma_f32_16x16x32_bf16 v[56:59], v[84:87], v[84:87], v[56:59]
    v_mfma_f32_16x16x32_bf16 v[44:47], v[108:111], v[92:95], v[44:47]
    v_mfma_f32_16x16x32_bf16 v[52:55], v[92:95], v[116:119], v[52:55]
    v_mfma_f32_16x16x32_bf16 v[60:63], v[84:87], v[20:23], v[60:63]
    s_barrier
    v_add_u32 v11, 0, v8
    v_add_u32 v12, 0, v9
    v_add_u32 v13, 0, v10
    v_mfma_f32_16x16x32_bf16 v[32:35], v[136:139], v[120:123], v[32:35]
    ds_read_b128 v[80:83], v11 offset:0
    ds_read_b128 v[88:91], v11 offset:2048
    v_mfma_f32_16x16x32_bf16 v[40:43], v[144:147], v[120:123], v[40:43]
    ds_read_b64_tr_b16 v[96:97], v13 offset:0
    ds_read_b64_tr_b16 v[98:99], v13 offset:512
    v_mfma_f32_16x16x32_bf16 v[48:51], v[120:123], v[152:155], v[48:51]
    ds_read_b64_tr_b16 v[104:105], v13 offset:8192
    ds_read_b64_tr_b16 v[106:107], v13 offset:8704
    v_mfma_f32_16x16x32_bf16 v[64:67], v[20:23], v[140:143], v[64:67]
    ds_read_b64_tr_b16 v[112:113], v13 offset:16384
    ds_read_b64_tr_b16 v[114:115], v13 offset:16896
    v_mfma_f32_16x16x32_bf16 v[36:39], v[136:139], v[128:131], v[36:39]
    ds_read_b128 v[84:87], v12 offset:0
    ds_read_b128 v[92:95], v12 offset:2048
    v_mfma_f32_16x16x32_bf16 v[44:47], v[144:147], v[128:131], v[44:47]
    ds_read_b64_tr_b16 v[100:101], v13 offset:4096
    ds_read_b64_tr_b16 v[102:103], v13 offset:4608
    v_mfma_f32_16x16x32_bf16 v[68:71], v[20:23], v[148:151], v[68:71]
    ds_read_b64_tr_b16 v[108:109], v13 offset:12288
    ds_read_b64_tr_b16 v[110:111], v13 offset:12800
    v_mfma_f32_16x16x32_bf16 v[52:55], v[128:131], v[152:155], v[52:55]
    ds_read_b64_tr_b16 v[116:117], v13 offset:20480
    ds_read_b64_tr_b16 v[118:119], v13 offset:20992
    v_mfma_f32_16x16x32_bf16 v[32:35], v[140:143], v[124:127], v[32:35]
    s_add_u32 s50, s49, 7
    s_and_b32 s50, s50, 7
    s_lshl_b32 s51, s50, 7
    s_add_u32 s51, s51, s45
    s_add_u32 m0, s47, 98304
    s_mul_i32 s50, s50, 196608
    buffer_load_dwordx4 v18, s[28:31], s51 offen lds
    v_mfma_f32_16x16x32_bf16 v[40:43], v[148:151], v[124:127], v[40:43]
    s_add_u32 s50, s50, s46
    s_add_u32 m0, s47, 106496
    s_add_u32 s44, s50, 0
    buffer_load_dwordx4 v19, s[32:35], s44 offen lds
    v_mfma_f32_16x16x32_bf16 v[72:75], v[20:23], v[156:159], v[72:75]
    s_add_u32 m0, s47, 114688
    s_add_u32 s44, s50, 1024
    buffer_load_dwordx4 v19, s[32:35], s44 offen lds
    v_mfma_f32_16x16x32_bf16 v[48:51], v[124:127], v[156:159], v[48:51]
    s_add_u32 m0, s47, 122880
    s_add_u32 s44, s50, 2048
    buffer_load_dwordx4 v19, s[32:35], s44 offen lds
    s_waitcnt vmcnt(8) lgkmcnt(0)
    v_mfma_f32_16x16x32_bf16 v[36:39], v[140:143], v[132:135], v[36:39]
    v_mfma_f32_16x16x32_bf16 v[56:59], v[124:127], v[124:127], v[56:59]
    v_mfma_f32_16x16x32_bf16 v[44:47], v[148:151], v[132:135], v[44:47]
    v_mfma_f32_16x16x32_bf16 v[52:55], v[132:135], v[156:159], v[52:55]
    v_mfma_f32_16x16x32_bf16 v[60:63], v[124:127], v[20:23], v[60:63]
    s_barrier
    s_and_b32 s53, s27, 1
    s_lshl_b32 s53, s53, 2
    s_and_b32 s54, s3, 3
    s_add_u32 s53, s53, s54
    s_lshr_b32 s54, s27, 1
    s_lshl_b32 s54, s54, 3
    s_lshr_b32 s55, s3, 2
    s_add_u32 s54, s54, s55
    s_lshl_b32 s53, s53, 18
    s_lshl_b32 s54, s54, 13
    s_add_u32 s53, s53, s54
    s_lshl_b32 s54, s26, 10
    s_add_u32 s53, s53, s54
    s_add_u32 s53, s53, 10747904
    v_lshlrev_b32 v28, 4, v1
    v_mov_b32 v24, -1
    v_mov_b32 v25, -1
    v_mov_b32 v26, -1
    v_mov_b32 v27, -1
    buffer_store_dwordx4 v[24:27], v28, s[36:39], s53 offen sc1
    v_add_u32 v11, 32768, v8
    v_add_u32 v12, 32768, v9
    v_add_u32 v13, 32768, v10
    v_mfma_f32_16x16x32_bf16 v[32:35], v[96:99], v[80:83], v[32:35]
    ds_read_b128 v[120:123], v11 offset:0
    ds_read_b128 v[128:131], v11 offset:2048
    v_mfma_f32_16x16x32_bf16 v[40:43], v[104:107], v[80:83], v[40:43]
    ds_read_b64_tr_b16 v[136:137], v13 offset:0
    ds_read_b64_tr_b16 v[138:139], v13 offset:512
    v_mfma_f32_16x16x32_bf16 v[48:51], v[80:83], v[112:115], v[48:51]
    ds_read_b64_tr_b16 v[144:145], v13 offset:8192
    ds_read_b64_tr_b16 v[146:147], v13 offset:8704
    v_mfma_f32_16x16x32_bf16 v[64:67], v[20:23], v[100:103], v[64:67]
    ds_read_b64_tr_b16 v[152:153], v13 offset:16384
    ds_read_b64_tr_b16 v[154:155], v13 offset:16896
    v_mfma_f32_16x16x32_bf16 v[36:39], v[96:99], v[88:91], v[36:39]
    ds_read_b128 v[124:127], v12 offset:0
    ds_read_b128 v[132:135], v12 offset:2048
    v_mfma_f32_16x16x32_bf16 v[44:47], v[104:107], v[88:91], v[44:47]
    ds_read_b64_tr_b16 v[140:141], v13 offset:4096
    ds_read_b64_tr_b16 v[142:143], v13 offset:4608
    v_mfma_f32_16x16x32_bf16 v[68:71], v[20:23], v[108:111], v[68:71]
    ds_read_b64_tr_b16 v[148:149], v13 offset:12288
    ds_read_b64_tr_b16 v[150:151], v13 offset:12800
    v_mfma_f32_16x16x32_bf16 v[52:55], v[88:91], v[112:115], v[52:55]
    ds_read_b64_tr_b16 v[156:157], v13 offset:20480
    ds_read_b64_tr_b16 v[158:159], v13 offset:20992
    v_mfma_f32_16x16x32_bf16 v[32:35], v[100:103], v[84:87], v[32:35]
    v_mfma_f32_16x16x32_bf16 v[40:43], v[108:111], v[84:87], v[40:43]
    v_mfma_f32_16x16x32_bf16 v[72:75], v[20:23], v[116:119], v[72:75]
    v_mfma_f32_16x16x32_bf16 v[48:51], v[84:87], v[116:119], v[48:51]
    s_waitcnt vmcnt(5) lgkmcnt(0)
    v_mfma_f32_16x16x32_bf16 v[36:39], v[100:103], v[92:95], v[36:39]
    v_mfma_f32_16x16x32_bf16 v[56:59], v[84:87], v[84:87], v[56:59]
    v_mfma_f32_16x16x32_bf16 v[44:47], v[108:111], v[92:95], v[44:47]
    v_mfma_f32_16x16x32_bf16 v[52:55], v[92:95], v[116:119], v[52:55]
    v_mfma_f32_16x16x32_bf16 v[60:63], v[84:87], v[20:23], v[60:63]
    s_barrier
    v_add_u32 v11, 65536, v8
    v_add_u32 v12, 65536, v9
    v_add_u32 v13, 65536, v10
    v_mfma_f32_16x16x32_bf16 v[32:35], v[136:139], v[120:123], v[32:35]
    ds_read_b128 v[80:83], v11 offset:0
    ds_read_b128 v[88:91], v11 offset:2048
    v_mfma_f32_16x16x32_bf16 v[40:43], v[144:147], v[120:123], v[40:43]
    ds_read_b64_tr_b16 v[96:97], v13 offset:0
    ds_read_b64_tr_b16 v[98:99], v13 offset:512
    v_mfma_f32_16x16x32_bf16 v[48:51], v[120:123], v[152:155], v[48:51]
    ds_read_b64_tr_b16 v[104:105], v13 offset:8192
    ds_read_b64_tr_b16 v[106:107], v13 offset:8704
    v_mfma_f32_16x16x32_bf16 v[64:67], v[20:23], v[140:143], v[64:67]
    ds_read_b64_tr_b16 v[112:113], v13 offset:16384
    ds_read_b64_tr_b16 v[114:115], v13 offset:16896
    v_mfma_f32_16x16x32_bf16 v[36:39], v[136:139], v[128:131], v[36:39]
    ds_read_b128 v[84:87], v12 offset:0
    ds_read_b128 v[92:95], v12 offset:2048
    v_mfma_f32_16x16x32_bf16 v[44:47], v[144:147], v[128:131], v[44:47]
    ds_read_b64_tr_b16 v[100:101], v13 offset:4096
    ds_read_b64_tr_b16 v[102:103], v13 offset:4608
    v_mfma_f32_16x16x32_bf16 v[68:71], v[20:23], v[148:151], v[68:71]
    ds_read_b64_tr_b16 v[108:109], v13 offset:12288
    ds_read_b64_tr_b16 v[110:111], v13 offset:12800
    v_mfma_f32_16x16x32_bf16 v[52:55], v[128:131], v[152:155], v[52:55]
    ds_read_b64_tr_b16 v[116:117], v13 offset:20480
    ds_read_b64_tr_b16 v[118:119], v13 offset:20992
    v_mfma_f32_16x16x32_bf16 v[32:35], v[140:143], v[124:127], v[32:35]
    v_mfma_f32_16x16x32_bf16 v[40:43], v[148:151], v[124:127], v[40:43]
    v_mfma_f32_16x16x32_bf16 v[72:75], v[20:23], v[156:159], v[72:75]
    v_mfma_f32_16x16x32_bf16 v[48:51], v[124:127], v[156:159], v[48:51]
    s_waitcnt vmcnt(1) lgkmcnt(0)
    v_mfma_f32_16x16x32_bf16 v[36:39], v[140:143], v[132:135], v[36:39]
    v_mfma_f32_16x16x32_bf16 v[56:59], v[124:127], v[124:127], v[56:59]
    v_mfma_f32_16x16x32_bf16 v[44:47], v[148:151], v[132:135], v[44:47]
    v_mfma_f32_16x16x32_bf16 v[52:55], v[132:135], v[156:159], v[52:55]
    v_mfma_f32_16x16x32_bf16 v[60:63], v[124:127], v[20:23], v[60:63]
    s_barrier
    v_add_u32 v11, 98304, v8
    v_add_u32 v12, 98304, v9
    v_add_u32 v13, 98304, v10
    v_mfma_f32_16x16x32_bf16 v[32:35], v[96:99], v[80:83], v[32:35]
    ds_read_b128 v[120:123], v11 offset:0
    v_mfma_f32_16x16x32_bf16 v[40:43], v[104:107], v[80:83], v[40:43]
    ds_read_b128 v[128:131], v11 offset:2048
    v_mfma_f32_16x16x32_bf16 v[48:51], v[80:83], v[112:115], v[48:51]
    ds_read_b64_tr_b16 v[136:137], v13 offset:0
    ds_read_b64_tr_b16 v[138:139], v13 offset:512
    v_mfma_f32_16x16x32_bf16 v[64:67], v[20:23], v[100:103], v[64:67]
    ds_read_b64_tr_b16 v[144:145], v13 offset:8192
    v_mfma_f32_16x16x32_bf16 v[36:39], v[96:99], v[88:91], v[36:39]
    ds_read_b64_tr_b16 v[146:147], v13 offset:8704
    ds_read_b64_tr_b16 v[152:153], v13 offset:16384
    v_mfma_f32_16x16x32_bf16 v[44:47], v[104:107], v[88:91], v[44:47]
    ds_read_b64_tr_b16 v[154:155], v13 offset:16896
    v_mfma_f32_16x16x32_bf16 v[68:71], v[20:23], v[108:111], v[68:71]
    ds_read_b128 v[124:127], v12 offset:0
    ds_read_b128 v[132:135], v12 offset:2048
    v_mfma_f32_16x16x32_bf16 v[52:55], v[88:91], v[112:115], v[52:55]
    ds_read_b64_tr_b16 v[140:141], v13 offset:4096
    v_mfma_f32_16x16x32_bf16 v[32:35], v[100:103], v[84:87], v[32:35]
    ds_read_b64_tr_b16 v[142:143], v13 offset:4608
    ds_read_b64_tr_b16 v[148:149], v13 offset:12288
    v_mfma_f32_16x16x32_bf16 v[40:43], v[108:111], v[84:87], v[40:43]
    ds_read_b64_tr_b16 v[150:151], v13 offset:12800
    v_mfma_f32_16x16x32_bf16 v[72:75], v[20:23], v[116:119], v[72:75]
    ds_read_b64_tr_b16 v[156:157], v13 offset:20480
    ds_read_b64_tr_b16 v[158:159], v13 offset:20992
    v_mfma_f32_16x16x32_bf16 v[48:51], v[84:87], v[116:119], v[48:51]
    v_mfma_f32_16x16x32_bf16 v[36:39], v[100:103], v[92:95], v[36:39]
    v_mfma_f32_16x16x32_bf16 v[56:59], v[84:87], v[84:87], v[56:59]
    v_mfma_f32_16x16x32_bf16 v[44:47], v[108:111], v[92:95], v[44:47]
    v_mfma_f32_16x16x32_bf16 v[52:55], v[92:95], v[116:119], v[52:55]
    v_mfma_f32_16x16x32_bf16 v[60:63], v[84:87], v[20:23], v[60:63]
    s_waitcnt lgkmcnt(0)
    v_mfma_f32_16x16x32_bf16 v[32:35], v[136:139], v[120:123], v[32:35]
    v_mfma_f32_16x16x32_bf16 v[40:43], v[144:147], v[120:123], v[40:43]
    v_mfma_f32_16x16x32_bf16 v[48:51], v[120:123], v[152:155], v[48:51]
    v_mfma_f32_16x16x32_bf16 v[64:67], v[20:23], v[140:143], v[64:67]
    v_mfma_f32_16x16x32_bf16 v[36:39], v[136:139], v[128:131], v[36:39]
    v_mfma_f32_16x16x32_bf16 v[44:47], v[144:147], v[128:131], v[44:47]
    v_mfma_f32_16x16x32_bf16 v[68:71], v[20:23], v[148:151], v[68:71]
    v_mfma_f32_16x16x32_bf16 v[52:55], v[128:131], v[152:155], v[52:55]
    v_mfma_f32_16x16x32_bf16 v[32:35], v[140:143], v[124:127], v[32:35]
    v_mfma_f32_16x16x32_bf16 v[40:43], v[148:151], v[124:127], v[40:43]
    v_mfma_f32_16x16x32_bf16 v[72:75], v[20:23], v[156:159], v[72:75]
    v_mfma_f32_16x16x32_bf16 v[48:51], v[124:127], v[156:159], v[48:51]
    v_mfma_f32_16x16x32_bf16 v[36:39], v[140:143], v[132:135], v[36:39]
    v_mfma_f32_16x16x32_bf16 v[56:59], v[124:127], v[124:127], v[56:59]
    v_mfma_f32_16x16x32_bf16 v[44:47], v[148:151], v[132:135], v[44:47]
    v_mfma_f32_16x16x32_bf16 v[52:55], v[132:135], v[156:159], v[52:55]
    v_mfma_f32_16x16x32_bf16 v[60:63], v[124:127], v[20:23], v[60:63]
    s_branch L_k1_cj
L_k1_c6:
    s_waitcnt vmcnt(4) lgkmcnt(0)
    s_barrier
    v_add_u32 v11, 0, v8
    v_add_u32 v12, 0, v9
    v_add_u32 v13, 0, v10
    ds_read_b128 v[80:83], v11 offset:0
    ds_read_b128 v[88:91], v11 offset:2048
    ds_read_b64_tr_b16 v[96:97], v13 offset:0
    ds_read_b64_tr_b16 v[98:99], v13 offset:512
    ds_read_b64_tr_b16 v[104:105], v13 offset:8192
    ds_read_b64_tr_b16 v[106:107], v13 offset:8704
    ds_read_b64_tr_b16 v[112:113], v13 offset:16384
    ds_read_b64_tr_b16 v[114:115], v13 offset:16896
    ds_read_b128 v[84:87], v12 offset:0
    ds_read_b128 v[92:95], v12 offset:2048
    ds_read_b64_tr_b16 v[100:101], v13 offset:4096
    ds_read_b64_tr_b16 v[102:103], v13 offset:4608
    ds_read_b64_tr_b16 v[108:109], v13 offset:12288
    ds_read_b64_tr_b16 v[110:111], v13 offset:12800
    ds_read_b64_tr_b16 v[116:117], v13 offset:20480
    ds_read_b64_tr_b16 v[118:119], v13 offset:20992
    s_add_u32 s50, s49, 2
    s_and_b32 s50, s50, 7
    s_lshl_b32 s51, s50, 7
    s_add_u32 s51, s51, s45
    s_add_u32 m0, s47, 65536
    s_mul_i32 s50, s50, 196608
    buffer_load_dwordx4 v18, s[28:31], s51 offen lds
    s_add_u32 s50, s50, s46
    s_add_u32 m0, s47, 73728
    s_add_u32 s44, s50, 0
    buffer_load_dwordx4 v19, s[32:35], s44 offen lds
    s_add_u32 m0, s47, 81920
    s_add_u32 s44, s50, 1024
    buffer_load_dwordx4 v19, s[32:35], s44 offen lds
    s_add_u32 m0, s47, 90112
    s_add_u32 s44, s50, 2048
    buffer_load_dwordx4 v19, s[32:35], s44 offen lds
    s_add_u32 s50, s49, 3
    s_and_b32 s50, s50, 7
    s_lshl_b32 s51, s50, 7
    s_add_u32 s51, s51, s45
    s_add_u32 m0, s47, 98304
    s_mul_i32 s50, s50, 196608
    buffer_load_dwordx4 v18, s[28:31], s51 offen lds
    s_add_u32 s50, s50, s46
    s_add_u32 m0, s47, 106496
    s_add_u32 s44, s50, 0
    buffer_load_dwordx4 v19, s[32:35], s44 offen lds
    s_add_u32 m0, s47, 114688
    s_add_u32 s44, s50, 1024
    buffer_load_dwordx4 v19, s[32:35], s44 offen lds
    s_add_u32 m0, s47, 122880
    s_add_u32 s44, s50, 2048
    buffer_load_dwordx4 v19, s[32:35], s44 offen lds
    s_waitcnt vmcnt(8) lgkmcnt(0)
    s_barrier
    v_add_u32 v11, 32768, v8
    v_add_u32 v12, 32768, v9
    v_add_u32 v13, 32768, v10
    v_mfma_f32_16x16x32_bf16 v[32:35], v[96:99], v[80:83], v[32:35]
    ds_read_b128 v[120:123], v11 offset:0
    ds_read_b128 v[128:131], v11 offset:2048
    v_mfma_f32_16x16x32_bf16 v[40:43], v[104:107], v[80:83], v[40:43]
    ds_read_b64_tr_b16 v[136:137], v13 offset:0
    ds_read_b64_tr_b16 v[138:139], v13 offset:512
    v_mfma_f32_16x16x32_bf16 v[48:51], v[80:83], v[112:115], v[48:51]
    ds_read_b64_tr_b16 v[144:145], v13 offset:8192
    ds_read_b64_tr_b16 v[146:147], v13 offset:8704
    v_mfma_f32_16x16x32_bf16 v[64:67], v[20:23], v[100:103], v[64:67]
    ds_read_b64_tr_b16 v[152:153], v13 offset:16384
    ds_read_b64_tr_b16 v[154:155], v13 offset:16896
    v_mfma_f32_16x16x32_bf16 v[36:39], v[96:99], v[88:91], v[36:39]
    ds_read_b128 v[124:127], v12 offset:0
    ds_read_b128 v[132:135], v12 offset:2048
    v_mfma_f32_16x16x32_bf16 v[44:47], v[104:107], v[88:91], v[44:47]
    ds_read_b64_tr_b16 v[140:141], v13 offset:4096
    ds_read_b64_tr_b16 v[142:143], v13 offset:4608
    v_mfma_f32_16x16x32_bf16 v[68:71], v[20:23], v[108:111], v[68:71]
    ds_read_b64_tr_b16 v[148:149], v13 offset:12288
    ds_read_b64_tr_b16 v[150:151], v13 offset:12800
    v_mfma_f32_16x16x32_bf16 v[52:55], v[88:91], v[112:115], v[52:55]
    ds_read_b64_tr_b16 v[156:157], v13 offset:20480
    ds_read_b64_tr_b16 v[158:159], v13 offset:20992
    v_mfma_f32_16x16x32_bf16 v[32:35], v[100:103], v[84:87], v[32:35]
    s_add_u32 s50, s49, 4
    s_and_b32 s50, s50, 7
    s_lshl_b32 s51, s50, 7
    s_add_u32 s51, s51, s45
    s_add_u32 m0, s47, 0
    s_mul_i32 s50, s50, 196608
    buffer_load_dwordx4 v18, s[28:31], s51 offen lds
    v_mfma_f32_16x16x32_bf16 v[40:43], v[108:111], v[84:87], v[40:43]
    s_add_u32 s50, s50, s46
    s_add_u32 m0, s47, 8192
    s_add_u32 s44, s50, 0
    buffer_load_dwordx4 v19, s[32:35], s44 offen lds
    v_mfma_f32_16x16x32_bf16 v[72:75], v[20:23], v[116:119], v[72:75]
    s_add_u32 m0, s47, 16384
    s_add_u32 s44, s50, 1024
    buffer_load_dwordx4 v19, s[32:35], s44 offen lds
    v_mfma_f32_16x16x32_bf16 v[48:51], v[84:87], v[116:119], v[48:51]
    s_add_u32 m0, s47, 24576
    s_add_u32 s44, s50, 2048
    buffer_load_dwordx4 v19, s[32:35], s44 offen lds
    s_waitcnt vmcnt(8) lgkmcnt(0)
    v_mfma_f32_16x16x32_bf16 v[36:39], v[100:103], v[92:95], v[36:39]
    v_mfma_f32_16x16x32_bf16 v[56:59], v[88:91], v[88:91], v[56:59]
    v_mfma_f32_16x16x32_bf16 v[44:47], v[108:111], v[92:95], v[44:47]
    v_mfma_f32_16x16x32_bf16 v[52:55], v[92:95], v[116:119], v[52:55]
    v_mfma_f32_16x16x32_bf16 v[60:63], v[88:91], v[20:23], v[60:63]
    s_barrier
    v_add_u32 v11, 65536, v8
    v_add_u32 v12, 65536, v9
    v_add_u32 v13, 65536, v10
    v_mfma_f32_16x16x32_bf16 v[32:35], v[136:139], v[120:123], v[32:35]
    ds_read_b128 v[80:83], v11 offset:0
    ds_read_b128 v[88:91], v11 offset:2048
    v_mfma_f32_16x16x32_bf16 v[40:43], v[144:147], v[120:123], v[40:43]
    ds_read_b64_tr_b16 v[96:97], v13 offset:0
    ds_read_b64_tr_b16 v[98:99], v13 offset:512
    v_mfma_f32_16x16x32_bf16 v[48:51], v[120:123], v[152:155], v[48:51]
    ds_read_b64_tr_b16 v[104:105], v13 offset:8192
    ds_read_b64_tr_b16 v[106:107], v13 offset:8704
    v_mfma_f32_16x16x32_bf16 v[64:67], v[20:23], v[140:143], v[64:67]
    ds_read_b64_tr_b16 v[112:113], v13 offset:16384
    ds_read_b64_tr_b16 v[114:115], v13 offset:16896
    v_mfma_f32_16x16x32_bf16 v[36:39], v[136:139], v[128:131], v[36:39]
    ds_read_b128 v[84:87], v12 offset:0
    ds_read_b128 v[92:95], v12 offset:2048
    v_mfma_f32_16x16x32_bf16 v[44:47], v[144:147], v[128:131], v[44:47]
    ds_read_b64_tr_b16 v[100:101], v13 offset:4096
    ds_read_b64_tr_b16 v[102:103], v13 offset:4608
    v_mfma_f32_16x16x32_bf16 v[68:71], v[20:23], v[148:151], v[68:71]
    ds_read_b64_tr_b16 v[108:109], v13 offset:12288
    ds_read_b64_tr_b16 v[110:111], v13 offset:12800
    v_mfma_f32_16x16x32_bf16 v[52:55], v[128:131], v[152:155], v[52:55]
    ds_read_b64_tr_b16 v[116:117], v13 offset:20480
    ds_read_b64_tr_b16 v[118:119], v13 offset:20992
    v_mfma_f32_16x16x32_bf16 v[32:35], v[140:143], v[124:127], v[32:35]
    s_add_u32 s50, s49, 5
    s_and_b32 s50, s50, 7
    s_lshl_b32 s51, s50, 7
    s_add_u32 s51, s51, s45
    s_add_u32 m0, s47, 32768
    s_mul_i32 s50, s50, 196608
    buffer_load_dwordx4 v18, s[28:31], s51 offen lds
    v_mfma_f32_16x16x32_bf16 v[40:43], v[148:151], v[124:127], v[40:43]
    s_add_u32 s50, s50, s46
    s_add_u32 m0, s47, 40960
    s_add_u32 s44, s50, 0
    buffer_load_dwordx4 v19, s[32:35], s44 offen lds
    v_mfma_f32_16x16x32_bf16 v[72:75], v[20:23], v[156:159], v[72:75]
    s_add_u32 m0, s47, 49152
    s_add_u32 s44, s50, 1024
    buffer_load_dwordx4 v19, s[32:35], s44 offen lds
    v_mfma_f32_16x16x32_bf16 v[48:51], v[124:127], v[156:159], v[48:51]
    s_add_u32 m0, s47, 57344
    s_add_u32 s44, s50, 2048
    buffer_load_dwordx4 v19, s[32:35], s44 offen lds
    s_waitcnt vmcnt(8) lgkmcnt(0)
    v_mfma_f32_16x16x32_bf16 v[36:39], v[140:143], v[132:135], v[36:39]
    v_mfma_f32_16x16x32_bf16 v[56:59], v[128:131], v[128:131], v[56:59]
    v_mfma_f32_16x16x32_bf16 v[44:47], v[148:151], v[132:135], v[44:47]
    v_mfma_f32_16x16x32_bf16 v[52:55], v[132:135], v[156:159], v[52:55]
    v_mfma_f32_16x16x32_bf16 v[60:63], v[128:131], v[20:23], v[60:63]
    s_barrier
    v_add_u32 v11, 98304, v8
    v_add_u32 v12, 98304, v9
    v_add_u32 v13, 98304, v10
    v_mfma_f32_16x16x32_bf16 v[32:35], v[96:99], v[80:83], v[32:35]
    ds_read_b128 v[120:123], v11 offset:0
    ds_read_b128 v[128:131], v11 offset:2048
    v_mfma_f32_16x16x32_bf16 v[40:43], v[104:107], v[80:83], v[40:43]
    ds_read_b64_tr_b16 v[136:137], v13 offset:0
    ds_read_b64_tr_b16 v[138:139], v13 offset:512
    v_mfma_f32_16x16x32_bf16 v[48:51], v[80:83], v[112:115], v[48:51]
    ds_read_b64_tr_b16 v[144:145], v13 offset:8192
    ds_read_b64_tr_b16 v[146:147], v13 offset:8704
    v_mfma_f32_16x16x32_bf16 v[64:67], v[20:23], v[100:103], v[64:67]
    ds_read_b64_tr_b16 v[152:153], v13 offset:16384
    ds_read_b64_tr_b16 v[154:155], v13 offset:16896
    v_mfma_f32_16x16x32_bf16 v[36:39], v[96:99], v[88:91], v[36:39]
    ds_read_b128 v[124:127], v12 offset:0
    ds_read_b128 v[132:135], v12 offset:2048
    v_mfma_f32_16x16x32_bf16 v[44:47], v[104:107], v[88:91], v[44:47]
    ds_read_b64_tr_b16 v[140:141], v13 offset:4096
    ds_read_b64_tr_b16 v[142:143], v13 offset:4608
    v_mfma_f32_16x16x32_bf16 v[68:71], v[20:23], v[108:111], v[68:71]
    ds_read_b64_tr_b16 v[148:149], v13 offset:12288
    ds_read_b64_tr_b16 v[150:151], v13 offset:12800
    v_mfma_f32_16x16x32_bf16 v[52:55], v[88:91], v[112:115], v[52:55]
    ds_read_b64_tr_b16 v[156:157], v13 offset:20480
    ds_read_b64_tr_b16 v[158:159], v13 offset:20992
    v_mfma_f32_16x16x32_bf16 v[32:35], v[100:103], v[84:87], v[32:35]
    s_add_u32 s50, s49, 6
    s_and_b32 s50, s50, 7
    s_lshl_b32 s51, s50, 7
    s_add_u32 s51, s51, s45
    s_add_u32 m0, s47, 65536
    s_mul_i32 s50, s50, 196608
    buffer_load_dwordx4 v18, s[28:31], s51 offen lds
    v_mfma_f32_16x16x32_bf16 v[40:43], v[108:111], v[84:87], v[40:43]
    s_add_u32 s50, s50, s46
    s_add_u32 m0, s47, 73728
    s_add_u32 s44, s50, 0
    buffer_load_dwordx4 v19, s[32:35], s44 offen lds
    v_mfma_f32_16x16x32_bf16 v[72:75], v[20:23], v[116:119], v[72:75]
    s_add_u32 m0, s47, 81920
    s_add_u32 s44, s50, 1024
    buffer_load_dwordx4 v19, s[32:35], s44 offen lds
    v_mfma_f32_16x16x32_bf16 v[48:51], v[84:87], v[116:119], v[48:51]
    s_add_u32 m0, s47, 90112
    s_add_u32 s44, s50, 2048
    buffer_load_dwordx4 v19, s[32:35], s44 offen lds
    s_waitcnt vmcnt(8) lgkmcnt(0)
    v_mfma_f32_16x16x32_bf16 v[36:39], v[100:103], v[92:95], v[36:39]
    v_mfma_f32_16x16x32_bf16 v[56:59], v[88:91], v[88:91], v[56:59]
    v_mfma_f32_16x16x32_bf16 v[44:47], v[108:111], v[92:95], v[44:47]
    v_mfma_f32_16x16x32_bf16 v[52:55], v[92:95], v[116:119], v[52:55]
    v_mfma_f32_16x16x32_bf16 v[60:63], v[88:91], v[20:23], v[60:63]
    s_barrier
    v_add_u32 v11, 0, v8
    v_add_u32 v12, 0, v9
    v_add_u32 v13, 0, v10
    v_mfma_f32_16x16x32_bf16 v[32:35], v[136:139], v[120:123], v[32:35]
    ds_read_b128 v[80:83], v11 offset:0
    ds_read_b128 v[88:91], v11 offset:2048
    v_mfma_f32_16x16x32_bf16 v[40:43], v[144:147], v[120:123], v[40:43]
    ds_read_b64_tr_b16 v[96:97], v13 offset:0
    ds_read_b64_tr_b16 v[98:99], v13 offset:512
    v_mfma_f32_16x16x32_bf16 v[48:51], v[120:123], v[152:155], v[48:51]
    ds_read_b64_tr_b16 v[104:105], v13 offset:8192
    ds_read_b64_tr_b16 v[106:107], v13 offset:8704
    v_mfma_f32_16x16x32_bf16 v[64:67], v[20:23], v[140:143], v[64:67]
    ds_read_b64_tr_b16 v[112:113], v13 offset:16384
    ds_read_b64_tr_b16 v[114:115], v13 offset:16896
    v_mfma_f32_16x16x32_bf16 v[36:39], v[136:139], v[128:131], v[36:39]
    ds_read_b128 v[84:87], v12 offset:0
    ds_read_b128 v[92:95], v12 offset:2048
    v_mfma_f32_16x16x32_bf16 v[44:47], v[144:147], v[128:131], v[44:47]
    ds_read_b64_tr_b16 v[100:101], v13 offset:4096
    ds_read_b64_tr_b16 v[102:103], v13 offset:4608
    v_mfma_f32_16x16x32_bf16 v[68:71], v[20:23], v[148:151], v[68:71]
    ds_read_b64_tr_b16 v[108:109], v13 offset:12288
    ds_read_b64_tr_b16 v[110:111], v13 offset:12800
    v_mfma_f32_16x16x32_bf16 v[52:55], v[128:131], v[152:155], v[52:55]
    ds_read_b64_tr_b16 v[116:117], v13 offset:20480
    ds_read_b64_tr_b16 v[118:119], v13 offset:20992
    v_mfma_f32_16x16x32_bf16 v[32:35], v[140:143], v[124:127], v[32:35]
    s_add_u32 s50, s49, 7
    s_and_b32 s50, s50, 7
    s_lshl_b32 s51, s50, 7
    s_add_u32 s51, s51, s45
    s_add_u32 m0, s47, 98304
    s_mul_i32 s50, s50, 196608
    buffer_load_dwordx4 v18, s[28:31], s51 offen lds
    v_mfma_f32_16x16x32_bf16 v[40:43], v[148:151], v[124:127], v[40:43]
    s_add_u32 s50, s50, s46
    s_add_u32 m0, s47, 106496
    s_add_u32 s44, s50, 0
    buffer_load_dwordx4 v19, s[32:35], s44 offen lds
    v_mfma_f32_16x16x32_bf16 v[72:75], v[20:23], v[156:159], v[72:75]
    s_add_u32 m0, s47, 114688
    s_add_u32 s44, s50, 1024
    buffer_load_dwordx4 v19, s[32:35], s44 offen lds
    v_mfma_f32_16x16x32_bf16 v[48:51], v[124:127], v[156:159], v[48:51]
    s_add_u32 m0, s47, 122880
    s_add_u32 s44, s50, 2048
    buffer_load_dwordx4 v19, s[32:35], s44 offen lds
    s_waitcnt vmcnt(8) lgkmcnt(0)
    v_mfma_f32_16x16x32_bf16 v[36:39], v[140:143], v[132:135], v[36:39]
    v_mfma_f32_16x16x32_bf16 v[56:59], v[128:131], v[128:131], v[56:59]
    v_mfma_f32_16x16x32_bf16 v[44:47], v[148:151], v[132:135], v[44:47]
    v_mfma_f32_16x16x32_bf16 v[52:55], v[132:135], v[156:159], v[52:55]
    v_mfma_f32_16x16x32_bf16 v[60:63], v[128:131], v[20:23], v[60:63]
    s_barrier
    s_and_b32 s53, s27, 1
    s_lshl_b32 s53, s53, 2
    s_and_b32 s54, s3, 3
    s_add_u32 s53, s53, s54
    s_lshr_b32 s54, s27, 1
    s_lshl_b32 s54, s54, 3
    s_lshr_b32 s55, s3, 2
    s_add_u32 s54, s54, s55
    s_lshl_b32 s53, s53, 18
    s_lshl_b32 s54, s54, 13
    s_add_u32 s53, s53, s54
    s_lshl_b32 s54, s26, 10
    s_add_u32 s53, s53, s54
    s_add_u32 s53, s53, 10747904
    v_lshlrev_b32 v28, 4, v1
    v_mov_b32 v24, -1
    v_mov_b32 v25, -1
    v_mov_b32 v26, -1
    v_mov_b32 v27, -1
    buffer_store_dwordx4 v[24:27], v28, s[36:39], s53 offen sc1
    v_add_u32 v11, 32768, v8
    v_add_u32 v12, 32768, v9
    v_add_u32 v13, 32768, v10
    v_mfma_f32_16x16x32_bf16 v[32:35], v[96:99], v[80:83], v[32:35]
    ds_read_b128 v[120:123], v11 offset:0
    ds_read_b128 v[128:131], v11 offset:2048
    v_mfma_f32_16x16x32_bf16 v[40:43], v[104:107], v[80:83], v[40:43]
    ds_read_b64_tr_b16 v[136:137], v13 offset:0
    ds_read_b64_tr_b16 v[138:139], v13 offset:512
    v_mfma_f32_16x16x32_bf16 v[48:51], v[80:83], v[112:115], v[48:51]
    ds_read_b64_tr_b16 v[144:145], v13 offset:8192
    ds_read_b64_tr_b16 v[146:147], v13 offset:8704
    v_mfma_f32_16x16x32_bf16 v[64:67], v[20:23], v[100:103], v[64:67]
    ds_read_b64_tr_b16 v[152:153], v13 offset:16384
    ds_read_b64_tr_b16 v[154:155], v13 offset:16896
    v_mfma_f32_16x16x32_bf16 v[36:39], v[96:99], v[88:91], v[36:39]
    ds_read_b128 v[124:127], v12 offset:0
    ds_read_b128 v[132:135], v12 offset:2048
    v_mfma_f32_16x16x32_bf16 v[44:47], v[104:107], v[88:91], v[44:47]
    ds_read_b64_tr_b16 v[140:141], v13 offset:4096
    ds_read_b64_tr_b16 v[142:143], v13 offset:4608
    v_mfma_f32_16x16x32_bf16 v[68:71], v[20:23], v[108:111], v[68:71]
    ds_read_b64_tr_b16 v[148:149], v13 offset:12288
    ds_read_b64_tr_b16 v[150:151], v13 offset:12800
    v_mfma_f32_16x16x32_bf16 v[52:55], v[88:91], v[112:115], v[52:55]
    ds_read_b64_tr_b16 v[156:157], v13 offset:20480
    ds_read_b64_tr_b16 v[158:159], v13 offset:20992
    v_mfma_f32_16x16x32_bf16 v[32:35], v[100:103], v[84:87], v[32:35]
    v_mfma_f32_16x16x32_bf16 v[40:43], v[108:111], v[84:87], v[40:43]
    v_mfma_f32_16x16x32_bf16 v[72:75], v[20:23], v[116:119], v[72:75]
    v_mfma_f32_16x16x32_bf16 v[48:51], v[84:87], v[116:119], v[48:51]
    s_waitcnt vmcnt(5) lgkmcnt(0)
    v_mfma_f32_16x16x32_bf16 v[36:39], v[100:103], v[92:95], v[36:39]
    v_mfma_f32_16x16x32_bf16 v[56:59], v[88:91], v[88:91], v[56:59]
    v_mfma_f32_16x16x32_bf16 v[44:47], v[108:111], v[92:95], v[44:47]
    v_mfma_f32_16x16x32_bf16 v[52:55], v[92:95], v[116:119], v[52:55]
    v_mfma_f32_16x16x32_bf16 v[60:63], v[88:91], v[20:23], v[60:63]
    s_barrier
    v_add_u32 v11, 65536, v8
    v_add_u32 v12, 65536, v9
    v_add_u32 v13, 65536, v10
    v_mfma_f32_16x16x32_bf16 v[32:35], v[136:139], v[120:123], v[32:35]
    ds_read_b128 v[80:83], v11 offset:0
    ds_read_b128 v[88:91], v11 offset:2048
    v_mfma_f32_16x16x32_bf16 v[40:43], v[144:147], v[120:123], v[40:43]
    ds_read_b64_tr_b16 v[96:97], v13 offset:0
    ds_read_b64_tr_b16 v[98:99], v13 offset:512
    v_mfma_f32_16x16x32_bf16 v[48:51], v[120:123], v[152:155], v[48:51]
    ds_read_b64_tr_b16 v[104:105], v13 offset:8192
    ds_read_b64_tr_b16 v[106:107], v13 offset:8704
    v_mfma_f32_16x16x32_bf16 v[64:67], v[20:23], v[140:143], v[64:67]
    ds_read_b64_tr_b16 v[112:113], v13 offset:16384
    ds_read_b64_tr_b16 v[114:115], v13 offset:16896
    v_mfma_f32_16x16x32_bf16 v[36:39], v[136:139], v[128:131], v[36:39]
    ds_read_b128 v[84:87], v12 offset:0
    ds_read_b128 v[92:95], v12 offset:2048
    v_mfma_f32_16x16x32_bf16 v[44:47], v[144:147], v[128:131], v[44:47]
    ds_read_b64_tr_b16 v[100:101], v13 offset:4096
    ds_read_b64_tr_b16 v[102:103], v13 offset:4608
    v_mfma_f32_16x16x32_bf16 v[68:71], v[20:23], v[148:151], v[68:71]
    ds_read_b64_tr_b16 v[108:109], v13 offset:12288
    ds_read_b64_tr_b16 v[110:111], v13 offset:12800
    v_mfma_f32_16x16x32_bf16 v[52:55], v[128:131], v[152:155], v[52:55]
    ds_read_b64_tr_b16 v[116:117], v13 offset:20480
    ds_read_b64_tr_b16 v[118:119], v13 offset:20992
    v_mfma_f32_16x16x32_bf16 v[32:35], v[140:143], v[124:127], v[32:35]
    v_mfma_f32_16x16x32_bf16 v[40:43], v[148:151], v[124:127], v[40:43]
    v_mfma_f32_16x16x32_bf16 v[72:75], v[20:23], v[156:159], v[72:75]
    v_mfma_f32_16x16x32_bf16 v[48:51], v[124:127], v[156:159], v[48:51]
    s_waitcnt vmcnt(1) lgkmcnt(0)
    v_mfma_f32_16x16x32_bf16 v[36:39], v[140:143], v[132:135], v[36:39]
    v_mfma_f32_16x16x32_bf16 v[56:59], v[128:131], v[128:131], v[56:59]
    v_mfma_f32_16x16x32_bf16 v[44:47], v[148:151], v[132:135], v[44:47]
    v_mfma_f32_16x16x32_bf16 v[52:55], v[132:135], v[156:159], v[52:55]
    v_mfma_f32_16x16x32_bf16 v[60:63], v[128:131], v[20:23], v[60:63]
    s_barrier
    v_add_u32 v11, 98304, v8
    v_add_u32 v12, 98304, v9
    v_add_u32 v13, 98304, v10
    v_mfma_f32_16x16x32_bf16 v[32:35], v[96:99], v[80:83], v[32:35]
    ds_read_b128 v[120:123], v11 offset:0
    v_mfma_f32_16x16x32_bf16 v[40:43], v[104:107], v[80:83], v[40:43]
    ds_read_b128 v[128:131], v11 offset:2048
    v_mfma_f32_16x16x32_bf16 v[48:51], v[80:83], v[112:115], v[48:51]
    ds_read_b64_tr_b16 v[136:137], v13 offset:0
    ds_read_b64_tr_b16 v[138:139], v13 offset:512
    v_mfma_f32_16x16x32_bf16 v[64:67], v[20:23], v[100:103], v[64:67]
    ds_read_b64_tr_b16 v[144:145], v13 offset:8192
    v_mfma_f32_16x16x32_bf16 v[36:39], v[96:99], v[88:91], v[36:39]
    ds_read_b64_tr_b16 v[146:147], v13 offset:8704
    ds_read_b64_tr_b16 v[152:153], v13 offset:16384
    v_mfma_f32_16x16x32_bf16 v[44:47], v[104:107], v[88:91], v[44:47]
    ds_read_b64_tr_b16 v[154:155], v13 offset:16896
    v_mfma_f32_16x16x32_bf16 v[68:71], v[20:23], v[108:111], v[68:71]
    ds_read_b128 v[124:127], v12 offset:0
    ds_read_b128 v[132:135], v12 offset:2048
    v_mfma_f32_16x16x32_bf16 v[52:55], v[88:91], v[112:115], v[52:55]
    ds_read_b64_tr_b16 v[140:141], v13 offset:4096
    v_mfma_f32_16x16x32_bf16 v[32:35], v[100:103], v[84:87], v[32:35]
    ds_read_b64_tr_b16 v[142:143], v13 offset:4608
    ds_read_b64_tr_b16 v[148:149], v13 offset:12288
    v_mfma_f32_16x16x32_bf16 v[40:43], v[108:111], v[84:87], v[40:43]
    ds_read_b64_tr_b16 v[150:151], v13 offset:12800
    v_mfma_f32_16x16x32_bf16 v[72:75], v[20:23], v[116:119], v[72:75]
    ds_read_b64_tr_b16 v[156:157], v13 offset:20480
    ds_read_b64_tr_b16 v[158:159], v13 offset:20992
    v_mfma_f32_16x16x32_bf16 v[48:51], v[84:87], v[116:119], v[48:51]
    v_mfma_f32_16x16x32_bf16 v[36:39], v[100:103], v[92:95], v[36:39]
    v_mfma_f32_16x16x32_bf16 v[56:59], v[88:91], v[88:91], v[56:59]
    v_mfma_f32_16x16x32_bf16 v[44:47], v[108:111], v[92:95], v[44:47]
    v_mfma_f32_16x16x32_bf16 v[52:55], v[92:95], v[116:119], v[52:55]
    v_mfma_f32_16x16x32_bf16 v[60:63], v[88:91], v[20:23], v[60:63]
    s_waitcnt lgkmcnt(0)
    v_mfma_f32_16x16x32_bf16 v[32:35], v[136:139], v[120:123], v[32:35]
    v_mfma_f32_16x16x32_bf16 v[40:43], v[144:147], v[120:123], v[40:43]
    v_mfma_f32_16x16x32_bf16 v[48:51], v[120:123], v[152:155], v[48:51]
    v_mfma_f32_16x16x32_bf16 v[64:67], v[20:23], v[140:143], v[64:67]
    v_mfma_f32_16x16x32_bf16 v[36:39], v[136:139], v[128:131], v[36:39]
    v_mfma_f32_16x16x32_bf16 v[44:47], v[144:147], v[128:131], v[44:47]
    v_mfma_f32_16x16x32_bf16 v[68:71], v[20:23], v[148:151], v[68:71]
    v_mfma_f32_16x16x32_bf16 v[52:55], v[128:131], v[152:155], v[52:55]
    v_mfma_f32_16x16x32_bf16 v[32:35], v[140:143], v[124:127], v[32:35]
    v_mfma_f32_16x16x32_bf16 v[40:43], v[148:151], v[124:127], v[40:43]
    v_mfma_f32_16x16x32_bf16 v[72:75], v[20:23], v[156:159], v[72:75]
    v_mfma_f32_16x16x32_bf16 v[48:51], v[124:127], v[156:159], v[48:51]
    v_mfma_f32_16x16x32_bf16 v[36:39], v[140:143], v[132:135], v[36:39]
    v_mfma_f32_16x16x32_bf16 v[56:59], v[128:131], v[128:131], v[56:59]
    v_mfma_f32_16x16x32_bf16 v[44:47], v[148:151], v[132:135], v[44:47]
    v_mfma_f32_16x16x32_bf16 v[52:55], v[132:135], v[156:159], v[52:55]
    v_mfma_f32_16x16x32_bf16 v[60:63], v[128:131], v[20:23], v[60:63]
    s_branch L_k1_cj
L_k1_c7:
    s_waitcnt vmcnt(4) lgkmcnt(0)
    s_barrier
    v_add_u32 v11, 0, v8
    v_add_u32 v12, 0, v9
    v_add_u32 v13, 0, v10
    ds_read_b128 v[80:83], v11 offset:0
    ds_read_b128 v[88:91], v11 offset:2048
    ds_read_b64_tr_b16 v[96:97], v13 offset:0
    ds_read_b64_tr_b16 v[98:99], v13 offset:512
    ds_read_b64_tr_b16 v[104:105], v13 offset:8192
    ds_read_b64_tr_b16 v[106:107], v13 offset:8704
    ds_read_b64_tr_b16 v[112:113], v13 offset:16384
    ds_read_b64_tr_b16 v[114:115], v13 offset:16896
    ds_read_b128 v[84:87], v12 offset:0
    ds_read_b128 v[92:95], v12 offset:2048
    ds_read_b64_tr_b16 v[100:101], v13 offset:4096
    ds_read_b64_tr_b16 v[102:103], v13 offset:4608
    ds_read_b64_tr_b16 v[108:109], v13 offset:12288
    ds_read_b64_tr_b16 v[110:111], v13 offset:12800
    ds_read_b64_tr_b16 v[116:117], v13 offset:20480
    ds_read_b64_tr_b16 v[118:119], v13 offset:20992
    s_add_u32 s50, s49, 2
    s_and_b32 s50, s50, 7
    s_lshl_b32 s51, s50, 7
    s_add_u32 s51, s51, s45
    s_add_u32 m0, s47, 65536
    s_mul_i32 s50, s50, 196608
    buffer_load_dwordx4 v18, s[28:31], s51 offen lds
    s_add_u32 s50, s50, s46
    s_add_u32 m0, s47, 73728
    s_add_u32 s44, s50, 0
    buffer_load_dwordx4 v19, s[32:35], s44 offen lds
    s_add_u32 m0, s47, 81920
    s_add_u32 s44, s50, 1024
    buffer_load_dwordx4 v19, s[32:35], s44 offen lds
    s_add_u32 m0, s47, 90112
    s_add_u32 s44, s50, 2048
    buffer_load_dwordx4 v19, s[32:35], s44 offen lds
    s_add_u32 s50, s49, 3
    s_and_b32 s50, s50, 7
    s_lshl_b32 s51, s50, 7
    s_add_u32 s51, s51, s45
    s_add_u32 m0, s47, 98304
    s_mul_i32 s50, s50, 196608
    buffer_load_dwordx4 v18, s[28:31], s51 offen lds
    s_add_u32 s50, s50, s46
    s_add_u32 m0, s47, 106496
    s_add_u32 s44, s50, 0
    buffer_load_dwordx4 v19, s[32:35], s44 offen lds
    s_add_u32 m0, s47, 114688
    s_add_u32 s44, s50, 1024
    buffer_load_dwordx4 v19, s[32:35], s44 offen lds
    s_add_u32 m0, s47, 122880
    s_add_u32 s44, s50, 2048
    buffer_load_dwordx4 v19, s[32:35], s44 offen lds
    s_waitcnt vmcnt(8) lgkmcnt(0)
    s_barrier
    v_add_u32 v11, 32768, v8
    v_add_u32 v12, 32768, v9
    v_add_u32 v13, 32768, v10
    v_mfma_f32_16x16x32_bf16 v[32:35], v[96:99], v[80:83], v[32:35]
    ds_read_b128 v[120:123], v11 offset:0
    ds_read_b128 v[128:131], v11 offset:2048
    v_mfma_f32_16x16x32_bf16 v[40:43], v[104:107], v[80:83], v[40:43]
    ds_read_b64_tr_b16 v[136:137], v13 offset:0
    ds_read_b64_tr_b16 v[138:139], v13 offset:512
    v_mfma_f32_16x16x32_bf16 v[48:51], v[80:83], v[112:115], v[48:51]
    ds_read_b64_tr_b16 v[144:145], v13 offset:8192
    ds_read_b64_tr_b16 v[146:147], v13 offset:8704
    v_mfma_f32_16x16x32_bf16 v[64:67], v[20:23], v[100:103], v[64:67]
    ds_read_b64_tr_b16 v[152:153], v13 offset:16384
    ds_read_b64_tr_b16 v[154:155], v13 offset:16896
    v_mfma_f32_16x16x32_bf16 v[36:39], v[96:99], v[88:91], v[36:39]
    ds_read_b128 v[124:127], v12 offset:0
    ds_read_b128 v[132:135], v12 offset:2048
    v_mfma_f32_16x16x32_bf16 v[44:47], v[104:107], v[88:91], v[44:47]
    ds_read_b64_tr_b16 v[140:141], v13 offset:4096
    ds_read_b64_tr_b16 v[142:143], v13 offset:4608
    v_mfma_f32_16x16x32_bf16 v[68:71], v[20:23], v[108:111], v[68:71]
    ds_read_b64_tr_b16 v[148:149], v13 offset:12288
    ds_read_b64_tr_b16 v[150:151], v13 offset:12800
    v_mfma_f32_16x16x32_bf16 v[52:55], v[88:91], v[112:115], v[52:55]
    ds_read_b64_tr_b16 v[156:157], v13 offset:20480
    ds_read_b64_tr_b16 v[158:159], v13 offset:20992
    v_mfma_f32_16x16x32_bf16 v[32:35], v[100:103], v[84:87], v[32:35]
    s_add_u32 s50, s49, 4
    s_and_b32 s50, s50, 7
    s_lshl_b32 s51, s50, 7
    s_add_u32 s51, s51, s45
    s_add_u32 m0, s47, 0
    s_mul_i32 s50, s50, 196608
    buffer_load_dwordx4 v18, s[28:31], s51 offen lds
    v_mfma_f32_16x16x32_bf16 v[40:43], v[108:111], v[84:87], v[40:43]
    s_add_u32 s50, s50, s46
    s_add_u32 m0, s47, 8192
    s_add_u32 s44, s50, 0
    buffer_load_dwordx4 v19, s[32:35], s44 offen lds
    v_mfma_f32_16x16x32_bf16 v[72:75], v[20:23], v[116:119], v[72:75]
    s_add_u32 m0, s47, 16384
    s_add_u32 s44, s50, 1024
    buffer_load_dwordx4 v19, s[32:35], s44 offen lds
    v_mfma_f32_16x16x32_bf16 v[48:51], v[84:87], v[116:119], v[48:51]
    s_add_u32 m0, s47, 24576
    s_add_u32 s44, s50, 2048
    buffer_load_dwordx4 v19, s[32:35], s44 offen lds
    s_waitcnt vmcnt(8) lgkmcnt(0)
    v_mfma_f32_16x16x32_bf16 v[36:39], v[100:103], v[92:95], v[36:39]
    v_mfma_f32_16x16x32_bf16 v[56:59], v[92:95], v[92:95], v[56:59]
    v_mfma_f32_16x16x32_bf16 v[44:47], v[108:111], v[92:95], v[44:47]
    v_mfma_f32_16x16x32_bf16 v[52:55], v[92:95], v[116:119], v[52:55]
    v_mfma_f32_16x16x32_bf16 v[60:63], v[92:95], v[20:23], v[60:63]
    s_barrier
    v_add_u32 v11, 65536, v8
    v_add_u32 v12, 65536, v9
    v_add_u32 v13, 65536, v10
    v_mfma_f32_16x16x32_bf16 v[32:35], v[136:139], v[120:123], v[32:35]
    ds_read_b128 v[80:83], v11 offset:0
    ds_read_b128 v[88:91], v11 offset:2048
    v_mfma_f32_16x16x32_bf16 v[40:43], v[144:147], v[120:123], v[40:43]
    ds_read_b64_tr_b16 v[96:97], v13 offset:0
    ds_read_b64_tr_b16 v[98:99], v13 offset:512
    v_mfma_f32_16x16x32_bf16 v[48:51], v[120:123], v[152:155], v[48:51]
    ds_read_b64_tr_b16 v[104:105], v13 offset:8192
    ds_read_b64_tr_b16 v[106:107], v13 offset:8704
    v_mfma_f32_16x16x32_bf16 v[64:67], v[20:23], v[140:143], v[64:67]
    ds_read_b64_tr_b16 v[112:113], v13 offset:16384
    ds_read_b64_tr_b16 v[114:115], v13 offset:16896
    v_mfma_f32_16x16x32_bf16 v[36:39], v[136:139], v[128:131], v[36:39]
    ds_read_b128 v[84:87], v12 offset:0
    ds_read_b128 v[92:95], v12 offset:2048
    v_mfma_f32_16x16x32_bf16 v[44:47], v[144:147], v[128:131], v[44:47]
    ds_read_b64_tr_b16 v[100:101], v13 offset:4096
    ds_read_b64_tr_b16 v[102:103], v13 offset:4608
    v_mfma_f32_16x16x32_bf16 v[68:71], v[20:23], v[148:151], v[68:71]
    ds_read_b64_tr_b16 v[108:109], v13 offset:12288
    ds_read_b64_tr_b16 v[110:111], v13 offset:12800
    v_mfma_f32_16x16x32_bf16 v[52:55], v[128:131], v[152:155], v[52:55]
    ds_read_b64_tr_b16 v[116:117], v13 offset:20480
    ds_read_b64_tr_b16 v[118:119], v13 offset:20992
    v_mfma_f32_16x16x32_bf16 v[32:35], v[140:143], v[124:127], v[32:35]
    s_add_u32 s50, s49, 5
    s_and_b32 s50, s50, 7
    s_lshl_b32 s51, s50, 7
    s_add_u32 s51, s51, s45
    s_add_u32 m0, s47, 32768
    s_mul_i32 s50, s50, 196608
    buffer_load_dwordx4 v18, s[28:31], s51 offen lds
    v_mfma_f32_16x16x32_bf16 v[40:43], v[148:151], v[124:127], v[40:43]
    s_add_u32 s50, s50, s46
    s_add_u32 m0, s47, 40960
    s_add_u32 s44, s50, 0
    buffer_load_dwordx4 v19, s[32:35], s44 offen lds
    v_mfma_f32_16x16x32_bf16 v[72:75], v[20:23], v[156:159], v[72:75]
    s_add_u32 m0, s47, 49152
    s_add_u32 s44, s50, 1024
    buffer_load_dwordx4 v19, s[32:35], s44 offen lds
    v_mfma_f32_16x16x32_bf16 v[48:51], v[124:127], v[156:159], v[48:51]
    s_add_u32 m0, s47, 57344
    s_add_u32 s44, s50, 2048
    buffer_load_dwordx4 v19, s[32:35], s44 offen lds
    s_waitcnt vmcnt(8) lgkmcnt(0)
    v_mfma_f32_16x16x32_bf16 v[36:39], v[140:143], v[132:135], v[36:39]
    v_mfma_f32_16x16x32_bf16 v[56:59], v[132:135], v[132:135], v[56:59]
    v_mfma_f32_16x16x32_bf16 v[44:47], v[148:151], v[132:135], v[44:47]
    v_mfma_f32_16x16x32_bf16 v[52:55], v[132:135], v[156:159], v[52:55]
    v_mfma_f32_16x16x32_bf16 v[60:63], v[132:135], v[20:23], v[60:63]
    s_barrier
    v_add_u32 v11, 98304, v8
    v_add_u32 v12, 98304, v9
    v_add_u32 v13, 98304, v10
    v_mfma_f32_16x16x32_bf16 v[32:35], v[96:99], v[80:83], v[32:35]
    ds_read_b128 v[120:123], v11 offset:0
    ds_read_b128 v[128:131], v11 offset:2048
    v_mfma_f32_16x16x32_bf16 v[40:43], v[104:107], v[80:83], v[40:43]
    ds_read_b64_tr_b16 v[136:137], v13 offset:0
    ds_read_b64_tr_b16 v[138:139], v13 offset:512
    v_mfma_f32_16x16x32_bf16 v[48:51], v[80:83], v[112:115], v[48:51]
    ds_read_b64_tr_b16 v[144:145], v13 offset:8192
    ds_read_b64_tr_b16 v[146:147], v13 offset:8704
    v_mfma_f32_16x16x32_bf16 v[64:67], v[20:23], v[100:103], v[64:67]
    ds_read_b64_tr_b16 v[152:153], v13 offset:16384
    ds_read_b64_tr_b16 v[154:155], v13 offset:16896
    v_mfma_f32_16x16x32_bf16 v[36:39], v[96:99], v[88:91], v[36:39]
    ds_read_b128 v[124:127], v12 offset:0
    ds_read_b128 v[132:135], v12 offset:2048
    v_mfma_f32_16x16x32_bf16 v[44:47], v[104:107], v[88:91], v[44:47]
    ds_read_b64_tr_b16 v[140:141], v13 offset:4096
    ds_read_b64_tr_b16 v[142:143], v13 offset:4608
    v_mfma_f32_16x16x32_bf16 v[68:71], v[20:23], v[108:111], v[68:71]
    ds_read_b64_tr_b16 v[148:149], v13 offset:12288
    ds_read_b64_tr_b16 v[150:151], v13 offset:12800
    v_mfma_f32_16x16x32_bf16 v[52:55], v[88:91], v[112:115], v[52:55]
    ds_read_b64_tr_b16 v[156:157], v13 offset:20480
    ds_read_b64_tr_b16 v[158:159], v13 offset:20992
    v_mfma_f32_16x16x32_bf16 v[32:35], v[100:103], v[84:87], v[32:35]
    s_add_u32 s50, s49, 6
    s_and_b32 s50, s50, 7
    s_lshl_b32 s51, s50, 7
    s_add_u32 s51, s51, s45
    s_add_u32 m0, s47, 65536
    s_mul_i32 s50, s50, 196608
    buffer_load_dwordx4 v18, s[28:31], s51 offen lds
    v_mfma_f32_16x16x32_bf16 v[40:43], v[108:111], v[84:87], v[40:43]
    s_add_u32 s50, s50, s46
    s_add_u32 m0, s47, 73728
    s_add_u32 s44, s50, 0
    buffer_load_dwordx4 v19, s[32:35], s44 offen lds
    v_mfma_f32_16x16x32_bf16 v[72:75], v[20:23], v[116:119], v[72:75]
    s_add_u32 m0, s47, 81920
    s_add_u32 s44, s50, 1024
    buffer_load_dwordx4 v19, s[32:35], s44 offen lds
    v_mfma_f32_16x16x32_bf16 v[48:51], v[84:87], v[116:119], v[48:51]
    s_add_u32 m0, s47, 90112
    s_add_u32 s44, s50, 2048
    buffer_load_dwordx4 v19, s[32:35], s44 offen lds
    s_waitcnt vmcnt(8) lgkmcnt(0)
    v_mfma_f32_16x16x32_bf16 v[36:39], v[100:103], v[92:95], v[36:39]
    v_mfma_f32_16x16x32_bf16 v[56:59], v[92:95], v[92:95], v[56:59]
    v_mfma_f32_16x16x32_bf16 v[44:47], v[108:111], v[92:95], v[44:47]
    v_mfma_f32_16x16x32_bf16 v[52:55], v[92:95], v[116:119], v[52:55]
    v_mfma_f32_16x16x32_bf16 v[60:63], v[92:95], v[20:23], v[60:63]
    s_barrier
    v_add_u32 v11, 0, v8
    v_add_u32 v12, 0, v9
    v_add_u32 v13, 0, v10
    v_mfma_f32_16x16x32_bf16 v[32:35], v[136:139], v[120:123], v[32:35]
    ds_read_b128 v[80:83], v11 offset:0
    ds_read_b128 v[88:91], v11 offset:2048
    v_mfma_f32_16x16x32_bf16 v[40:43], v[144:147], v[120:123], v[40:43]
    ds_read_b64_tr_b16 v[96:97], v13 offset:0
    ds_read_b64_tr_b16 v[98:99], v13 offset:512
    v_mfma_f32_16x16x32_bf16 v[48:51], v[120:123], v[152:155], v[48:51]
    ds_read_b64_tr_b16 v[104:105], v13 offset:8192
    ds_read_b64_tr_b16 v[106:107], v13 offset:8704
    v_mfma_f32_16x16x32_bf16 v[64:67], v[20:23], v[140:143], v[64:67]
    ds_read_b64_tr_b16 v[112:113], v13 offset:16384
    ds_read_b64_tr_b16 v[114:115], v13 offset:16896
    v_mfma_f32_16x16x32_bf16 v[36:39], v[136:139], v[128:131], v[36:39]
    ds_read_b128 v[84:87], v12 offset:0
    ds_read_b128 v[92:95], v12 offset:2048
    v_mfma_f32_16x16x32_bf16 v[44:47], v[144:147], v[128:131], v[44:47]
    ds_read_b64_tr_b16 v[100:101], v13 offset:4096
    ds_read_b64_tr_b16 v[102:103], v13 offset:4608
    v_mfma_f32_16x16x32_bf16 v[68:71], v[20:23], v[148:151], v[68:71]
    ds_read_b64_tr_b16 v[108:109], v13 offset:12288
    ds_read_b64_tr_b16 v[110:111], v13 offset:12800
    v_mfma_f32_16x16x32_bf16 v[52:55], v[128:131], v[152:155], v[52:55]
    ds_read_b64_tr_b16 v[116:117], v13 offset:20480
    ds_read_b64_tr_b16 v[118:119], v13 offset:20992
    v_mfma_f32_16x16x32_bf16 v[32:35], v[140:143], v[124:127], v[32:35]
    s_add_u32 s50, s49, 7
    s_and_b32 s50, s50, 7
    s_lshl_b32 s51, s50, 7
    s_add_u32 s51, s51, s45
    s_add_u32 m0, s47, 98304
    s_mul_i32 s50, s50, 196608
    buffer_load_dwordx4 v18, s[28:31], s51 offen lds
    v_mfma_f32_16x16x32_bf16 v[40:43], v[148:151], v[124:127], v[40:43]
    s_add_u32 s50, s50, s46
    s_add_u32 m0, s47, 106496
    s_add_u32 s44, s50, 0
    buffer_load_dwordx4 v19, s[32:35], s44 offen lds
    v_mfma_f32_16x16x32_bf16 v[72:75], v[20:23], v[156:159], v[72:75]
    s_add_u32 m0, s47, 114688
    s_add_u32 s44, s50, 1024
    buffer_load_dwordx4 v19, s[32:35], s44 offen lds
    v_mfma_f32_16x16x32_bf16 v[48:51], v[124:127], v[156:159], v[48:51]
    s_add_u32 m0, s47, 122880
    s_add_u32 s44, s50, 2048
    buffer_load_dwordx4 v19, s[32:35], s44 offen lds
    s_waitcnt vmcnt(8) lgkmcnt(0)
    v_mfma_f32_16x16x32_bf16 v[36:39], v[140:143], v[132:135], v[36:39]
    v_mfma_f32_16x16x32_bf16 v[56:59], v[132:135], v[132:135], v[56:59]
    v_mfma_f32_16x16x32_bf16 v[44:47], v[148:151], v[132:135], v[44:47]
    v_mfma_f32_16x16x32_bf16 v[52:55], v[132:135], v[156:159], v[52:55]
    v_mfma_f32_16x16x32_bf16 v[60:63], v[132:135], v[20:23], v[60:63]
    s_barrier
    s_and_b32 s53, s27, 1
    s_lshl_b32 s53, s53, 2
    s_and_b32 s54, s3, 3
    s_add_u32 s53, s53, s54
    s_lshr_b32 s54, s27, 1
    s_lshl_b32 s54, s54, 3
    s_lshr_b32 s55, s3, 2
    s_add_u32 s54, s54, s55
    s_lshl_b32 s53, s53, 18
    s_lshl_b32 s54, s54, 13
    s_add_u32 s53, s53, s54
    s_lshl_b32 s54, s26, 10
    s_add_u32 s53, s53, s54
    s_add_u32 s53, s53, 10747904
    v_lshlrev_b32 v28, 4, v1
    v_mov_b32 v24, -1
    v_mov_b32 v25, -1
    v_mov_b32 v26, -1
    v_mov_b32 v27, -1
    buffer_store_dwordx4 v[24:27], v28, s[36:39], s53 offen sc1
    v_add_u32 v11, 32768, v8
    v_add_u32 v12, 32768, v9
    v_add_u32 v13, 32768, v10
    v_mfma_f32_16x16x32_bf16 v[32:35], v[96:99], v[80:83], v[32:35]
    ds_read_b128 v[120:123], v11 offset:0
    ds_read_b128 v[128:131], v11 offset:2048
    v_mfma_f32_16x16x32_bf16 v[40:43], v[104:107], v[80:83], v[40:43]
    ds_read_b64_tr_b16 v[136:137], v13 offset:0
    ds_read_b64_tr_b16 v[138:139], v13 offset:512
    v_mfma_f32_16x16x32_bf16 v[48:51], v[80:83], v[112:115], v[48:51]
    ds_read_b64_tr_b16 v[144:145], v13 offset:8192
    ds_read_b64_tr_b16 v[146:147], v13 offset:8704
    v_mfma_f32_16x16x32_bf16 v[64:67], v[20:23], v[100:103], v[64:67]
    ds_read_b64_tr_b16 v[152:153], v13 offset:16384
    ds_read_b64_tr_b16 v[154:155], v13 offset:16896
    v_mfma_f32_16x16x32_bf16 v[36:39], v[96:99], v[88:91], v[36:39]
    ds_read_b128 v[124:127], v12 offset:0
    ds_read_b128 v[132:135], v12 offset:2048
    v_mfma_f32_16x16x32_bf16 v[44:47], v[104:107], v[88:91], v[44:47]
    ds_read_b64_tr_b16 v[140:141], v13 offset:4096
    ds_read_b64_tr_b16 v[142:143], v13 offset:4608
    v_mfma_f32_16x16x32_bf16 v[68:71], v[20:23], v[108:111], v[68:71]
    ds_read_b64_tr_b16 v[148:149], v13 offset:12288
    ds_read_b64_tr_b16 v[150:151], v13 offset:12800
    v_mfma_f32_16x16x32_bf16 v[52:55], v[88:91], v[112:115], v[52:55]
    ds_read_b64_tr_b16 v[156:157], v13 offset:20480
    ds_read_b64_tr_b16 v[158:159], v13 offset:20992
    v_mfma_f32_16x16x32_bf16 v[32:35], v[100:103], v[84:87], v[32:35]
    v_mfma_f32_16x16x32_bf16 v[40:43], v[108:111], v[84:87], v[40:43]
    v_mfma_f32_16x16x32_bf16 v[72:75], v[20:23], v[116:119], v[72:75]
    v_mfma_f32_16x16x32_bf16 v[48:51], v[84:87], v[116:119], v[48:51]
    s_waitcnt vmcnt(5) lgkmcnt(0)
    v_mfma_f32_16x16x32_bf16 v[36:39], v[100:103], v[92:95], v[36:39]
    v_mfma_f32_16x16x32_bf16 v[56:59], v[92:95], v[92:95], v[56:59]
    v_mfma_f32_16x16x32_bf16 v[44:47], v[108:111], v[92:95], v[44:47]
    v_mfma_f32_16x16x32_bf16 v[52:55], v[92:95], v[116:119], v[52:55]
    v_mfma_f32_16x16x32_bf16 v[60:63], v[92:95], v[20:23], v[60:63]
    s_barrier
    v_add_u32 v11, 65536, v8
    v_add_u32 v12, 65536, v9
    v_add_u32 v13, 65536, v10
    v_mfma_f32_16x16x32_bf16 v[32:35], v[136:139], v[120:123], v[32:35]
    ds_read_b128 v[80:83], v11 offset:0
    ds_read_b128 v[88:91], v11 offset:2048
    v_mfma_f32_16x16x32_bf16 v[40:43], v[144:147], v[120:123], v[40:43]
    ds_read_b64_tr_b16 v[96:97], v13 offset:0
    ds_read_b64_tr_b16 v[98:99], v13 offset:512
    v_mfma_f32_16x16x32_bf16 v[48:51], v[120:123], v[152:155], v[48:51]
    ds_read_b64_tr_b16 v[104:105], v13 offset:8192
    ds_read_b64_tr_b16 v[106:107], v13 offset:8704
    v_mfma_f32_16x16x32_bf16 v[64:67], v[20:23], v[140:143], v[64:67]
    ds_read_b64_tr_b16 v[112:113], v13 offset:16384
    ds_read_b64_tr_b16 v[114:115], v13 offset:16896
    v_mfma_f32_16x16x32_bf16 v[36:39], v[136:139], v[128:131], v[36:39]
    ds_read_b128 v[84:87], v12 offset:0
    ds_read_b128 v[92:95], v12 offset:2048
    v_mfma_f32_16x16x32_bf16 v[44:47], v[144:147], v[128:131], v[44:47]
    ds_read_b64_tr_b16 v[100:101], v13 offset:4096
    ds_read_b64_tr_b16 v[102:103], v13 offset:4608
    v_mfma_f32_16x16x32_bf16 v[68:71], v[20:23], v[148:151], v[68:71]
    ds_read_b64_tr_b16 v[108:109], v13 offset:12288
    ds_read_b64_tr_b16 v[110:111], v13 offset:12800
    v_mfma_f32_16x16x32_bf16 v[52:55], v[128:131], v[152:155], v[52:55]
    ds_read_b64_tr_b16 v[116:117], v13 offset:20480
    ds_read_b64_tr_b16 v[118:119], v13 offset:20992
    v_mfma_f32_16x16x32_bf16 v[32:35], v[140:143], v[124:127], v[32:35]
    v_mfma_f32_16x16x32_bf16 v[40:43], v[148:151], v[124:127], v[40:43]
    v_mfma_f32_16x16x32_bf16 v[72:75], v[20:23], v[156:159], v[72:75]
    v_mfma_f32_16x16x32_bf16 v[48:51], v[124:127], v[156:159], v[48:51]
    s_waitcnt vmcnt(1) lgkmcnt(0)
    v_mfma_f32_16x16x32_bf16 v[36:39], v[140:143], v[132:135], v[36:39]
    v_mfma_f32_16x16x32_bf16 v[56:59], v[132:135], v[132:135], v[56:59]
    v_mfma_f32_16x16x32_bf16 v[44:47], v[148:151], v[132:135], v[44:47]
    v_mfma_f32_16x16x32_bf16 v[52:55], v[132:135], v[156:159], v[52:55]
    v_mfma_f32_16x16x32_bf16 v[60:63], v[132:135], v[20:23], v[60:63]
    s_barrier
    v_add_u32 v11, 98304, v8
    v_add_u32 v12, 98304, v9
    v_add_u32 v13, 98304, v10
    v_mfma_f32_16x16x32_bf16 v[32:35], v[96:99], v[80:83], v[32:35]
    ds_read_b128 v[120:123], v11 offset:0
    v_mfma_f32_16x16x32_bf16 v[40:43], v[104:107], v[80:83], v[40:43]
    ds_read_b128 v[128:131], v11 offset:2048
    v_mfma_f32_16x16x32_bf16 v[48:51], v[80:83], v[112:115], v[48:51]
    ds_read_b64_tr_b16 v[136:137], v13 offset:0
    ds_read_b64_tr_b16 v[138:139], v13 offset:512
    v_mfma_f32_16x16x32_bf16 v[64:67], v[20:23], v[100:103], v[64:67]
    ds_read_b64_tr_b16 v[144:145], v13 offset:8192
    v_mfma_f32_16x16x32_bf16 v[36:39], v[96:99], v[88:91], v[36:39]
    ds_read_b64_tr_b16 v[146:147], v13 offset:8704
    ds_read_b64_tr_b16 v[152:153], v13 offset:16384
    v_mfma_f32_16x16x32_bf16 v[44:47], v[104:107], v[88:91], v[44:47]
    ds_read_b64_tr_b16 v[154:155], v13 offset:16896
    v_mfma_f32_16x16x32_bf16 v[68:71], v[20:23], v[108:111], v[68:71]
    ds_read_b128 v[124:127], v12 offset:0
    ds_read_b128 v[132:135], v12 offset:2048
    v_mfma_f32_16x16x32_bf16 v[52:55], v[88:91], v[112:115], v[52:55]
    ds_read_b64_tr_b16 v[140:141], v13 offset:4096
    v_mfma_f32_16x16x32_bf16 v[32:35], v[100:103], v[84:87], v[32:35]
    ds_read_b64_tr_b16 v[142:143], v13 offset:4608
    ds_read_b64_tr_b16 v[148:149], v13 offset:12288
    v_mfma_f32_16x16x32_bf16 v[40:43], v[108:111], v[84:87], v[40:43]
    ds_read_b64_tr_b16 v[150:151], v13 offset:12800
    v_mfma_f32_16x16x32_bf16 v[72:75], v[20:23], v[116:119], v[72:75]
    ds_read_b64_tr_b16 v[156:157], v13 offset:20480
    ds_read_b64_tr_b16 v[158:159], v13 offset:20992
    v_mfma_f32_16x16x32_bf16 v[48:51], v[84:87], v[116:119], v[48:51]
    v_mfma_f32_16x16x32_bf16 v[36:39], v[100:103], v[92:95], v[36:39]
    v_mfma_f32_16x16x32_bf16 v[56:59], v[92:95], v[92:95], v[56:59]
    v_mfma_f32_16x16x32_bf16 v[44:47], v[108:111], v[92:95], v[44:47]
    v_mfma_f32_16x16x32_bf16 v[52:55], v[92:95], v[116:119], v[52:55]
    v_mfma_f32_16x16x32_bf16 v[60:63], v[92:95], v[20:23], v[60:63]
    s_waitcnt lgkmcnt(0)
    v_mfma_f32_16x16x32_bf16 v[32:35], v[136:139], v[120:123], v[32:35]
    v_mfma_f32_16x16x32_bf16 v[40:43], v[144:147], v[120:123], v[40:43]
    v_mfma_f32_16x16x32_bf16 v[48:51], v[120:123], v[152:155], v[48:51]
    v_mfma_f32_16x16x32_bf16 v[64:67], v[20:23], v[140:143], v[64:67]
    v_mfma_f32_16x16x32_bf16 v[36:39], v[136:139], v[128:131], v[36:39]
    v_mfma_f32_16x16x32_bf16 v[44:47], v[144:147], v[128:131], v[44:47]
    v_mfma_f32_16x16x32_bf16 v[68:71], v[20:23], v[148:151], v[68:71]
    v_mfma_f32_16x16x32_bf16 v[52:55], v[128:131], v[152:155], v[52:55]
    v_mfma_f32_16x16x32_bf16 v[32:35], v[140:143], v[124:127], v[32:35]
    v_mfma_f32_16x16x32_bf16 v[40:43], v[148:151], v[124:127], v[40:43]
    v_mfma_f32_16x16x32_bf16 v[72:75], v[20:23], v[156:159], v[72:75]
    v_mfma_f32_16x16x32_bf16 v[48:51], v[124:127], v[156:159], v[48:51]
    v_mfma_f32_16x16x32_bf16 v[36:39], v[140:143], v[132:135], v[36:39]
    v_mfma_f32_16x16x32_bf16 v[56:59], v[132:135], v[132:135], v[56:59]
    v_mfma_f32_16x16x32_bf16 v[44:47], v[148:151], v[132:135], v[44:47]
    v_mfma_f32_16x16x32_bf16 v[52:55], v[132:135], v[156:159], v[52:55]
    v_mfma_f32_16x16x32_bf16 v[60:63], v[132:135], v[20:23], v[60:63]
L_k1_cj:
    v_and_b32 v5, 3, v1
    v_cmp_eq_u32 s[50:51], 1, v5
    v_cmp_eq_u32 s[56:57], 2, v5
    v_cmp_eq_u32 s[58:59], 3, v5
    v_lshrrev_b32 v7, 2, v3
    v_cmp_eq_u32 s[44:45], v4, v7
    s_and_b32 s46, s43, 1
    s_lshl_b32 s46, s46, 8
    s_lshl_b32 s47, s42, 7
    s_add_u32 s46, s46, s47
    s_lshr_b32 s47, s43, 1
    s_lshl_b32 s47, s47, 6
    s_add_u32 s46, s46, s47
    s_add_u32 s46, s46, 131072
    v_lshlrev_b32 v6, 2, v3
    v_add_u32 v7, s46, v6
    v_cndmask_b32 v76, v56, v57, s[50:51]
    v_cndmask_b32 v76, v76, v58, s[56:57]
    v_cndmask_b32 v76, v76, v59, s[58:59]
    v_cndmask_b32 v77, v60, v61, s[50:51]
    v_cndmask_b32 v77, v77, v62, s[56:57]
    v_cndmask_b32 v77, v77, v63, s[58:59]
    s_mov_b64 exec, s[44:45]
    ds_write_b32 v7, v77
    ds_write_b32 v7, v76 offset:512
    s_mov_b64 exec, 0xffff
    s_mul_i32 s46, s42, 768
    s_lshl_b32 s47, s43, 6
    s_add_u32 s46, s46, s47
    s_add_u32 s46, s46, 132096
    v_add_u32 v7, s46, v6
    ds_write_b32 v7, v64 offset:0
    ds_write_b32 v7, v68 offset:256
    ds_write_b32 v7, v72 offset:512
    s_mov_b64 exec, -1
    s_waitcnt lgkmcnt(0)
    s_barrier
    s_lshl_b32 s46, s42, 7
    s_add_u32 s46, s46, 131072
    v_add_u32 v7, s46, v6
    ds_read_b32 v80, v7 offset:0
    ds_read_b32 v81, v7 offset:256
    ds_read_b32 v82, v7 offset:512
    ds_read_b32 v83, v7 offset:768
    ds_read_b32 v84, v7 offset:64
    ds_read_b32 v85, v7 offset:320
    ds_read_b32 v86, v7 offset:576
    ds_read_b32 v87, v7 offset:832
    s_lshl_b32 s47, s43, 6
    s_add_u32 s47, s47, 132096
    v_lshlrev_b32 v5, 4, v4
    v_add_u32 v5, s47, v5
    ds_read_b128 v[88:91], v5
    ds_read_b128 v[92:95], v5 offset:256
    ds_read_b128 v[96:99], v5 offset:768
    ds_read_b128 v[100:103], v5 offset:1024
    v_add_u32 v5, s47, v6
    ds_read_b32 v104, v5 offset:512
    ds_read_b32 v105, v5 offset:1280
    s_waitcnt lgkmcnt(6)
    v_add_f32 v106, v80, v81
    v_add_f32 v108, v82, v83
    v_mul_f32 v106, 0x3b000000, v106
    v_mul_f32 v108, 0x3b000000, v108
    v_fma_f32 v108, -v106, v106, v108
    v_max_f32 v108, 0, v108
    v_add_f32 v108, 0x3727c5ac, v108
    v_rsq_f32 v108, v108
    v_add_f32 v107, v84, v85
    v_add_f32 v109, v86, v87
    v_mul_f32 v107, 0x3b000000, v107
    v_mul_f32 v109, 0x3b000000, v109
    v_fma_f32 v109, -v107, v107, v109
    v_max_f32 v109, 0, v109
    v_add_f32 v109, 0x3727c5ac, v109
    v_rsq_f32 v109, v109
    s_lshl_b32 s46, s26, 8
    s_add_u32 s46, s46, 133632
    v_add_u32 v7, s46, v6
    ds_write_b32 v7, v108
    ds_write_b32 v7, v109 offset:64
    ds_write_b32 v7, v106 offset:128
    ds_write_b32 v7, v107 offset:192
    v_lshlrev_b32 v5, 4, v4
    v_add_u32 v5, s46, v5
    s_waitcnt lgkmcnt(0)
    ds_read_b128 v[112:115], v5 offset:0
    ds_read_b128 v[120:123], v5 offset:128
    ds_read_b128 v[116:119], v5 offset:64
    ds_read_b128 v[124:127], v5 offset:192
    v_pk_add_f32 v[88:89], v[88:89], v[96:97]
    v_pk_add_f32 v[92:93], v[92:93], v[100:101]
    v_pk_add_f32 v[90:91], v[90:91], v[98:99]
    v_pk_add_f32 v[94:95], v[94:95], v[102:103]
    v_add_f32 v104, v104, v105
    s_mov_b32 s48, 0x3eb8aa3b
    v_mul_f32 v110, s48, v108
    v_mul_f32 v111, s48, v109
    s_lshl_b32 s45, s41, 1
    s_add_u32 s45, s45, s42
    s_lshl_b32 s50, s40, 2
    s_add_u32 s50, s50, s43
    s_lshl_b32 s46, s50, 16
    s_lshl_b32 s47, s45, 10
    s_add_u32 s46, s46, s47
    v_bfe_u32 v5, v1, 4, 1
    v_lshlrev_b32 v5, 9, v5
    v_lshrrev_b32 v7, 5, v1
    v_lshl_add_u32 v5, v7, 8, v5
    v_lshl_add_u32 v5, v3, 4, v5
    v_fma_f32 v136, -v106, v92, v40
    v_fma_f32 v137, -v106, v93, v41
    v_fma_f32 v138, -v106, v94, v42
    v_fma_f32 v139, -v106, v95, v43
    v_fma_f32 v140, -v107, v92, v44
    v_fma_f32 v141, -v107, v93, v45
    v_fma_f32 v142, -v107, v94, v46
    v_fma_f32 v143, -v107, v95, v47
    v_mul_f32 v136, v108, v136
    v_mul_f32 v137, v108, v137
    v_mul_f32 v138, v108, v138
    v_mul_f32 v139, v108, v139
    v_mul_f32 v140, v109, v140
    v_mul_f32 v141, v109, v141
    v_mul_f32 v142, v109, v142
    v_mul_f32 v143, v109, v143
    v_cvt_pk_bf16_f32 v148, v136, v137
    v_cvt_pk_bf16_f32 v149, v138, v139
    v_cvt_pk_bf16_f32 v150, v140, v141
    v_cvt_pk_bf16_f32 v151, v142, v143
    v_mul_f32 v76, v136, v136
    v_fmac_f32 v76, v137, v137
    v_fmac_f32 v76, v138, v138
    v_fmac_f32 v76, v139, v139
    v_mul_f32 v77, v140, v140
    v_fmac_f32 v77, v141, v141
    v_fmac_f32 v77, v142, v142
    v_fmac_f32 v77, v143, v143
    v_permlane32_swap_b32 v148, v150
    v_permlane32_swap_b32 v149, v151
    s_add_u32 s47, s46, 2097152
    buffer_store_dwordx4 v[148:151], v5, s[36:39], s47 offen sc1
    v_mov_b32 v78, v76
    v_mov_b32 v79, v77
    v_fma_f32 v128, -v106, v88, v32
    v_fma_f32 v129, -v106, v89, v33
    v_fma_f32 v130, -v106, v90, v34
    v_fma_f32 v131, -v106, v91, v35
    v_fma_f32 v132, -v107, v88, v36
    v_permlane32_swap_b32 v78, v76
    v_permlane32_swap_b32 v79, v77
    v_fma_f32 v133, -v107, v89, v37
    v_fma_f32 v134, -v107, v90, v38
    v_fma_f32 v135, -v107, v91, v39
    v_mul_f32 v128, v110, v128
    v_mul_f32 v129, v110, v129
    v_add_f32 v76, v76, v78
    v_add_f32 v77, v77, v79
    v_mul_f32 v130, v110, v130
    v_mul_f32 v131, v110, v131
    v_mul_f32 v132, v111, v132
    v_mul_f32 v133, v111, v133
    v_mul_f32 v134, v111, v134
    v_mov_b32 v78, v76
    v_mov_b32 v79, v77
    v_mul_f32 v135, v111, v135
    v_cvt_pk_bf16_f32 v144, v128, v129
    v_cvt_pk_bf16_f32 v145, v130, v131
    v_cvt_pk_bf16_f32 v146, v132, v133
    v_cvt_pk_bf16_f32 v147, v134, v135
    v_permlane16_swap_b32 v78, v76
    v_permlane16_swap_b32 v79, v77
    s_waitcnt lgkmcnt(0)
    v_fma_f32 v160, -v120, v104, v48
    v_fma_f32 v161, -v121, v104, v49
    v_fma_f32 v162, -v122, v104, v50
    v_fma_f32 v163, -v123, v104, v51
    v_add_f32 v76, v76, v78
    v_add_f32 v77, v77, v79
    v_fma_f32 v164, -v124, v104, v52
    v_fma_f32 v165, -v125, v104, v53
    v_fma_f32 v166, -v126, v104, v54
    v_fma_f32 v167, -v127, v104, v55
    v_permlane32_swap_b32 v144, v146
    v_max_f32 v76, v76, v77
    v_permlane32_swap_b32 v145, v147
    s_add_u32 s47, s46, 0
    buffer_store_dwordx4 v[144:147], v5, s[36:39], s47 offen sc1
    v_mul_f32 v160, v112, v160
    v_mul_f32 v161, v113, v161
    v_max_f32_dpp v76, v76, v76 row_shr:1 row_mask:0xf bank_mask:0xf
    v_mul_f32 v162, v114, v162
    v_mul_f32 v163, v115, v163
    v_mul_f32 v164, v116, v164
    v_mul_f32 v165, v117, v165
    v_mul_f32 v166, v118, v166
    v_max_f32_dpp v76, v76, v76 row_shr:2 row_mask:0xf bank_mask:0xf
    v_mul_f32 v167, v119, v167
    v_cvt_pk_bf16_f32 v152, v160, v161
    v_cvt_pk_bf16_f32 v153, v162, v163
    v_cvt_pk_bf16_f32 v154, v164, v165
    v_cvt_pk_bf16_f32 v155, v166, v167
    v_max_f32_dpp v76, v76, v76 row_shr:4 row_mask:0xf bank_mask:0xf
    v_bfe_u32 v6, v1, 4, 1
    v_lshlrev_b32 v6, 8, v6
    v_lshrrev_b32 v7, 5, v1
    v_lshl_add_u32 v6, v7, 9, v6
    v_lshl_add_u32 v6, v3, 4, v6
    v_max_f32_dpp v76, v76, v76 row_shr:8 row_mask:0xf bank_mask:0xf
    v_permlane32_swap_b32 v152, v154
    v_permlane32_swap_b32 v153, v155
    s_add_u32 s47, s46, 4194304
    buffer_store_dwordx4 v[152:155], v6, s[36:39], s47 offen sc1
    v_max_f32_dpp v76, v76, v76 row_bcast:15 row_mask:0xa bank_mask:0xf
    s_nop 1
    v_max_f32_dpp v76, v76, v76 row_bcast:31 row_mask:0xc bank_mask:0xf
    s_nop 1
    s_mov_b32 exec_lo, 0
    s_mov_b32 exec_hi, 0x80000000
    s_lshl_b32 s47, s50, 8
    s_add_u32 s47, s47, 14483456
    v_mov_b32 v7, 0
    buffer_atomic_umax v76, v7, s[36:39], s47 offen
    s_mov_b64 exec, -1
    s_waitcnt vmcnt(0)
    s_barrier
    s_lshl_b32 s44, s40, 11
    s_add_u32 s44, s44, 14417920
    s_cmp_lg_u32 s26, 0
    s_cbranch_scc1 L_sig_4
    s_mov_b64 exec, 255
    v_lshlrev_b32 v2, 8, v1
    v_mov_b32 v3, 1
    buffer_atomic_add v3, v2, s[36:39], s44 offen
    s_mov_b64 exec, -1
L_sig_4:
    s_and_b32 s43, s3, 1
    s_lshl_b32 s43, s43, 3
    s_add_u32 s43, s43, s27
    s_lshl_b32 s40, s43, 1
    s_bfe_u32 s44, s3, 0x10001
    s_add_u32 s40, s40, s44
    s_lshr_b32 s42, s3, 2
    s_lshl_b32 s41, s42, 3
    s_add_u32 s41, s41, s26
    s_mov_b32 s101, s27
    s_mov_b32 s97, s3
    s_cmp_lt_u32 s3, 29
    s_cselect_b32 s98, 1, 0
    s_mul_i32 s46, s26, 88064
    s_mul_i32 s47, s97, 96
    s_add_u32 s93, s46, s47
    v_add_u32 v114, 0, v1
    v_mul_u32_u24 v115, 43691, v114
    v_lshrrev_b32 v115, 18, v115
    v_mul_u32_u24 v116, 6, v115
    v_sub_u32 v116, v114, v116
    v_mul_u32_u24 v115, 2752, v115
    v_lshl_add_u32 v117, v116, 4, v115
    v_add_u32 v114, 64, v1
    v_mul_u32_u24 v115, 43691, v114
    v_lshrrev_b32 v115, 18, v115
    v_mul_u32_u24 v116, 6, v115
    v_sub_u32 v116, v114, v116
    v_mul_u32_u24 v115, 2752, v115
    v_lshl_add_u32 v118, v116, 4, v115
    v_add_u32 v114, 128, v1
    v_mul_u32_u24 v115, 43691, v114
    v_lshrrev_b32 v115, 18, v115
    v_mul_u32_u24 v116, 6, v115
    v_sub_u32 v116, v114, v116
    v_mul_u32_u24 v115, 2752, v115
    v_lshl_add_u32 v119, v116, 4, v115
    s_mov_b32 s28, s12
    s_and_b32 s29, s13, 0xffff
    s_mov_b32 s30, 0x560000
    s_mov_b32 s31, 0x20000
    s_mov_b32 s99, s98
    s_mov_b32 s52, s4
    s_and_b32 s53, s5, 0xffff
    s_mov_b32 s54, 0x200000
    s_mov_b32 s55, 0x20000
    s_and_b32 s44, s27, 1
    s_lshl_b32 s44, s44, 2
    s_and_b32 s46, s3, 3
    s_add_u32 s44, s44, s46
    s_lshr_b32 s46, s27, 1
    s_lshl_b32 s46, s46, 3
    s_lshr_b32 s47, s3, 2
    s_add_u32 s46, s46, s47
    s_lshl_b32 s46, s46, 16
    s_bfe_u32 s47, s26, 0x10001
    s_lshl_b32 s47, s47, 15
    s_add_u32 s46, s46, s47
    s_lshl_b32 s44, s44, 7
    s_add_u32 s46, s46, s44
    s_and_b32 s47, s26, 1
    s_lshl_b32 s47, s47, 6
    s_add_u32 s92, s46, s47
    v_and_b32 v120, 31, v1
    v_lshlrev_b32 v120, 10, v120
    v_lshrrev_b32 v121, 5, v1
    v_lshl_add_u32 v120, v121, 3, v120
    v_lshlrev_b32 v4, 4, v1
    v_mov_b32 v5, v4
    v_and_b32 v7, 15, v1
    v_lshlrev_b32 v6, 4, v7
    v_lshrrev_b32 v7, 5, v1
    v_lshl_add_u32 v6, v7, 8, v6
    v_add_u32 v6, 65536, v6
    v_and_b32 v7, 27, v1
    v_cmp_eq_u32 vcc, 16, v7
    v_mov_b32 v7, 0x3f803f80
    v_mov_b32 v2, 0
    v_mov_b32 v101, 131072
    v_cndmask_b32 v7, 0, v7, vcc
    ds_write_b32 v101, v2
    ds_write_b32 v101, v2 offset:4
    s_mov_b32 s50, 0x0000ffff
    s_mov_b32 s51, 0x0000ffff
    v_mov_b32 v92, v7
    v_mov_b32 v96, v7
    v_mov_b32 v93, v7
    v_mov_b32 v97, v7
    v_mov_b32 v94, v7
    v_mov_b32 v98, v7
    v_mov_b32 v95, v7
    v_mov_b32 v99, v7
    v_mov_b32 v72, 0
    v_mov_b32 v73, 0
    v_mov_b32 v74, 0
    v_mov_b32 v75, 0
    v_mov_b32 v76, 0
    v_mov_b32 v77, 0
    v_mov_b32 v78, 0
    v_mov_b32 v79, 0
    v_mov_b32 v80, 0
    v_mov_b32 v81, 0
    v_mov_b32 v82, 0
    v_mov_b32 v83, 0
    v_mov_b32 v84, 0
    v_mov_b32 v85, 0
    v_mov_b32 v86, 0
    v_mov_b32 v87, 0
    v_mov_b32 v64, 0
    v_mov_b32 v65, 0
    v_mov_b32 v66, 0
    v_mov_b32 v67, 0
    v_mov_b32 v68, 0
    v_mov_b32 v69, 0
    v_mov_b32 v70, 0
    v_mov_b32 v71, 0
    v_mov_b32 v102, 0
    global_load_dword v103, v102, s[22:23] sc1
    s_lshr_b32 s43, s43, 1
    s_lshl_b32 s44, s43, 11
    s_add_u32 s44, s44, 14417920
    s_waitcnt lgkmcnt(0)
    s_cmp_lg_u32 s26, 0
    s_cbranch_scc1 L_w_5
    s_mov_b64 exec, 1
    s_lshl_b32 s56, s27, 0
    s_xor_b32 s56, s56, s3
    s_and_b32 s56, s56, 7
    s_lshl_b32 s56, s56, 8
    v_mov_b32 v2, s56
    s_mov_b32 s57, 0
L_wp_6:
    buffer_load_dword v3, v2, s[36:39], s44 offen sc1
    s_waitcnt vmcnt(0)
    v_readfirstlane_b32 s56, v3
    s_add_u32 s57, s57, 1
    s_cmp_ge_u32 s56, 32
    s_cbranch_scc1 L_wd_7
    s_cmp_gt_u32 s57, 30000
    s_cbranch_scc1 L_wd_7
    s_sleep 1
    s_branch L_wp_6
L_wd_7:
    s_mov_b64 exec, -1
L_w_5:
    s_barrier
    s_lshl_b32 s45, s40, 16
    s_lshl_b32 s43, s41, 10
    s_add_u32 s43, s43, s45
    s_add_u32 s43, s43, 0
    buffer_load_dwordx4 v[8:11], v4, s[36:39], s43 offen sc1
    v_mov_b32 v7, 0
    s_lshl_b32 s43, s40, 8
    s_add_u32 s43, s43, 14483456
    buffer_load_dword v100, v7, s[36:39], s43 offen sc1
    s_add_u32 s44, s45, 2097152
    s_add_u32 s46, s45, 4194304
    s_lshl_b32 s45, s26, 11
    s_add_u32 m0, s45, 0
    s_add_u32 s47, s45, 0
    s_add_u32 s47, s47, s44
    buffer_load_dwordx4 v4, s[36:39], s47 offen sc1 lds
    s_add_u32 m0, s45, 65536
    s_add_u32 s47, s45, 0
    s_add_u32 s47, s47, s46
    buffer_load_dwordx4 v4, s[36:39], s47 offen sc1 lds
    s_add_u32 m0, s45, 1024
    s_add_u32 s47, s45, 1024
    s_add_u32 s47, s47, s44
    buffer_load_dwordx4 v4, s[36:39], s47 offen sc1 lds
    s_add_u32 m0, s45, 66560
    s_add_u32 s47, s45, 1024
    s_add_u32 s47, s47, s46
    buffer_load_dwordx4 v4, s[36:39], s47 offen sc1 lds
    s_waitcnt vmcnt(4)
    v_readfirstlane_b32 s96, v103
    v_lshlrev_b32 v108, 16, v8
    v_and_b32 v109, 0xffff0000, v8
    v_lshlrev_b32 v110, 16, v9
    v_and_b32 v111, 0xffff0000, v9
    v_lshlrev_b32 v112, 16, v10
    v_and_b32 v113, 0xffff0000, v10
    v_lshlrev_b32 v114, 16, v11
    v_and_b32 v115, 0xffff0000, v11
    v_mul_f32 v7, v108, v108
    v_fmac_f32 v7, v109, v109
    v_fmac_f32 v7, v110, v110
    v_fmac_f32 v7, v111, v111
    v_fmac_f32 v7, v112, v112
    v_fmac_f32 v7, v113, v113
    v_fmac_f32 v7, v114, v114
    v_fmac_f32 v7, v115, v115
    v_mov_b32 v2, v7
    s_nop 1
    v_permlane32_swap_b32 v2, v7
    s_nop 1
    v_add_f32 v7, v7, v2
    v_mul_f32 v7, v100, v7
    v_sqrt_f32 v7, v7
    s_nop 0
    v_mul_f32 v7, 0x3f828f5c, v7
    v_cmp_lt_f32 vcc, 0x42200000, v7
    s_nop 1
    s_mov_b64 s[56:57], vcc
    s_waitcnt vmcnt(0)
    s_barrier
    s_mov_b32 s49, 0
    s_cmp_ge_u32 s26, 4
    s_cbranch_scc1 L_att_iss
    s_mov_b32 s49, 1
    s_branch L_att_noiss
L_att_iss:
    s_setprio 1
    s_and_b32 s45, s26, 3
    s_lshl_b32 s45, s45, 12
    s_add_u32 m0, s45, 16384
    s_add_u32 s47, s45, 16384
    s_add_u32 s47, s47, s44
    buffer_load_dwordx4 v4, s[36:39], s47 offen sc1 lds
    s_add_u32 m0, s45, 81920
    s_add_u32 s47, s45, 16384
    s_add_u32 s47, s47, s46
    buffer_load_dwordx4 v4, s[36:39], s47 offen sc1 lds
    s_add_u32 m0, s45, 17408
    s_add_u32 s47, s45, 17408
    s_add_u32 s47, s47, s44
    buffer_load_dwordx4 v4, s[36:39], s47 offen sc1 lds
    s_add_u32 m0, s45, 82944
    s_add_u32 s47, s45, 17408
    s_add_u32 s47, s47, s46
    buffer_load_dwordx4 v4, s[36:39], s47 offen sc1 lds
    s_add_u32 m0, s45, 18432
    s_add_u32 s47, s45, 18432
    s_add_u32 s47, s47, s44
    buffer_load_dwordx4 v4, s[36:39], s47 offen sc1 lds
    s_add_u32 m0, s45, 83968
    s_add_u32 s47, s45, 18432
    s_add_u32 s47, s47, s46
    buffer_load_dwordx4 v4, s[36:39], s47 offen sc1 lds
    s_add_u32 m0, s45, 19456
    s_add_u32 s47, s45, 19456
    s_add_u32 s47, s47, s44
    buffer_load_dwordx4 v4, s[36:39], s47 offen sc1 lds
    s_add_u32 m0, s45, 84992
    s_add_u32 s47, s45, 19456
    s_add_u32 s47, s47, s46
    buffer_load_dwordx4 v4, s[36:39], s47 offen sc1 lds
    s_add_u32 m0, s45, 32768
    s_add_u32 s47, s45, 32768
    s_add_u32 s47, s47, s44
    buffer_load_dwordx4 v4, s[36:39], s47 offen sc1 lds
    s_add_u32 m0, s45, 98304
    s_add_u32 s47, s45, 32768
    s_add_u32 s47, s47, s46
    buffer_load_dwordx4 v4, s[36:39], s47 offen sc1 lds
    s_add_u32 m0, s45, 33792
    s_add_u32 s47, s45, 33792
    s_add_u32 s47, s47, s44
    buffer_load_dwordx4 v4, s[36:39], s47 offen sc1 lds
    s_add_u32 m0, s45, 99328
    s_add_u32 s47, s45, 33792
    s_add_u32 s47, s47, s46
    buffer_load_dwordx4 v4, s[36:39], s47 offen sc1 lds
    s_add_u32 m0, s45, 34816
    s_add_u32 s47, s45, 34816
    s_add_u32 s47, s47, s44
    buffer_load_dwordx4 v4, s[36:39], s47 offen sc1 lds
    s_add_u32 m0, s45, 100352
    s_add_u32 s47, s45, 34816
    s_add_u32 s47, s47, s46
    buffer_load_dwordx4 v4, s[36:39], s47 offen sc1 lds
    s_add_u32 m0, s45, 35840
    s_add_u32 s47, s45, 35840
    s_add_u32 s47, s47, s44
    buffer_load_dwordx4 v4, s[36:39], s47 offen sc1 lds
    s_add_u32 m0, s45, 101376
    s_add_u32 s47, s45, 35840
    s_add_u32 s47, s47, s46
    buffer_load_dwordx4 v4, s[36:39], s47 offen sc1 lds
    s_add_u32 m0, s45, 49152
    s_add_u32 s47, s45, 49152
    s_add_u32 s47, s47, s44
    buffer_load_dwordx4 v4, s[36:39], s47 offen sc1 lds
    s_add_u32 m0, s45, 114688
    s_add_u32 s47, s45, 49152
    s_add_u32 s47, s47, s46
    buffer_load_dwordx4 v4, s[36:39], s47 offen sc1 lds
    s_add_u32 m0, s45, 50176
    s_add_u32 s47, s45, 50176
    s_add_u32 s47, s47, s44
    buffer_load_dwordx4 v4, s[36:39], s47 offen sc1 lds
    s_add_u32 m0, s45, 115712
    s_add_u32 s47, s45, 50176
    s_add_u32 s47, s47, s46
    buffer_load_dwordx4 v4, s[36:39], s47 offen sc1 lds
    s_add_u32 m0, s45, 51200
    s_add_u32 s47, s45, 51200
    s_add_u32 s47, s47, s44
    buffer_load_dwordx4 v4, s[36:39], s47 offen sc1 lds
    s_add_u32 m0, s45, 116736
    s_add_u32 s47, s45, 51200
    s_add_u32 s47, s47, s46
    buffer_load_dwordx4 v4, s[36:39], s47 offen sc1 lds
    s_add_u32 m0, s45, 52224
    s_add_u32 s47, s45, 52224
    s_add_u32 s47, s47, s44
    buffer_load_dwordx4 v4, s[36:39], s47 offen sc1 lds
    s_add_u32 m0, s45, 117760
    s_add_u32 s47, s45, 52224
    s_add_u32 s47, s47, s46
    buffer_load_dwordx4 v4, s[36:39], s47 offen sc1 lds
L_att_noiss:
    s_cmp_eq_u64 s[56:57], 0
    s_cbranch_scc1 L_att_fast
    s_cmp_lg_u32 s49, 0
    s_cbranch_scc1 L_sl_8
    s_waitcnt vmcnt(0)
    s_mov_b64 exec, 1
    v_mov_b32 v2, 1
    ds_add_u32 v101, v2
    s_mov_b64 exec, -1
    s_mov_b32 s49, 1
L_sl_8:
    s_mov_b32 s47, 0
L_sp_9:
    ds_read_b32 v2, v101
    s_waitcnt lgkmcnt(0)
    v_readfirstlane_b32 s48, v2
    s_add_u32 s47, s47, 1
    s_cmp_gt_u32 s47, 600000
    s_cbranch_scc1 L_spx_10
    s_cmp_lt_u32 s48, 4
    s_cbranch_scc1 L_sp_9
L_spx_10:
    v_mov_b32 v7, 0xff800000
    v_mov_b32 v2, v5
    s_mov_b32 s58, 0
L_att_p1:
    ds_read_b128 v[88:91], v2
    v_add_u32 v2, 1024, v2
    s_waitcnt lgkmcnt(0)
    v_mfma_f32_32x32x16_bf16 v[32:47], v[88:91], v[8:11], 0
    s_nop 7
    s_nop 3
    v_max3_f32 v7, v7, v32, v33
    v_max3_f32 v7, v7, v34, v35
    v_max3_f32 v7, v7, v36, v37
    v_max3_f32 v7, v7, v38, v39
    v_max3_f32 v7, v7, v40, v41
    v_max3_f32 v7, v7, v42, v43
    v_max3_f32 v7, v7, v44, v45
    v_max3_f32 v7, v7, v46, v47
    s_add_u32 s58, s58, 1
    s_cmp_lt_u32 s58, 64
    s_cbranch_scc1 L_att_p1
    v_mov_b32 v2, v7
    s_nop 1
    v_permlane32_swap_b32 v2, v7
    s_nop 1
    v_max_f32 v7, v7, v2
L_att_fast:
    v_sub_f32 v16, 0, v7
    v_sub_f32 v17, 0, v7
    v_sub_f32 v18, 0, v7
    v_sub_f32 v19, 0, v7
    v_sub_f32 v20, 0, v7
    v_sub_f32 v21, 0, v7
    v_sub_f32 v22, 0, v7
    v_sub_f32 v23, 0, v7
    v_sub_f32 v24, 0, v7
    v_sub_f32 v25, 0, v7
    v_sub_f32 v26, 0, v7
    v_sub_f32 v27, 0, v7
    v_sub_f32 v28, 0, v7
    v_sub_f32 v29, 0, v7
    v_sub_f32 v30, 0, v7
    v_sub_f32 v31, 0, v7
    ds_read_b128 v[88:91], v5
    s_waitcnt lgkmcnt(0)
    v_mfma_f32_32x32x16_bf16 v[32:47], v[88:91], v[8:11], v[16:31]
    ds_read_b128 v[88:91], v5 offset:1024
    s_mov_b64 exec, s[50:51]
    ds_read_b128 v[92:95], v6
    s_mov_b64 exec, -1
    s_mov_b32 s58, 0
    s_nop 7
.p2align 6
    v_exp_f32 v32, v32
    v_exp_f32 v33, v33
    s_mov_b64 exec, s[50:51]
    ds_read_b128 v[96:99], v6 offset:512
    s_mov_b64 exec, -1
    v_exp_f32 v34, v34
    v_exp_f32 v35, v35
    v_exp_f32 v36, v36
    v_exp_f32 v37, v37
    s_waitcnt lgkmcnt(2)
    v_mfma_f32_32x32x16_bf16 v[48:63], v[88:91], v[8:11], v[16:31]
    ds_read_b128 v[88:91], v5 offset:2048
    v_exp_f32 v38, v38
    v_exp_f32 v39, v39
    v_cvt_pk_bf16_f32 v64, v32, v33
    v_cvt_pk_bf16_f32 v65, v34, v35
    v_cvt_pk_bf16_f32 v66, v36, v37
    v_cvt_pk_bf16_f32 v67, v38, v39
    v_exp_f32 v40, v40
    v_exp_f32 v41, v41
    s_waitcnt lgkmcnt(2)
    v_mfma_f32_32x32x16_bf16 v[72:87], v[92:95], v[64:67], v[72:87]
    s_mov_b64 exec, s[50:51]
    ds_read_b128 v[92:95], v6 offset:1024
    s_mov_b64 exec, -1
    v_exp_f32 v42, v42
    v_exp_f32 v43, v43
    v_exp_f32 v44, v44
    v_exp_f32 v45, v45
    v_exp_f32 v46, v46
    v_exp_f32 v47, v47
    v_cvt_pk_bf16_f32 v68, v40, v41
    v_cvt_pk_bf16_f32 v69, v42, v43
    v_cvt_pk_bf16_f32 v70, v44, v45
    v_cvt_pk_bf16_f32 v71, v46, v47
    v_exp_f32 v48, v48
    v_exp_f32 v49, v49
    s_waitcnt lgkmcnt(2)
    v_mfma_f32_32x32x16_bf16 v[72:87], v[96:99], v[68:71], v[72:87]
    s_mov_b64 exec, s[50:51]
    ds_read_b128 v[96:99], v6 offset:1536
    s_mov_b64 exec, -1
    v_exp_f32 v50, v50
    v_exp_f32 v51, v51
    v_exp_f32 v52, v52
    v_exp_f32 v53, v53
    s_waitcnt lgkmcnt(2)
    v_mfma_f32_32x32x16_bf16 v[32:47], v[88:91], v[8:11], v[16:31]
    ds_read_b128 v[88:91], v5 offset:3072
    v_exp_f32 v54, v54
    v_exp_f32 v55, v55
    v_cvt_pk_bf16_f32 v64, v48, v49
    v_cvt_pk_bf16_f32 v65, v50, v51
    v_cvt_pk_bf16_f32 v66, v52, v53
    v_cvt_pk_bf16_f32 v67, v54, v55
    v_exp_f32 v56, v56
    v_exp_f32 v57, v57
    s_waitcnt lgkmcnt(2)
    v_mfma_f32_32x32x16_bf16 v[72:87], v[92:95], v[64:67], v[72:87]
    s_mov_b64 exec, s[50:51]
    ds_read_b128 v[92:95], v6 offset:2048
    s_mov_b64 exec, -1
    v_exp_f32 v58, v58
    v_exp_f32 v59, v59
    v_exp_f32 v60, v60
    v_exp_f32 v61, v61
    v_exp_f32 v62, v62
    v_exp_f32 v63, v63
    v_cvt_pk_bf16_f32 v68, v56, v57
    v_cvt_pk_bf16_f32 v69, v58, v59
    v_cvt_pk_bf16_f32 v70, v60, v61
    v_cvt_pk_bf16_f32 v71, v62, v63
    v_exp_f32 v32, v32
    v_exp_f32 v33, v33
    s_waitcnt lgkmcnt(2)
    v_mfma_f32_32x32x16_bf16 v[72:87], v[96:99], v[68:71], v[72:87]
    s_mov_b64 exec, s[50:51]
    ds_read_b128 v[96:99], v6 offset:2560
    s_mov_b64 exec, -1
    v_exp_f32 v34, v34
    v_exp_f32 v35, v35
    v_exp_f32 v36, v36
    v_exp_f32 v37, v37
    s_waitcnt lgkmcnt(2)
    v_mfma_f32_32x32x16_bf16 v[48:63], v[88:91], v[8:11], v[16:31]
    ds_read_b128 v[88:91], v5 offset:4096
    v_exp_f32 v38, v38
    v_exp_f32 v39, v39
    v_cvt_pk_bf16_f32 v64, v32, v33
    v_cvt_pk_bf16_f32 v65, v34, v35
    v_cvt_pk_bf16_f32 v66, v36, v37
    v_cvt_pk_bf16_f32 v67, v38, v39
    v_exp_f32 v40, v40
    v_exp_f32 v41, v41
    s_waitcnt lgkmcnt(2)
    v_mfma_f32_32x32x16_bf16 v[72:87], v[92:95], v[64:67], v[72:87]
    s_mov_b64 exec, s[50:51]
    ds_read_b128 v[92:95], v6 offset:3072
    s_mov_b64 exec, -1
    v_exp_f32 v42, v42
    v_exp_f32 v43, v43
    v_exp_f32 v44, v44
    v_exp_f32 v45, v45
    v_exp_f32 v46, v46
    v_exp_f32 v47, v47
    v_cvt_pk_bf16_f32 v68, v40, v41
    v_cvt_pk_bf16_f32 v69, v42, v43
    v_cvt_pk_bf16_f32 v70, v44, v45
    v_cvt_pk_bf16_f32 v71, v46, v47
    v_exp_f32 v48, v48
    v_exp_f32 v49, v49
    s_waitcnt lgkmcnt(2)
    v_mfma_f32_32x32x16_bf16 v[72:87], v[96:99], v[68:71], v[72:87]
    s_mov_b64 exec, s[50:51]
    ds_read_b128 v[96:99], v6 offset:3584
    s_mov_b64 exec, -1
    v_exp_f32 v50, v50
    v_exp_f32 v51, v51
    v_exp_f32 v52, v52
    v_exp_f32 v53, v53
    s_waitcnt lgkmcnt(2)
    v_mfma_f32_32x32x16_bf16 v[32:47], v[88:91], v[8:11], v[16:31]
    ds_read_b128 v[88:91], v5 offset:5120
    v_exp_f32 v54, v54
    v_exp_f32 v55, v55
    v_cvt_pk_bf16_f32 v64, v48, v49
    v_cvt_pk_bf16_f32 v65, v50, v51
    v_cvt_pk_bf16_f32 v66, v52, v53
    v_cvt_pk_bf16_f32 v67, v54, v55
    v_exp_f32 v56, v56
    v_exp_f32 v57, v57
    s_waitcnt lgkmcnt(2)
    v_mfma_f32_32x32x16_bf16 v[72:87], v[92:95], v[64:67], v[72:87]
    s_mov_b64 exec, s[50:51]
    ds_read_b128 v[92:95], v6 offset:4096
    s_mov_b64 exec, -1
    v_exp_f32 v58, v58
    v_exp_f32 v59, v59
    v_exp_f32 v60, v60
    v_exp_f32 v61, v61
    v_exp_f32 v62, v62
    v_exp_f32 v63, v63
    v_cvt_pk_bf16_f32 v68, v56, v57
    v_cvt_pk_bf16_f32 v69, v58, v59
    v_cvt_pk_bf16_f32 v70, v60, v61
    v_cvt_pk_bf16_f32 v71, v62, v63
    v_exp_f32 v32, v32
    v_exp_f32 v33, v33
    s_waitcnt lgkmcnt(2)
    v_mfma_f32_32x32x16_bf16 v[72:87], v[96:99], v[68:71], v[72:87]
    s_mov_b64 exec, s[50:51]
    ds_read_b128 v[96:99], v6 offset:4608
    s_mov_b64 exec, -1
    v_exp_f32 v34, v34
    v_exp_f32 v35, v35
    v_exp_f32 v36, v36
    v_exp_f32 v37, v37
    s_cmp_lg_u32 s49, 0
    s_cbranch_scc1 L_sl_11
    s_waitcnt vmcnt(0)
    s_mov_b64 exec, 1
    v_mov_b32 v2, 1
    ds_add_u32 v101, v2
    s_mov_b64 exec, -1
    s_mov_b32 s49, 1
L_sl_11:
    s_waitcnt lgkmcnt(2)
    v_mfma_f32_32x32x16_bf16 v[48:63], v[88:91], v[8:11], v[16:31]
    ds_read_b128 v[88:91], v5 offset:6144
    v_exp_f32 v38, v38
    v_exp_f32 v39, v39
    v_cvt_pk_bf16_f32 v64, v32, v33
    v_cvt_pk_bf16_f32 v65, v34, v35
    v_cvt_pk_bf16_f32 v66, v36, v37
    v_cvt_pk_bf16_f32 v67, v38, v39
    v_exp_f32 v40, v40
    v_exp_f32 v41, v41
    s_waitcnt lgkmcnt(2)
    v_mfma_f32_32x32x16_bf16 v[72:87], v[92:95], v[64:67], v[72:87]
    s_mov_b64 exec, s[50:51]
    ds_read_b128 v[92:95], v6 offset:5120
    s_mov_b64 exec, -1
    v_exp_f32 v42, v42
    v_exp_f32 v43, v43
    v_exp_f32 v44, v44
    v_exp_f32 v45, v45
    v_exp_f32 v46, v46
    v_exp_f32 v47, v47
    v_cvt_pk_bf16_f32 v68, v40, v41
    v_cvt_pk_bf16_f32 v69, v42, v43
    v_cvt_pk_bf16_f32 v70, v44, v45
    v_cvt_pk_bf16_f32 v71, v46, v47
    v_exp_f32 v48, v48
    v_exp_f32 v49, v49
    s_waitcnt lgkmcnt(2)
    v_mfma_f32_32x32x16_bf16 v[72:87], v[96:99], v[68:71], v[72:87]
    s_mov_b64 exec, s[50:51]
    ds_read_b128 v[96:99], v6 offset:5632
    s_mov_b64 exec, -1
    v_exp_f32 v50, v50
    v_exp_f32 v51, v51
    v_exp_f32 v52, v52
    v_exp_f32 v53, v53
    s_cmp_lg_u32 s26, 7
    s_cbranch_scc1 L_pf7_12
    s_lshl_b32 s43, s42, 18
    s_lshl_b32 s47, s40, 10
    s_add_u32 s43, s43, s47
    s_add_u32 s43, s43, 6553600
    v_mov_b32 v124, -1
    v_mov_b32 v125, -1
    v_mov_b32 v126, -1
    v_mov_b32 v127, -1
    buffer_store_dwordx4 v[124:127], v4, s[36:39], s43 offen sc1
    s_add_u32 s43, s43, 32768
    buffer_store_dwordx4 v[124:127], v4, s[36:39], s43 offen sc1
    s_add_u32 s43, s43, 32768
    buffer_store_dwordx4 v[124:127], v4, s[36:39], s43 offen sc1
    s_add_u32 s43, s43, 32768
    buffer_store_dwordx4 v[124:127], v4, s[36:39], s43 offen sc1
    s_add_u32 s43, s43, 32768
    buffer_store_dwordx4 v[124:127], v4, s[36:39], s43 offen sc1
    s_add_u32 s43, s43, 32768
    buffer_store_dwordx4 v[124:127], v4, s[36:39], s43 offen sc1
    s_add_u32 s43, s43, 32768
    buffer_store_dwordx4 v[124:127], v4, s[36:39], s43 offen sc1
    s_add_u32 s43, s43, 32768
    buffer_store_dwordx4 v[124:127], v4, s[36:39], s43 offen sc1
L_pf7_12:
    s_waitcnt lgkmcnt(2)
    v_mfma_f32_32x32x16_bf16 v[32:47], v[88:91], v[8:11], v[16:31]
    ds_read_b128 v[88:91], v5 offset:7168
    v_exp_f32 v54, v54
    v_exp_f32 v55, v55
    v_cvt_pk_bf16_f32 v64, v48, v49
    v_cvt_pk_bf16_f32 v65, v50, v51
    v_cvt_pk_bf16_f32 v66, v52, v53
    v_cvt_pk_bf16_f32 v67, v54, v55
    v_exp_f32 v56, v56
    v_exp_f32 v57, v57
    s_waitcnt lgkmcnt(2)
    v_mfma_f32_32x32x16_bf16 v[72:87], v[92:95], v[64:67], v[72:87]
    s_mov_b64 exec, s[50:51]
    ds_read_b128 v[92:95], v6 offset:6144
    s_mov_b64 exec, -1
    v_exp_f32 v58, v58
    v_exp_f32 v59, v59
    v_exp_f32 v60, v60
    v_exp_f32 v61, v61
    v_exp_f32 v62, v62
    v_exp_f32 v63, v63
    v_cvt_pk_bf16_f32 v68, v56, v57
    v_cvt_pk_bf16_f32 v69, v58, v59
    v_cvt_pk_bf16_f32 v70, v60, v61
    v_cvt_pk_bf16_f32 v71, v62, v63
    v_exp_f32 v32, v32
    v_exp_f32 v33, v33
    s_waitcnt lgkmcnt(2)
    v_mfma_f32_32x32x16_bf16 v[72:87], v[96:99], v[68:71], v[72:87]
    s_mov_b64 exec, s[50:51]
    ds_read_b128 v[96:99], v6 offset:6656
    s_mov_b64 exec, -1
    v_exp_f32 v34, v34
    v_exp_f32 v35, v35
    v_exp_f32 v36, v36
    v_exp_f32 v37, v37
    s_add_u32 s43, s93, 0
    buffer_load_dwordx4 v[128:131], v117, s[28:31], s43 offen
    s_waitcnt lgkmcnt(2)
    v_mfma_f32_32x32x16_bf16 v[48:63], v[88:91], v[8:11], v[16:31]
    ds_read_b128 v[88:91], v5 offset:8192
    v_exp_f32 v38, v38
    v_exp_f32 v39, v39
    v_cvt_pk_bf16_f32 v64, v32, v33
    v_cvt_pk_bf16_f32 v65, v34, v35
    v_cvt_pk_bf16_f32 v66, v36, v37
    v_cvt_pk_bf16_f32 v67, v38, v39
    v_exp_f32 v40, v40
    v_exp_f32 v41, v41
    s_waitcnt lgkmcnt(2)
    v_mfma_f32_32x32x16_bf16 v[72:87], v[92:95], v[64:67], v[72:87]
    s_mov_b64 exec, s[50:51]
    ds_read_b128 v[92:95], v6 offset:7168
    s_mov_b64 exec, -1
    v_exp_f32 v42, v42
    v_exp_f32 v43, v43
    v_exp_f32 v44, v44
    v_exp_f32 v45, v45
    v_exp_f32 v46, v46
    v_exp_f32 v47, v47
    v_cvt_pk_bf16_f32 v68, v40, v41
    v_cvt_pk_bf16_f32 v69, v42, v43
    v_cvt_pk_bf16_f32 v70, v44, v45
    v_cvt_pk_bf16_f32 v71, v46, v47
    v_exp_f32 v48, v48
    v_exp_f32 v49, v49
    s_waitcnt lgkmcnt(2)
    v_mfma_f32_32x32x16_bf16 v[72:87], v[96:99], v[68:71], v[72:87]
    s_mov_b64 exec, s[50:51]
    ds_read_b128 v[96:99], v6 offset:7680
    s_mov_b64 exec, -1
    v_exp_f32 v50, v50
    v_exp_f32 v51, v51
    v_exp_f32 v52, v52
    v_exp_f32 v53, v53
    s_waitcnt lgkmcnt(2)
    v_mfma_f32_32x32x16_bf16 v[32:47], v[88:91], v[8:11], v[16:31]
    ds_read_b128 v[88:91], v5 offset:9216
    v_exp_f32 v54, v54
    v_exp_f32 v55, v55
    v_cvt_pk_bf16_f32 v64, v48, v49
    v_cvt_pk_bf16_f32 v65, v50, v51
    v_cvt_pk_bf16_f32 v66, v52, v53
    v_cvt_pk_bf16_f32 v67, v54, v55
    v_exp_f32 v56, v56
    v_exp_f32 v57, v57
    s_waitcnt lgkmcnt(2)
    v_mfma_f32_32x32x16_bf16 v[72:87], v[92:95], v[64:67], v[72:87]
    s_mov_b64 exec, s[50:51]
    ds_read_b128 v[92:95], v6 offset:8192
    s_mov_b64 exec, -1
    v_exp_f32 v58, v58
    v_exp_f32 v59, v59
    v_exp_f32 v60, v60
    v_exp_f32 v61, v61
    v_exp_f32 v62, v62
    v_exp_f32 v63, v63
    v_cvt_pk_bf16_f32 v68, v56, v57
    v_cvt_pk_bf16_f32 v69, v58, v59
    v_cvt_pk_bf16_f32 v70, v60, v61
    v_cvt_pk_bf16_f32 v71, v62, v63
    v_exp_f32 v32, v32
    v_exp_f32 v33, v33
    s_waitcnt lgkmcnt(2)
    v_mfma_f32_32x32x16_bf16 v[72:87], v[96:99], v[68:71], v[72:87]
    s_mov_b64 exec, s[50:51]
    ds_read_b128 v[96:99], v6 offset:8704
    s_mov_b64 exec, -1
    v_exp_f32 v34, v34
    v_exp_f32 v35, v35
    v_exp_f32 v36, v36
    v_exp_f32 v37, v37
    s_add_u32 s43, s93, 0
    buffer_load_dwordx4 v[132:135], v118, s[28:31], s43 offen
    s_waitcnt lgkmcnt(2)
    v_mfma_f32_32x32x16_bf16 v[48:63], v[88:91], v[8:11], v[16:31]
    ds_read_b128 v[88:91], v5 offset:10240
    v_exp_f32 v38, v38
    v_exp_f32 v39, v39
    v_cvt_pk_bf16_f32 v64, v32, v33
    v_cvt_pk_bf16_f32 v65, v34, v35
    v_cvt_pk_bf16_f32 v66, v36, v37
    v_cvt_pk_bf16_f32 v67, v38, v39
    v_exp_f32 v40, v40
    v_exp_f32 v41, v41
    s_waitcnt lgkmcnt(2)
    v_mfma_f32_32x32x16_bf16 v[72:87], v[92:95], v[64:67], v[72:87]
    s_mov_b64 exec, s[50:51]
    ds_read_b128 v[92:95], v6 offset:9216
    s_mov_b64 exec, -1
    v_exp_f32 v42, v42
    v_exp_f32 v43, v43
    v_exp_f32 v44, v44
    v_exp_f32 v45, v45
    v_exp_f32 v46, v46
    v_exp_f32 v47, v47
    v_cvt_pk_bf16_f32 v68, v40, v41
    v_cvt_pk_bf16_f32 v69, v42, v43
    v_cvt_pk_bf16_f32 v70, v44, v45
    v_cvt_pk_bf16_f32 v71, v46, v47
    v_exp_f32 v48, v48
    v_exp_f32 v49, v49
    s_waitcnt lgkmcnt(2)
    v_mfma_f32_32x32x16_bf16 v[72:87], v[96:99], v[68:71], v[72:87]
    s_mov_b64 exec, s[50:51]
    ds_read_b128 v[96:99], v6 offset:9728
    s_mov_b64 exec, -1
    v_exp_f32 v50, v50
    v_exp_f32 v51, v51
    v_exp_f32 v52, v52
    v_exp_f32 v53, v53
    s_waitcnt lgkmcnt(2)
    v_mfma_f32_32x32x16_bf16 v[32:47], v[88:91], v[8:11], v[16:31]
    ds_read_b128 v[88:91], v5 offset:11264
    v_exp_f32 v54, v54
    v_exp_f32 v55, v55
    v_cvt_pk_bf16_f32 v64, v48, v49
    v_cvt_pk_bf16_f32 v65, v50, v51
    v_cvt_pk_bf16_f32 v66, v52, v53
    v_cvt_pk_bf16_f32 v67, v54, v55
    v_exp_f32 v56, v56
    v_exp_f32 v57, v57
    s_waitcnt lgkmcnt(2)
    v_mfma_f32_32x32x16_bf16 v[72:87], v[92:95], v[64:67], v[72:87]
    s_mov_b64 exec, s[50:51]
    ds_read_b128 v[92:95], v6 offset:10240
    s_mov_b64 exec, -1
    v_exp_f32 v58, v58
    v_exp_f32 v59, v59
    v_exp_f32 v60, v60
    v_exp_f32 v61, v61
    v_exp_f32 v62, v62
    v_exp_f32 v63, v63
    v_cvt_pk_bf16_f32 v68, v56, v57
    v_cvt_pk_bf16_f32 v69, v58, v59
    v_cvt_pk_bf16_f32 v70, v60, v61
    v_cvt_pk_bf16_f32 v71, v62, v63
    v_exp_f32 v32, v32
    v_exp_f32 v33, v33
    s_waitcnt lgkmcnt(2)
    v_mfma_f32_32x32x16_bf16 v[72:87], v[96:99], v[68:71], v[72:87]
    s_mov_b64 exec, s[50:51]
    ds_read_b128 v[96:99], v6 offset:10752
    s_mov_b64 exec, -1
    v_exp_f32 v34, v34
    v_exp_f32 v35, v35
    v_exp_f32 v36, v36
    v_exp_f32 v37, v37
    s_add_u32 s43, s93, 0
    buffer_load_dwordx4 v[136:139], v119, s[28:31], s43 offen
    s_waitcnt lgkmcnt(2)
    v_mfma_f32_32x32x16_bf16 v[48:63], v[88:91], v[8:11], v[16:31]
    ds_read_b128 v[88:91], v5 offset:12288
    v_exp_f32 v38, v38
    v_exp_f32 v39, v39
    v_cvt_pk_bf16_f32 v64, v32, v33
    v_cvt_pk_bf16_f32 v65, v34, v35
    v_cvt_pk_bf16_f32 v66, v36, v37
    v_cvt_pk_bf16_f32 v67, v38, v39
    v_exp_f32 v40, v40
    v_exp_f32 v41, v41
    s_waitcnt lgkmcnt(2)
    v_mfma_f32_32x32x16_bf16 v[72:87], v[92:95], v[64:67], v[72:87]
    s_mov_b64 exec, s[50:51]
    ds_read_b128 v[92:95], v6 offset:11264
    s_mov_b64 exec, -1
    v_exp_f32 v42, v42
    v_exp_f32 v43, v43
    v_exp_f32 v44, v44
    v_exp_f32 v45, v45
    v_exp_f32 v46, v46
    v_exp_f32 v47, v47
    v_cvt_pk_bf16_f32 v68, v40, v41
    v_cvt_pk_bf16_f32 v69, v42, v43
    v_cvt_pk_bf16_f32 v70, v44, v45
    v_cvt_pk_bf16_f32 v71, v46, v47
    v_exp_f32 v48, v48
    v_exp_f32 v49, v49
    s_waitcnt lgkmcnt(2)
    v_mfma_f32_32x32x16_bf16 v[72:87], v[96:99], v[68:71], v[72:87]
    s_mov_b64 exec, s[50:51]
    ds_read_b128 v[96:99], v6 offset:11776
    s_mov_b64 exec, -1
    v_exp_f32 v50, v50
    v_exp_f32 v51, v51
    v_exp_f32 v52, v52
    v_exp_f32 v53, v53
    s_waitcnt lgkmcnt(2)
    v_mfma_f32_32x32x16_bf16 v[32:47], v[88:91], v[8:11], v[16:31]
    ds_read_b128 v[88:91], v5 offset:13312
    v_exp_f32 v54, v54
    v_exp_f32 v55, v55
    v_cvt_pk_bf16_f32 v64, v48, v49
    v_cvt_pk_bf16_f32 v65, v50, v51
    v_cvt_pk_bf16_f32 v66, v52, v53
    v_cvt_pk_bf16_f32 v67, v54, v55
    v_exp_f32 v56, v56
    v_exp_f32 v57, v57
    s_waitcnt lgkmcnt(2)
    v_mfma_f32_32x32x16_bf16 v[72:87], v[92:95], v[64:67], v[72:87]
    s_mov_b64 exec, s[50:51]
    ds_read_b128 v[92:95], v6 offset:12288
    s_mov_b64 exec, -1
    v_exp_f32 v58, v58
    v_exp_f32 v59, v59
    v_exp_f32 v60, v60
    v_exp_f32 v61, v61
    v_exp_f32 v62, v62
    v_exp_f32 v63, v63
    v_cvt_pk_bf16_f32 v68, v56, v57
    v_cvt_pk_bf16_f32 v69, v58, v59
    v_cvt_pk_bf16_f32 v70, v60, v61
    v_cvt_pk_bf16_f32 v71, v62, v63
    v_exp_f32 v32, v32
    v_exp_f32 v33, v33
    s_waitcnt lgkmcnt(2)
    v_mfma_f32_32x32x16_bf16 v[72:87], v[96:99], v[68:71], v[72:87]
    s_mov_b64 exec, s[50:51]
    ds_read_b128 v[96:99], v6 offset:12800
    s_mov_b64 exec, -1
    v_exp_f32 v34, v34
    v_exp_f32 v35, v35
    v_exp_f32 v36, v36
    v_exp_f32 v37, v37
    s_add_u32 s43, s93, 704512
    buffer_load_dwordx4 v[140:143], v117, s[28:31], s43 offen
    s_waitcnt lgkmcnt(2)
    v_mfma_f32_32x32x16_bf16 v[48:63], v[88:91], v[8:11], v[16:31]
    ds_read_b128 v[88:91], v5 offset:14336
    v_exp_f32 v38, v38
    v_exp_f32 v39, v39
    v_cvt_pk_bf16_f32 v64, v32, v33
    v_cvt_pk_bf16_f32 v65, v34, v35
    v_cvt_pk_bf16_f32 v66, v36, v37
    v_cvt_pk_bf16_f32 v67, v38, v39
    v_exp_f32 v40, v40
    v_exp_f32 v41, v41
    s_waitcnt lgkmcnt(2)
    v_mfma_f32_32x32x16_bf16 v[72:87], v[92:95], v[64:67], v[72:87]
    s_mov_b64 exec, s[50:51]
    ds_read_b128 v[92:95], v6 offset:13312
    s_mov_b64 exec, -1
    v_exp_f32 v42, v42
    v_exp_f32 v43, v43
    v_exp_f32 v44, v44
    v_exp_f32 v45, v45
    v_exp_f32 v46, v46
    v_exp_f32 v47, v47
    v_cvt_pk_bf16_f32 v68, v40, v41
    v_cvt_pk_bf16_f32 v69, v42, v43
    v_cvt_pk_bf16_f32 v70, v44, v45
    v_cvt_pk_bf16_f32 v71, v46, v47
    v_exp_f32 v48, v48
    v_exp_f32 v49, v49
    s_waitcnt lgkmcnt(2)
    v_mfma_f32_32x32x16_bf16 v[72:87], v[96:99], v[68:71], v[72:87]
    s_mov_b64 exec, s[50:51]
    ds_read_b128 v[96:99], v6 offset:13824
    s_mov_b64 exec, -1
    v_exp_f32 v50, v50
    v_exp_f32 v51, v51
    v_exp_f32 v52, v52
    v_exp_f32 v53, v53
    s_waitcnt lgkmcnt(2)
    v_mfma_f32_32x32x16_bf16 v[32:47], v[88:91], v[8:11], v[16:31]
    ds_read_b128 v[88:91], v5 offset:15360
    v_exp_f32 v54, v54
    v_exp_f32 v55, v55
    v_cvt_pk_bf16_f32 v64, v48, v49
    v_cvt_pk_bf16_f32 v65, v50, v51
    v_cvt_pk_bf16_f32 v66, v52, v53
    v_cvt_pk_bf16_f32 v67, v54, v55
    v_exp_f32 v56, v56
    v_exp_f32 v57, v57
    s_waitcnt lgkmcnt(2)
    v_mfma_f32_32x32x16_bf16 v[72:87], v[92:95], v[64:67], v[72:87]
    s_mov_b64 exec, s[50:51]
    ds_read_b128 v[92:95], v6 offset:14336
    s_mov_b64 exec, -1
    v_exp_f32 v58, v58
    v_exp_f32 v59, v59
    v_exp_f32 v60, v60
    v_exp_f32 v61, v61
    v_exp_f32 v62, v62
    v_exp_f32 v63, v63
    v_cvt_pk_bf16_f32 v68, v56, v57
    v_cvt_pk_bf16_f32 v69, v58, v59
    v_cvt_pk_bf16_f32 v70, v60, v61
    v_cvt_pk_bf16_f32 v71, v62, v63
    v_exp_f32 v32, v32
    v_exp_f32 v33, v33
    s_waitcnt lgkmcnt(2)
    v_mfma_f32_32x32x16_bf16 v[72:87], v[96:99], v[68:71], v[72:87]
    s_mov_b64 exec, s[50:51]
    ds_read_b128 v[96:99], v6 offset:14848
    s_mov_b64 exec, -1
    v_exp_f32 v34, v34
    v_exp_f32 v35, v35
    v_exp_f32 v36, v36
    v_exp_f32 v37, v37
    s_mov_b32 s47, 0
L_sp_13:
    ds_read_b32 v2, v101
    s_waitcnt lgkmcnt(0)
    v_readfirstlane_b32 s48, v2
    s_add_u32 s47, s47, 1
    s_cmp_gt_u32 s47, 600000
    s_cbranch_scc1 L_spx_14
    s_cmp_lt_u32 s48, 4
    s_cbranch_scc1 L_sp_13
L_spx_14:
    s_add_u32 s43, s93, 704512
    buffer_load_dwordx4 v[144:147], v118, s[28:31], s43 offen
    s_waitcnt lgkmcnt(2)
    v_mfma_f32_32x32x16_bf16 v[48:63], v[88:91], v[8:11], v[16:31]
    ds_read_b128 v[88:91], v5 offset:16384
    v_exp_f32 v38, v38
    v_exp_f32 v39, v39
    v_cvt_pk_bf16_f32 v64, v32, v33
    v_cvt_pk_bf16_f32 v65, v34, v35
    v_cvt_pk_bf16_f32 v66, v36, v37
    v_cvt_pk_bf16_f32 v67, v38, v39
    v_exp_f32 v40, v40
    v_exp_f32 v41, v41
    s_waitcnt lgkmcnt(2)
    v_mfma_f32_32x32x16_bf16 v[72:87], v[92:95], v[64:67], v[72:87]
    s_mov_b64 exec, s[50:51]
    ds_read_b128 v[92:95], v6 offset:15360
    s_mov_b64 exec, -1
    v_exp_f32 v42, v42
    v_exp_f32 v43, v43
    v_exp_f32 v44, v44
    v_exp_f32 v45, v45
    v_exp_f32 v46, v46
    v_exp_f32 v47, v47
    v_cvt_pk_bf16_f32 v68, v40, v41
    v_cvt_pk_bf16_f32 v69, v42, v43
    v_cvt_pk_bf16_f32 v70, v44, v45
    v_cvt_pk_bf16_f32 v71, v46, v47
    v_exp_f32 v48, v48
    v_exp_f32 v49, v49
    s_waitcnt lgkmcnt(2)
    v_mfma_f32_32x32x16_bf16 v[72:87], v[96:99], v[68:71], v[72:87]
    s_mov_b64 exec, s[50:51]
    ds_read_b128 v[96:99], v6 offset:15872
    s_mov_b64 exec, -1
    v_exp_f32 v50, v50
    v_exp_f32 v51, v51
    v_exp_f32 v52, v52
    v_exp_f32 v53, v53
    s_waitcnt lgkmcnt(2)
    v_mfma_f32_32x32x16_bf16 v[32:47], v[88:91], v[8:11], v[16:31]
    ds_read_b128 v[88:91], v5 offset:17408
    v_exp_f32 v54, v54
    v_exp_f32 v55, v55
    v_cvt_pk_bf16_f32 v64, v48, v49
    v_cvt_pk_bf16_f32 v65, v50, v51
    v_cvt_pk_bf16_f32 v66, v52, v53
    v_cvt_pk_bf16_f32 v67, v54, v55
    v_exp_f32 v56, v56
    v_exp_f32 v57, v57
    s_waitcnt lgkmcnt(2)
    v_mfma_f32_32x32x16_bf16 v[72:87], v[92:95], v[64:67], v[72:87]
    s_mov_b64 exec, s[50:51]
    ds_read_b128 v[92:95], v6 offset:16384
    s_mov_b64 exec, -1
    v_exp_f32 v58, v58
    v_exp_f32 v59, v59
    v_exp_f32 v60, v60
    v_exp_f32 v61, v61
    v_exp_f32 v62, v62
    v_exp_f32 v63, v63
    v_cvt_pk_bf16_f32 v68, v56, v57
    v_cvt_pk_bf16_f32 v69, v58, v59
    v_cvt_pk_bf16_f32 v70, v60, v61
    v_cvt_pk_bf16_f32 v71, v62, v63
    v_exp_f32 v32, v32
    v_exp_f32 v33, v33
    s_waitcnt lgkmcnt(2)
    v_mfma_f32_32x32x16_bf16 v[72:87], v[96:99], v[68:71], v[72:87]
    s_mov_b64 exec, s[50:51]
    ds_read_b128 v[96:99], v6 offset:16896
    s_mov_b64 exec, -1
    v_exp_f32 v34, v34
    v_exp_f32 v35, v35
    v_exp_f32 v36, v36
    v_exp_f32 v37, v37
    s_add_u32 s43, s93, 704512
    buffer_load_dwordx4 v[148:151], v119, s[28:31], s43 offen
    s_waitcnt lgkmcnt(2)
    v_mfma_f32_32x32x16_bf16 v[48:63], v[88:91], v[8:11], v[16:31]
    ds_read_b128 v[88:91], v5 offset:18432
    v_exp_f32 v38, v38
    v_exp_f32 v39, v39
    v_cvt_pk_bf16_f32 v64, v32, v33
    v_cvt_pk_bf16_f32 v65, v34, v35
    v_cvt_pk_bf16_f32 v66, v36, v37
    v_cvt_pk_bf16_f32 v67, v38, v39
    v_exp_f32 v40, v40
    v_exp_f32 v41, v41
    s_waitcnt lgkmcnt(2)
    v_mfma_f32_32x32x16_bf16 v[72:87], v[92:95], v[64:67], v[72:87]
    s_mov_b64 exec, s[50:51]
    ds_read_b128 v[92:95], v6 offset:17408
    s_mov_b64 exec, -1
    v_exp_f32 v42, v42
    v_exp_f32 v43, v43
    v_exp_f32 v44, v44
    v_exp_f32 v45, v45
    v_exp_f32 v46, v46
    v_exp_f32 v47, v47
    v_cvt_pk_bf16_f32 v68, v40, v41
    v_cvt_pk_bf16_f32 v69, v42, v43
    v_cvt_pk_bf16_f32 v70, v44, v45
    v_cvt_pk_bf16_f32 v71, v46, v47
    v_exp_f32 v48, v48
    v_exp_f32 v49, v49
    s_waitcnt lgkmcnt(2)
    v_mfma_f32_32x32x16_bf16 v[72:87], v[96:99], v[68:71], v[72:87]
    s_mov_b64 exec, s[50:51]
    ds_read_b128 v[96:99], v6 offset:17920
    s_mov_b64 exec, -1
    v_exp_f32 v50, v50
    v_exp_f32 v51, v51
    v_exp_f32 v52, v52
    v_exp_f32 v53, v53
    s_waitcnt lgkmcnt(2)
    v_mfma_f32_32x32x16_bf16 v[32:47], v[88:91], v[8:11], v[16:31]
    ds_read_b128 v[88:91], v5 offset:19456
    v_exp_f32 v54, v54
    v_exp_f32 v55, v55
    v_cvt_pk_bf16_f32 v64, v48, v49
    v_cvt_pk_bf16_f32 v65, v50, v51
    v_cvt_pk_bf16_f32 v66, v52, v53
    v_cvt_pk_bf16_f32 v67, v54, v55
    v_exp_f32 v56, v56
    v_exp_f32 v57, v57
    s_waitcnt lgkmcnt(2)
    v_mfma_f32_32x32x16_bf16 v[72:87], v[92:95], v[64:67], v[72:87]
    s_mov_b64 exec, s[50:51]
    ds_read_b128 v[92:95], v6 offset:18432
    s_mov_b64 exec, -1
    v_exp_f32 v58, v58
    v_exp_f32 v59, v59
    v_exp_f32 v60, v60
    v_exp_f32 v61, v61
    v_exp_f32 v62, v62
    v_exp_f32 v63, v63
    v_cvt_pk_bf16_f32 v68, v56, v57
    v_cvt_pk_bf16_f32 v69, v58, v59
    v_cvt_pk_bf16_f32 v70, v60, v61
    v_cvt_pk_bf16_f32 v71, v62, v63
    v_exp_f32 v32, v32
    v_exp_f32 v33, v33
    s_waitcnt lgkmcnt(2)
    v_mfma_f32_32x32x16_bf16 v[72:87], v[96:99], v[68:71], v[72:87]
    s_mov_b64 exec, s[50:51]
    ds_read_b128 v[96:99], v6 offset:18944
    s_mov_b64 exec, -1
    v_exp_f32 v34, v34
    v_exp_f32 v35, v35
    v_exp_f32 v36, v36
    v_exp_f32 v37, v37
    s_cmp_lg_u32 s26, 7
    s_cbranch_scc1 L_pf7_15
    s_waitcnt vmcnt(6)
    s_lshl_b32 s47, s42, 11
    s_add_u32 s47, s47, 14434304
    s_mov_b64 exec, 255
    v_lshlrev_b32 v124, 8, v1
    v_mov_b32 v125, 1
    buffer_atomic_add v125, v124, s[36:39], s47 offen
    s_mov_b64 exec, 1
    v_mov_b32 v124, 131076
    ds_write_b32 v124, v125
    s_mov_b64 exec, -1
L_pf7_15:
    s_add_u32 s43, s93, 1409024
    buffer_load_dwordx4 v[152:155], v117, s[28:31], s43 offen
    s_waitcnt lgkmcnt(2)
    v_mfma_f32_32x32x16_bf16 v[48:63], v[88:91], v[8:11], v[16:31]
    ds_read_b128 v[88:91], v5 offset:20480
    v_exp_f32 v38, v38
    v_exp_f32 v39, v39
    v_cvt_pk_bf16_f32 v64, v32, v33
    v_cvt_pk_bf16_f32 v65, v34, v35
    v_cvt_pk_bf16_f32 v66, v36, v37
    v_cvt_pk_bf16_f32 v67, v38, v39
    v_exp_f32 v40, v40
    v_exp_f32 v41, v41
    s_waitcnt lgkmcnt(2)
    v_mfma_f32_32x32x16_bf16 v[72:87], v[92:95], v[64:67], v[72:87]
    s_mov_b64 exec, s[50:51]
    ds_read_b128 v[92:95], v6 offset:19456
    s_mov_b64 exec, -1
    v_exp_f32 v42, v42
    v_exp_f32 v43, v43
    v_exp_f32 v44, v44
    v_exp_f32 v45, v45
    v_exp_f32 v46, v46
    v_exp_f32 v47, v47
    v_cvt_pk_bf16_f32 v68, v40, v41
    v_cvt_pk_bf16_f32 v69, v42, v43
    v_cvt_pk_bf16_f32 v70, v44, v45
    v_cvt_pk_bf16_f32 v71, v46, v47
    v_exp_f32 v48, v48
    v_exp_f32 v49, v49
    s_waitcnt lgkmcnt(2)
    v_mfma_f32_32x32x16_bf16 v[72:87], v[96:99], v[68:71], v[72:87]
    s_mov_b64 exec, s[50:51]
    ds_read_b128 v[96:99], v6 offset:19968
    s_mov_b64 exec, -1
    v_exp_f32 v50, v50
    v_exp_f32 v51, v51
    v_exp_f32 v52, v52
    v_exp_f32 v53, v53
    s_waitcnt lgkmcnt(2)
    v_mfma_f32_32x32x16_bf16 v[32:47], v[88:91], v[8:11], v[16:31]
    ds_read_b128 v[88:91], v5 offset:21504
    v_exp_f32 v54, v54
    v_exp_f32 v55, v55
    v_cvt_pk_bf16_f32 v64, v48, v49
    v_cvt_pk_bf16_f32 v65, v50, v51
    v_cvt_pk_bf16_f32 v66, v52, v53
    v_cvt_pk_bf16_f32 v67, v54, v55
    v_exp_f32 v56, v56
    v_exp_f32 v57, v57
    s_waitcnt lgkmcnt(2)
    v_mfma_f32_32x32x16_bf16 v[72:87], v[92:95], v[64:67], v[72:87]
    s_mov_b64 exec, s[50:51]
    ds_read_b128 v[92:95], v6 offset:20480
    s_mov_b64 exec, -1
    v_exp_f32 v58, v58
    v_exp_f32 v59, v59
    v_exp_f32 v60, v60
    v_exp_f32 v61, v61
    v_exp_f32 v62, v62
    v_exp_f32 v63, v63
    v_cvt_pk_bf16_f32 v68, v56, v57
    v_cvt_pk_bf16_f32 v69, v58, v59
    v_cvt_pk_bf16_f32 v70, v60, v61
    v_cvt_pk_bf16_f32 v71, v62, v63
    v_exp_f32 v32, v32
    v_exp_f32 v33, v33
    s_waitcnt lgkmcnt(2)
    v_mfma_f32_32x32x16_bf16 v[72:87], v[96:99], v[68:71], v[72:87]
    s_mov_b64 exec, s[50:51]
    ds_read_b128 v[96:99], v6 offset:20992
    s_mov_b64 exec, -1
    v_exp_f32 v34, v34
    v_exp_f32 v35, v35
    v_exp_f32 v36, v36
    v_exp_f32 v37, v37
    s_add_u32 s43, s93, 1409024
    buffer_load_dwordx4 v[156:159], v118, s[28:31], s43 offen
    s_waitcnt lgkmcnt(2)
    v_mfma_f32_32x32x16_bf16 v[48:63], v[88:91], v[8:11], v[16:31]
    ds_read_b128 v[88:91], v5 offset:22528
    v_exp_f32 v38, v38
    v_exp_f32 v39, v39
    v_cvt_pk_bf16_f32 v64, v32, v33
    v_cvt_pk_bf16_f32 v65, v34, v35
    v_cvt_pk_bf16_f32 v66, v36, v37
    v_cvt_pk_bf16_f32 v67, v38, v39
    v_exp_f32 v40, v40
    v_exp_f32 v41, v41
    s_waitcnt lgkmcnt(2)
    v_mfma_f32_32x32x16_bf16 v[72:87], v[92:95], v[64:67], v[72:87]
    s_mov_b64 exec, s[50:51]
    ds_read_b128 v[92:95], v6 offset:21504
    s_mov_b64 exec, -1
    v_exp_f32 v42, v42
    v_exp_f32 v43, v43
    v_exp_f32 v44, v44
    v_exp_f32 v45, v45
    v_exp_f32 v46, v46
    v_exp_f32 v47, v47
    v_cvt_pk_bf16_f32 v68, v40, v41
    v_cvt_pk_bf16_f32 v69, v42, v43
    v_cvt_pk_bf16_f32 v70, v44, v45
    v_cvt_pk_bf16_f32 v71, v46, v47
    v_exp_f32 v48, v48
    v_exp_f32 v49, v49
    s_waitcnt lgkmcnt(2)
    v_mfma_f32_32x32x16_bf16 v[72:87], v[96:99], v[68:71], v[72:87]
    s_mov_b64 exec, s[50:51]
    ds_read_b128 v[96:99], v6 offset:22016
    s_mov_b64 exec, -1
    v_exp_f32 v50, v50
    v_exp_f32 v51, v51
    v_exp_f32 v52, v52
    v_exp_f32 v53, v53
    s_waitcnt lgkmcnt(2)
    v_mfma_f32_32x32x16_bf16 v[32:47], v[88:91], v[8:11], v[16:31]
    ds_read_b128 v[88:91], v5 offset:23552
    v_exp_f32 v54, v54
    v_exp_f32 v55, v55
    v_cvt_pk_bf16_f32 v64, v48, v49
    v_cvt_pk_bf16_f32 v65, v50, v51
    v_cvt_pk_bf16_f32 v66, v52, v53
    v_cvt_pk_bf16_f32 v67, v54, v55
    v_exp_f32 v56, v56
    v_exp_f32 v57, v57
    s_waitcnt lgkmcnt(2)
    v_mfma_f32_32x32x16_bf16 v[72:87], v[92:95], v[64:67], v[72:87]
    s_mov_b64 exec, s[50:51]
    ds_read_b128 v[92:95], v6 offset:22528
    s_mov_b64 exec, -1
    v_exp_f32 v58, v58
    v_exp_f32 v59, v59
    v_exp_f32 v60, v60
    v_exp_f32 v61, v61
    v_exp_f32 v62, v62
    v_exp_f32 v63, v63
    v_cvt_pk_bf16_f32 v68, v56, v57
    v_cvt_pk_bf16_f32 v69, v58, v59
    v_cvt_pk_bf16_f32 v70, v60, v61
    v_cvt_pk_bf16_f32 v71, v62, v63
    v_exp_f32 v32, v32
    v_exp_f32 v33, v33
    s_waitcnt lgkmcnt(2)
    v_mfma_f32_32x32x16_bf16 v[72:87], v[96:99], v[68:71], v[72:87]
    s_mov_b64 exec, s[50:51]
    ds_read_b128 v[96:99], v6 offset:23040
    s_mov_b64 exec, -1
    v_exp_f32 v34, v34
    v_exp_f32 v35, v35
    v_exp_f32 v36, v36
    v_exp_f32 v37, v37
    s_add_u32 s43, s93, 1409024
    buffer_load_dwordx4 v[160:163], v119, s[28:31], s43 offen
    s_waitcnt lgkmcnt(2)
    v_mfma_f32_32x32x16_bf16 v[48:63], v[88:91], v[8:11], v[16:31]
    ds_read_b128 v[88:91], v5 offset:24576
    v_exp_f32 v38, v38
    v_exp_f32 v39, v39
    v_cvt_pk_bf16_f32 v64, v32, v33
    v_cvt_pk_bf16_f32 v65, v34, v35
    v_cvt_pk_bf16_f32 v66, v36, v37
    v_cvt_pk_bf16_f32 v67, v38, v39
    v_exp_f32 v40, v40
    v_exp_f32 v41, v41
    s_waitcnt lgkmcnt(2)
    v_mfma_f32_32x32x16_bf16 v[72:87], v[92:95], v[64:67], v[72:87]
    s_mov_b64 exec, s[50:51]
    ds_read_b128 v[92:95], v6 offset:23552
    s_mov_b64 exec, -1
    v_exp_f32 v42, v42
    v_exp_f32 v43, v43
    v_exp_f32 v44, v44
    v_exp_f32 v45, v45
    v_exp_f32 v46, v46
    v_exp_f32 v47, v47
    v_cvt_pk_bf16_f32 v68, v40, v41
    v_cvt_pk_bf16_f32 v69, v42, v43
    v_cvt_pk_bf16_f32 v70, v44, v45
    v_cvt_pk_bf16_f32 v71, v46, v47
    v_exp_f32 v48, v48
    v_exp_f32 v49, v49
    s_waitcnt lgkmcnt(2)
    v_mfma_f32_32x32x16_bf16 v[72:87], v[96:99], v[68:71], v[72:87]
    s_mov_b64 exec, s[50:51]
    ds_read_b128 v[96:99], v6 offset:24064
    s_mov_b64 exec, -1
    v_exp_f32 v50, v50
    v_exp_f32 v51, v51
    v_exp_f32 v52, v52
    v_exp_f32 v53, v53
    s_waitcnt lgkmcnt(2)
    v_mfma_f32_32x32x16_bf16 v[32:47], v[88:91], v[8:11], v[16:31]
    ds_read_b128 v[88:91], v5 offset:25600
    v_exp_f32 v54, v54
    v_exp_f32 v55, v55
    v_cvt_pk_bf16_f32 v64, v48, v49
    v_cvt_pk_bf16_f32 v65, v50, v51
    v_cvt_pk_bf16_f32 v66, v52, v53
    v_cvt_pk_bf16_f32 v67, v54, v55
    v_exp_f32 v56, v56
    v_exp_f32 v57, v57
    s_waitcnt lgkmcnt(2)
    v_mfma_f32_32x32x16_bf16 v[72:87], v[92:95], v[64:67], v[72:87]
    s_mov_b64 exec, s[50:51]
    ds_read_b128 v[92:95], v6 offset:24576
    s_mov_b64 exec, -1
    v_exp_f32 v58, v58
    v_exp_f32 v59, v59
    v_exp_f32 v60, v60
    v_exp_f32 v61, v61
    v_exp_f32 v62, v62
    v_exp_f32 v63, v63
    v_cvt_pk_bf16_f32 v68, v56, v57
    v_cvt_pk_bf16_f32 v69, v58, v59
    v_cvt_pk_bf16_f32 v70, v60, v61
    v_cvt_pk_bf16_f32 v71, v62, v63
    v_exp_f32 v32, v32
    v_exp_f32 v33, v33
    s_waitcnt lgkmcnt(2)
    v_mfma_f32_32x32x16_bf16 v[72:87], v[96:99], v[68:71], v[72:87]
    s_mov_b64 exec, s[50:51]
    ds_read_b128 v[96:99], v6 offset:25088
    s_mov_b64 exec, -1
    v_exp_f32 v34, v34
    v_exp_f32 v35, v35
    v_exp_f32 v36, v36
    v_exp_f32 v37, v37
    s_add_u32 s43, s93, 2113536
    buffer_load_dwordx4 v[164:167], v117, s[28:31], s43 offen
    s_waitcnt lgkmcnt(2)
    v_mfma_f32_32x32x16_bf16 v[48:63], v[88:91], v[8:11], v[16:31]
    ds_read_b128 v[88:91], v5 offset:26624
    v_exp_f32 v38, v38
    v_exp_f32 v39, v39
    v_cvt_pk_bf16_f32 v64, v32, v33
    v_cvt_pk_bf16_f32 v65, v34, v35
    v_cvt_pk_bf16_f32 v66, v36, v37
    v_cvt_pk_bf16_f32 v67, v38, v39
    v_exp_f32 v40, v40
    v_exp_f32 v41, v41
    s_waitcnt lgkmcnt(2)
    v_mfma_f32_32x32x16_bf16 v[72:87], v[92:95], v[64:67], v[72:87]
    s_mov_b64 exec, s[50:51]
    ds_read_b128 v[92:95], v6 offset:25600
    s_mov_b64 exec, -1
    v_exp_f32 v42, v42
    v_exp_f32 v43, v43
    v_exp_f32 v44, v44
    v_exp_f32 v45, v45
    v_exp_f32 v46, v46
    v_exp_f32 v47, v47
    v_cvt_pk_bf16_f32 v68, v40, v41
    v_cvt_pk_bf16_f32 v69, v42, v43
    v_cvt_pk_bf16_f32 v70, v44, v45
    v_cvt_pk_bf16_f32 v71, v46, v47
    s_cmp_ge_u32 s26, 4
    s_cbranch_scc1 L_sw_16
    s_setprio 2
L_sw_16:
    v_exp_f32 v48, v48
    v_exp_f32 v49, v49
    s_waitcnt lgkmcnt(2)
    v_mfma_f32_32x32x16_bf16 v[72:87], v[96:99], v[68:71], v[72:87]
    s_mov_b64 exec, s[50:51]
    ds_read_b128 v[96:99], v6 offset:26112
    s_mov_b64 exec, -1
    v_exp_f32 v50, v50
    v_exp_f32 v51, v51
    v_exp_f32 v52, v52
    v_exp_f32 v53, v53
    s_waitcnt lgkmcnt(2)
    v_mfma_f32_32x32x16_bf16 v[32:47], v[88:91], v[8:11], v[16:31]
    ds_read_b128 v[88:91], v5 offset:27648
    v_exp_f32 v54, v54
    v_exp_f32 v55, v55
    v_cvt_pk_bf16_f32 v64, v48, v49
    v_cvt_pk_bf16_f32 v65, v50, v51
    v_cvt_pk_bf16_f32 v66, v52, v53
    v_cvt_pk_bf16_f32 v67, v54, v55
    v_exp_f32 v56, v56
    v_exp_f32 v57, v57
    s_waitcnt lgkmcnt(2)
    v_mfma_f32_32x32x16_bf16 v[72:87], v[92:95], v[64:67], v[72:87]
    s_mov_b64 exec, s[50:51]
    ds_read_b128 v[92:95], v6 offset:26624
    s_mov_b64 exec, -1
    v_exp_f32 v58, v58
    v_exp_f32 v59, v59
    v_exp_f32 v60, v60
    v_exp_f32 v61, v61
    v_exp_f32 v62, v62
    v_exp_f32 v63, v63
    v_cvt_pk_bf16_f32 v68, v56, v57
    v_cvt_pk_bf16_f32 v69, v58, v59
    v_cvt_pk_bf16_f32 v70, v60, v61
    v_cvt_pk_bf16_f32 v71, v62, v63
    v_exp_f32 v32, v32
    v_exp_f32 v33, v33
    s_waitcnt lgkmcnt(2)
    v_mfma_f32_32x32x16_bf16 v[72:87], v[96:99], v[68:71], v[72:87]
    s_mov_b64 exec, s[50:51]
    ds_read_b128 v[96:99], v6 offset:27136
    s_mov_b64 exec, -1
    v_exp_f32 v34, v34
    v_exp_f32 v35, v35
    v_exp_f32 v36, v36
    v_exp_f32 v37, v37
    s_add_u32 s43, s93, 2113536
    buffer_load_dwordx4 v[168:171], v118, s[28:31], s43 offen
    s_waitcnt lgkmcnt(2)
    v_mfma_f32_32x32x16_bf16 v[48:63], v[88:91], v[8:11], v[16:31]
    ds_read_b128 v[88:91], v5 offset:28672
    v_exp_f32 v38, v38
    v_exp_f32 v39, v39
    v_cvt_pk_bf16_f32 v64, v32, v33
    v_cvt_pk_bf16_f32 v65, v34, v35
    v_cvt_pk_bf16_f32 v66, v36, v37
    v_cvt_pk_bf16_f32 v67, v38, v39
    v_exp_f32 v40, v40
    v_exp_f32 v41, v41
    s_waitcnt lgkmcnt(2)
    v_mfma_f32_32x32x16_bf16 v[72:87], v[92:95], v[64:67], v[72:87]
    s_mov_b64 exec, s[50:51]
    ds_read_b128 v[92:95], v6 offset:27648
    s_mov_b64 exec, -1
    v_exp_f32 v42, v42
    v_exp_f32 v43, v43
    v_exp_f32 v44, v44
    v_exp_f32 v45, v45
    v_exp_f32 v46, v46
    v_exp_f32 v47, v47
    v_cvt_pk_bf16_f32 v68, v40, v41
    v_cvt_pk_bf16_f32 v69, v42, v43
    v_cvt_pk_bf16_f32 v70, v44, v45
    v_cvt_pk_bf16_f32 v71, v46, v47
    v_exp_f32 v48, v48
    v_exp_f32 v49, v49
    s_waitcnt lgkmcnt(2)
    v_mfma_f32_32x32x16_bf16 v[72:87], v[96:99], v[68:71], v[72:87]
    s_mov_b64 exec, s[50:51]
    ds_read_b128 v[96:99], v6 offset:28160
    s_mov_b64 exec, -1
    v_exp_f32 v50, v50
    v_exp_f32 v51, v51
    v_exp_f32 v52, v52
    v_exp_f32 v53, v53
    s_waitcnt lgkmcnt(2)
    v_mfma_f32_32x32x16_bf16 v[32:47], v[88:91], v[8:11], v[16:31]
    ds_read_b128 v[88:91], v5 offset:29696
    v_exp_f32 v54, v54
    v_exp_f32 v55, v55
    v_cvt_pk_bf16_f32 v64, v48, v49
    v_cvt_pk_bf16_f32 v65, v50, v51
    v_cvt_pk_bf16_f32 v66, v52, v53
    v_cvt_pk_bf16_f32 v67, v54, v55
    v_exp_f32 v56, v56
    v_exp_f32 v57, v57
    s_waitcnt lgkmcnt(2)
    v_mfma_f32_32x32x16_bf16 v[72:87], v[92:95], v[64:67], v[72:87]
    s_mov_b64 exec, s[50:51]
    ds_read_b128 v[92:95], v6 offset:28672
    s_mov_b64 exec, -1
    v_exp_f32 v58, v58
    v_exp_f32 v59, v59
    v_exp_f32 v60, v60
    v_exp_f32 v61, v61
    v_exp_f32 v62, v62
    v_exp_f32 v63, v63
    v_cvt_pk_bf16_f32 v68, v56, v57
    v_cvt_pk_bf16_f32 v69, v58, v59
    v_cvt_pk_bf16_f32 v70, v60, v61
    v_cvt_pk_bf16_f32 v71, v62, v63
    v_exp_f32 v32, v32
    v_exp_f32 v33, v33
    s_waitcnt lgkmcnt(2)
    v_mfma_f32_32x32x16_bf16 v[72:87], v[96:99], v[68:71], v[72:87]
    s_mov_b64 exec, s[50:51]
    ds_read_b128 v[96:99], v6 offset:29184
    s_mov_b64 exec, -1
    v_exp_f32 v34, v34
    v_exp_f32 v35, v35
    v_exp_f32 v36, v36
    v_exp_f32 v37, v37
    s_add_u32 s43, s93, 2113536
    buffer_load_dwordx4 v[172:175], v119, s[28:31], s43 offen
    s_waitcnt lgkmcnt(2)
    v_mfma_f32_32x32x16_bf16 v[48:63], v[88:91], v[8:11], v[16:31]
    ds_read_b128 v[88:91], v5 offset:30720
    v_exp_f32 v38, v38
    v_exp_f32 v39, v39
    v_cvt_pk_bf16_f32 v64, v32, v33
    v_cvt_pk_bf16_f32 v65, v34, v35
    v_cvt_pk_bf16_f32 v66, v36, v37
    v_cvt_pk_bf16_f32 v67, v38, v39
    v_exp_f32 v40, v40
    v_exp_f32 v41, v41
    s_waitcnt lgkmcnt(2)
    v_mfma_f32_32x32x16_bf16 v[72:87], v[92:95], v[64:67], v[72:87]
    s_mov_b64 exec, s[50:51]
    ds_read_b128 v[92:95], v6 offset:29696
    s_mov_b64 exec, -1
    v_exp_f32 v42, v42
    v_exp_f32 v43, v43
    v_exp_f32 v44, v44
    v_exp_f32 v45, v45
    v_exp_f32 v46, v46
    v_exp_f32 v47, v47
    v_cvt_pk_bf16_f32 v68, v40, v41
    v_cvt_pk_bf16_f32 v69, v42, v43
    v_cvt_pk_bf16_f32 v70, v44, v45
    v_cvt_pk_bf16_f32 v71, v46, v47
    v_exp_f32 v48, v48
    v_exp_f32 v49, v49
    s_waitcnt lgkmcnt(2)
    v_mfma_f32_32x32x16_bf16 v[72:87], v[96:99], v[68:71], v[72:87]
    s_mov_b64 exec, s[50:51]
    ds_read_b128 v[96:99], v6 offset:30208
    s_mov_b64 exec, -1
    v_exp_f32 v50, v50
    v_exp_f32 v51, v51
    v_exp_f32 v52, v52
    v_exp_f32 v53, v53
    s_waitcnt lgkmcnt(2)
    v_mfma_f32_32x32x16_bf16 v[32:47], v[88:91], v[8:11], v[16:31]
    ds_read_b128 v[88:91], v5 offset:31744
    v_exp_f32 v54, v54
    v_exp_f32 v55, v55
    v_cvt_pk_bf16_f32 v64, v48, v49
    v_cvt_pk_bf16_f32 v65, v50, v51
    v_cvt_pk_bf16_f32 v66, v52, v53
    v_cvt_pk_bf16_f32 v67, v54, v55
    v_exp_f32 v56, v56
    v_exp_f32 v57, v57
    s_waitcnt lgkmcnt(2)
    v_mfma_f32_32x32x16_bf16 v[72:87], v[92:95], v[64:67], v[72:87]
    s_mov_b64 exec, s[50:51]
    ds_read_b128 v[92:95], v6 offset:30720
    s_mov_b64 exec, -1
    v_exp_f32 v58, v58
    v_exp_f32 v59, v59
    v_exp_f32 v60, v60
    v_exp_f32 v61, v61
    v_exp_f32 v62, v62
    v_exp_f32 v63, v63
    v_cvt_pk_bf16_f32 v68, v56, v57
    v_cvt_pk_bf16_f32 v69, v58, v59
    v_cvt_pk_bf16_f32 v70, v60, v61
    v_cvt_pk_bf16_f32 v71, v62, v63
    v_exp_f32 v32, v32
    v_exp_f32 v33, v33
    s_waitcnt lgkmcnt(2)
    v_mfma_f32_32x32x16_bf16 v[72:87], v[96:99], v[68:71], v[72:87]
    s_mov_b64 exec, s[50:51]
    ds_read_b128 v[96:99], v6 offset:31232
    s_mov_b64 exec, -1
    v_exp_f32 v34, v34
    v_exp_f32 v35, v35
    v_exp_f32 v36, v36
    v_exp_f32 v37, v37
    s_add_u32 s43, s93, 2818048
    buffer_load_dwordx4 v[176:179], v117, s[28:31], s43 offen
    s_waitcnt lgkmcnt(2)
    v_mfma_f32_32x32x16_bf16 v[48:63], v[88:91], v[8:11], v[16:31]
    ds_read_b128 v[88:91], v5 offset:32768
    v_exp_f32 v38, v38
    v_exp_f32 v39, v39
    v_cvt_pk_bf16_f32 v64, v32, v33
    v_cvt_pk_bf16_f32 v65, v34, v35
    v_cvt_pk_bf16_f32 v66, v36, v37
    v_cvt_pk_bf16_f32 v67, v38, v39
    v_exp_f32 v40, v40
    v_exp_f32 v41, v41
    s_waitcnt lgkmcnt(2)
    v_mfma_f32_32x32x16_bf16 v[72:87], v[92:95], v[64:67], v[72:87]
    s_mov_b64 exec, s[50:51]
    ds_read_b128 v[92:95], v6 offset:31744
    s_mov_b64 exec, -1
    v_exp_f32 v42, v42
    v_exp_f32 v43, v43
    v_exp_f32 v44, v44
    v_exp_f32 v45, v45
    v_exp_f32 v46, v46
    v_exp_f32 v47, v47
    v_cvt_pk_bf16_f32 v68, v40, v41
    v_cvt_pk_bf16_f32 v69, v42, v43
    v_cvt_pk_bf16_f32 v70, v44, v45
    v_cvt_pk_bf16_f32 v71, v46, v47
    v_exp_f32 v48, v48
    v_exp_f32 v49, v49
    s_waitcnt lgkmcnt(2)
    v_mfma_f32_32x32x16_bf16 v[72:87], v[96:99], v[68:71], v[72:87]
    s_mov_b64 exec, s[50:51]
    ds_read_b128 v[96:99], v6 offset:32256
    s_mov_b64 exec, -1
    v_exp_f32 v50, v50
    v_exp_f32 v51, v51
    v_exp_f32 v52, v52
    v_exp_f32 v53, v53
    s_waitcnt lgkmcnt(2)
    v_mfma_f32_32x32x16_bf16 v[32:47], v[88:91], v[8:11], v[16:31]
    ds_read_b128 v[88:91], v5 offset:33792
    v_exp_f32 v54, v54
    v_exp_f32 v55, v55
    v_cvt_pk_bf16_f32 v64, v48, v49
    v_cvt_pk_bf16_f32 v65, v50, v51
    v_cvt_pk_bf16_f32 v66, v52, v53
    v_cvt_pk_bf16_f32 v67, v54, v55
    v_exp_f32 v56, v56
    v_exp_f32 v57, v57
    s_waitcnt lgkmcnt(2)
    v_mfma_f32_32x32x16_bf16 v[72:87], v[92:95], v[64:67], v[72:87]
    s_mov_b64 exec, s[50:51]
    ds_read_b128 v[92:95], v6 offset:32768
    s_mov_b64 exec, -1
    v_exp_f32 v58, v58
    v_exp_f32 v59, v59
    v_exp_f32 v60, v60
    v_exp_f32 v61, v61
    v_exp_f32 v62, v62
    v_exp_f32 v63, v63
    v_cvt_pk_bf16_f32 v68, v56, v57
    v_cvt_pk_bf16_f32 v69, v58, v59
    v_cvt_pk_bf16_f32 v70, v60, v61
    v_cvt_pk_bf16_f32 v71, v62, v63
    v_exp_f32 v32, v32
    v_exp_f32 v33, v33
    s_waitcnt lgkmcnt(2)
    v_mfma_f32_32x32x16_bf16 v[72:87], v[96:99], v[68:71], v[72:87]
    s_mov_b64 exec, s[50:51]
    ds_read_b128 v[96:99], v6 offset:33280
    s_mov_b64 exec, -1
    v_exp_f32 v34, v34
    v_exp_f32 v35, v35
    v_exp_f32 v36, v36
    v_exp_f32 v37, v37
    s_add_u32 s43, s93, 2818048
    buffer_load_dwordx4 v[180:183], v118, s[28:31], s43 offen
    s_waitcnt lgkmcnt(2)
    v_mfma_f32_32x32x16_bf16 v[48:63], v[88:91], v[8:11], v[16:31]
    ds_read_b128 v[88:91], v5 offset:34816
    v_exp_f32 v38, v38
    v_exp_f32 v39, v39
    v_cvt_pk_bf16_f32 v64, v32, v33
    v_cvt_pk_bf16_f32 v65, v34, v35
    v_cvt_pk_bf16_f32 v66, v36, v37
    v_cvt_pk_bf16_f32 v67, v38, v39
    v_exp_f32 v40, v40
    v_exp_f32 v41, v41
    s_waitcnt lgkmcnt(2)
    v_mfma_f32_32x32x16_bf16 v[72:87], v[92:95], v[64:67], v[72:87]
    s_mov_b64 exec, s[50:51]
    ds_read_b128 v[92:95], v6 offset:33792
    s_mov_b64 exec, -1
    v_exp_f32 v42, v42
    v_exp_f32 v43, v43
    v_exp_f32 v44, v44
    v_exp_f32 v45, v45
    v_exp_f32 v46, v46
    v_exp_f32 v47, v47
    v_cvt_pk_bf16_f32 v68, v40, v41
    v_cvt_pk_bf16_f32 v69, v42, v43
    v_cvt_pk_bf16_f32 v70, v44, v45
    v_cvt_pk_bf16_f32 v71, v46, v47
    v_exp_f32 v48, v48
    v_exp_f32 v49, v49
    s_waitcnt lgkmcnt(2)
    v_mfma_f32_32x32x16_bf16 v[72:87], v[96:99], v[68:71], v[72:87]
    s_mov_b64 exec, s[50:51]
    ds_read_b128 v[96:99], v6 offset:34304
    s_mov_b64 exec, -1
    v_exp_f32 v50, v50
    v_exp_f32 v51, v51
    v_exp_f32 v52, v52
    v_exp_f32 v53, v53
    s_waitcnt lgkmcnt(2)
    v_mfma_f32_32x32x16_bf16 v[32:47], v[88:91], v[8:11], v[16:31]
    ds_read_b128 v[88:91], v5 offset:35840
    v_exp_f32 v54, v54
    v_exp_f32 v55, v55
    v_cvt_pk_bf16_f32 v64, v48, v49
    v_cvt_pk_bf16_f32 v65, v50, v51
    v_cvt_pk_bf16_f32 v66, v52, v53
    v_cvt_pk_bf16_f32 v67, v54, v55
    v_exp_f32 v56, v56
    v_exp_f32 v57, v57
    s_waitcnt lgkmcnt(2)
    v_mfma_f32_32x32x16_bf16 v[72:87], v[92:95], v[64:67], v[72:87]
    s_mov_b64 exec, s[50:51]
    ds_read_b128 v[92:95], v6 offset:34816
    s_mov_b64 exec, -1
    v_exp_f32 v58, v58
    v_exp_f32 v59, v59
    v_exp_f32 v60, v60
    v_exp_f32 v61, v61
    v_exp_f32 v62, v62
    v_exp_f32 v63, v63
    v_cvt_pk_bf16_f32 v68, v56, v57
    v_cvt_pk_bf16_f32 v69, v58, v59
    v_cvt_pk_bf16_f32 v70, v60, v61
    v_cvt_pk_bf16_f32 v71, v62, v63
    v_exp_f32 v32, v32
    v_exp_f32 v33, v33
    s_waitcnt lgkmcnt(2)
    v_mfma_f32_32x32x16_bf16 v[72:87], v[96:99], v[68:71], v[72:87]
    s_mov_b64 exec, s[50:51]
    ds_read_b128 v[96:99], v6 offset:35328
    s_mov_b64 exec, -1
    v_exp_f32 v34, v34
    v_exp_f32 v35, v35
    v_exp_f32 v36, v36
    v_exp_f32 v37, v37
    s_add_u32 s43, s93, 2818048
    buffer_load_dwordx4 v[184:187], v119, s[28:31], s43 offen
    s_waitcnt lgkmcnt(2)
    v_mfma_f32_32x32x16_bf16 v[48:63], v[88:91], v[8:11], v[16:31]
    ds_read_b128 v[88:91], v5 offset:36864
    v_exp_f32 v38, v38
    v_exp_f32 v39, v39
    v_cvt_pk_bf16_f32 v64, v32, v33
    v_cvt_pk_bf16_f32 v65, v34, v35
    v_cvt_pk_bf16_f32 v66, v36, v37
    v_cvt_pk_bf16_f32 v67, v38, v39
    v_exp_f32 v40, v40
    v_exp_f32 v41, v41
    s_waitcnt lgkmcnt(2)
    v_mfma_f32_32x32x16_bf16 v[72:87], v[92:95], v[64:67], v[72:87]
    s_mov_b64 exec, s[50:51]
    ds_read_b128 v[92:95], v6 offset:35840
    s_mov_b64 exec, -1
    v_exp_f32 v42, v42
    v_exp_f32 v43, v43
    v_exp_f32 v44, v44
    v_exp_f32 v45, v45
    v_exp_f32 v46, v46
    v_exp_f32 v47, v47
    v_cvt_pk_bf16_f32 v68, v40, v41
    v_cvt_pk_bf16_f32 v69, v42, v43
    v_cvt_pk_bf16_f32 v70, v44, v45
    v_cvt_pk_bf16_f32 v71, v46, v47
    v_exp_f32 v48, v48
    v_exp_f32 v49, v49
    s_waitcnt lgkmcnt(2)
    v_mfma_f32_32x32x16_bf16 v[72:87], v[96:99], v[68:71], v[72:87]
    s_mov_b64 exec, s[50:51]
    ds_read_b128 v[96:99], v6 offset:36352
    s_mov_b64 exec, -1
    v_exp_f32 v50, v50
    v_exp_f32 v51, v51
    v_exp_f32 v52, v52
    v_exp_f32 v53, v53
    s_waitcnt lgkmcnt(2)
    v_mfma_f32_32x32x16_bf16 v[32:47], v[88:91], v[8:11], v[16:31]
    ds_read_b128 v[88:91], v5 offset:37888
    v_exp_f32 v54, v54
    v_exp_f32 v55, v55
    v_cvt_pk_bf16_f32 v64, v48, v49
    v_cvt_pk_bf16_f32 v65, v50, v51
    v_cvt_pk_bf16_f32 v66, v52, v53
    v_cvt_pk_bf16_f32 v67, v54, v55
    v_exp_f32 v56, v56
    v_exp_f32 v57, v57
    s_waitcnt lgkmcnt(2)
    v_mfma_f32_32x32x16_bf16 v[72:87], v[92:95], v[64:67], v[72:87]
    s_mov_b64 exec, s[50:51]
    ds_read_b128 v[92:95], v6 offset:36864
    s_mov_b64 exec, -1
    v_exp_f32 v58, v58
    v_exp_f32 v59, v59
    v_exp_f32 v60, v60
    v_exp_f32 v61, v61
    v_exp_f32 v62, v62
    v_exp_f32 v63, v63
    v_cvt_pk_bf16_f32 v68, v56, v57
    v_cvt_pk_bf16_f32 v69, v58, v59
    v_cvt_pk_bf16_f32 v70, v60, v61
    v_cvt_pk_bf16_f32 v71, v62, v63
    v_exp_f32 v32, v32
    v_exp_f32 v33, v33
    s_waitcnt lgkmcnt(2)
    v_mfma_f32_32x32x16_bf16 v[72:87], v[96:99], v[68:71], v[72:87]
    s_mov_b64 exec, s[50:51]
    ds_read_b128 v[96:99], v6 offset:37376
    s_mov_b64 exec, -1
    v_exp_f32 v34, v34
    v_exp_f32 v35, v35
    v_exp_f32 v36, v36
    v_exp_f32 v37, v37
    s_add_u32 s43, s93, 3522560
    buffer_load_dwordx4 v[188:191], v117, s[28:31], s43 offen
    s_waitcnt lgkmcnt(2)
    v_mfma_f32_32x32x16_bf16 v[48:63], v[88:91], v[8:11], v[16:31]
    ds_read_b128 v[88:91], v5 offset:38912
    v_exp_f32 v38, v38
    v_exp_f32 v39, v39
    v_cvt_pk_bf16_f32 v64, v32, v33
    v_cvt_pk_bf16_f32 v65, v34, v35
    v_cvt_pk_bf16_f32 v66, v36, v37
    v_cvt_pk_bf16_f32 v67, v38, v39
    v_exp_f32 v40, v40
    v_exp_f32 v41, v41
    s_waitcnt lgkmcnt(2)
    v_mfma_f32_32x32x16_bf16 v[72:87], v[92:95], v[64:67], v[72:87]
    s_mov_b64 exec, s[50:51]
    ds_read_b128 v[92:95], v6 offset:37888
    s_mov_b64 exec, -1
    v_exp_f32 v42, v42
    v_exp_f32 v43, v43
    v_exp_f32 v44, v44
    v_exp_f32 v45, v45
    v_exp_f32 v46, v46
    v_exp_f32 v47, v47
    v_cvt_pk_bf16_f32 v68, v40, v41
    v_cvt_pk_bf16_f32 v69, v42, v43
    v_cvt_pk_bf16_f32 v70, v44, v45
    v_cvt_pk_bf16_f32 v71, v46, v47
    v_exp_f32 v48, v48
    v_exp_f32 v49, v49
    s_waitcnt lgkmcnt(2)
    v_mfma_f32_32x32x16_bf16 v[72:87], v[96:99], v[68:71], v[72:87]
    s_mov_b64 exec, s[50:51]
    ds_read_b128 v[96:99], v6 offset:38400
    s_mov_b64 exec, -1
    v_exp_f32 v50, v50
    v_exp_f32 v51, v51
    v_exp_f32 v52, v52
    v_exp_f32 v53, v53
    s_waitcnt lgkmcnt(2)
    v_mfma_f32_32x32x16_bf16 v[32:47], v[88:91], v[8:11], v[16:31]
    ds_read_b128 v[88:91], v5 offset:39936
    v_exp_f32 v54, v54
    v_exp_f32 v55, v55
    v_cvt_pk_bf16_f32 v64, v48, v49
    v_cvt_pk_bf16_f32 v65, v50, v51
    v_cvt_pk_bf16_f32 v66, v52, v53
    v_cvt_pk_bf16_f32 v67, v54, v55
    v_exp_f32 v56, v56
    v_exp_f32 v57, v57
    s_waitcnt lgkmcnt(2)
    v_mfma_f32_32x32x16_bf16 v[72:87], v[92:95], v[64:67], v[72:87]
    s_mov_b64 exec, s[50:51]
    ds_read_b128 v[92:95], v6 offset:38912
    s_mov_b64 exec, -1
    v_exp_f32 v58, v58
    v_exp_f32 v59, v59
    v_exp_f32 v60, v60
    v_exp_f32 v61, v61
    v_exp_f32 v62, v62
    v_exp_f32 v63, v63
    v_cvt_pk_bf16_f32 v68, v56, v57
    v_cvt_pk_bf16_f32 v69, v58, v59
    v_cvt_pk_bf16_f32 v70, v60, v61
    v_cvt_pk_bf16_f32 v71, v62, v63
    v_exp_f32 v32, v32
    v_exp_f32 v33, v33
    s_waitcnt lgkmcnt(2)
    v_mfma_f32_32x32x16_bf16 v[72:87], v[96:99], v[68:71], v[72:87]
    s_mov_b64 exec, s[50:51]
    ds_read_b128 v[96:99], v6 offset:39424
    s_mov_b64 exec, -1
    v_exp_f32 v34, v34
    v_exp_f32 v35, v35
    v_exp_f32 v36, v36
    v_exp_f32 v37, v37
    s_add_u32 s43, s93, 3522560
    buffer_load_dwordx4 v[192:195], v118, s[28:31], s43 offen
    s_waitcnt lgkmcnt(2)
    v_mfma_f32_32x32x16_bf16 v[48:63], v[88:91], v[8:11], v[16:31]
    ds_read_b128 v[88:91], v5 offset:40960
    v_exp_f32 v38, v38
    v_exp_f32 v39, v39
    v_cvt_pk_bf16_f32 v64, v32, v33
    v_cvt_pk_bf16_f32 v65, v34, v35
    v_cvt_pk_bf16_f32 v66, v36, v37
    v_cvt_pk_bf16_f32 v67, v38, v39
    v_exp_f32 v40, v40
    v_exp_f32 v41, v41
    s_waitcnt lgkmcnt(2)
    v_mfma_f32_32x32x16_bf16 v[72:87], v[92:95], v[64:67], v[72:87]
    s_mov_b64 exec, s[50:51]
    ds_read_b128 v[92:95], v6 offset:39936
    s_mov_b64 exec, -1
    v_exp_f32 v42, v42
    v_exp_f32 v43, v43
    v_exp_f32 v44, v44
    v_exp_f32 v45, v45
    v_exp_f32 v46, v46
    v_exp_f32 v47, v47
    v_cvt_pk_bf16_f32 v68, v40, v41
    v_cvt_pk_bf16_f32 v69, v42, v43
    v_cvt_pk_bf16_f32 v70, v44, v45
    v_cvt_pk_bf16_f32 v71, v46, v47
    v_exp_f32 v48, v48
    v_exp_f32 v49, v49
    s_waitcnt lgkmcnt(2)
    v_mfma_f32_32x32x16_bf16 v[72:87], v[96:99], v[68:71], v[72:87]
    s_mov_b64 exec, s[50:51]
    ds_read_b128 v[96:99], v6 offset:40448
    s_mov_b64 exec, -1
    v_exp_f32 v50, v50
    v_exp_f32 v51, v51
    v_exp_f32 v52, v52
    v_exp_f32 v53, v53
    s_waitcnt lgkmcnt(2)
    v_mfma_f32_32x32x16_bf16 v[32:47], v[88:91], v[8:11], v[16:31]
    ds_read_b128 v[88:91], v5 offset:41984
    v_exp_f32 v54, v54
    v_exp_f32 v55, v55
    v_cvt_pk_bf16_f32 v64, v48, v49
    v_cvt_pk_bf16_f32 v65, v50, v51
    v_cvt_pk_bf16_f32 v66, v52, v53
    v_cvt_pk_bf16_f32 v67, v54, v55
    v_exp_f32 v56, v56
    v_exp_f32 v57, v57
    s_waitcnt lgkmcnt(2)
    v_mfma_f32_32x32x16_bf16 v[72:87], v[92:95], v[64:67], v[72:87]
    s_mov_b64 exec, s[50:51]
    ds_read_b128 v[92:95], v6 offset:40960
    s_mov_b64 exec, -1
    v_exp_f32 v58, v58
    v_exp_f32 v59, v59
    v_exp_f32 v60, v60
    v_exp_f32 v61, v61
    v_exp_f32 v62, v62
    v_exp_f32 v63, v63
    v_cvt_pk_bf16_f32 v68, v56, v57
    v_cvt_pk_bf16_f32 v69, v58, v59
    v_cvt_pk_bf16_f32 v70, v60, v61
    v_cvt_pk_bf16_f32 v71, v62, v63
    v_exp_f32 v32, v32
    v_exp_f32 v33, v33
    s_waitcnt lgkmcnt(2)
    v_mfma_f32_32x32x16_bf16 v[72:87], v[96:99], v[68:71], v[72:87]
    s_mov_b64 exec, s[50:51]
    ds_read_b128 v[96:99], v6 offset:41472
    s_mov_b64 exec, -1
    v_exp_f32 v34, v34
    v_exp_f32 v35, v35
    v_exp_f32 v36, v36
    v_exp_f32 v37, v37
    s_add_u32 s43, s93, 3522560
    buffer_load_dwordx4 v[196:199], v119, s[28:31], s43 offen
    s_waitcnt lgkmcnt(2)
    v_mfma_f32_32x32x16_bf16 v[48:63], v[88:91], v[8:11], v[16:31]
    ds_read_b128 v[88:91], v5 offset:43008
    v_exp_f32 v38, v38
    v_exp_f32 v39, v39
    v_cvt_pk_bf16_f32 v64, v32, v33
    v_cvt_pk_bf16_f32 v65, v34, v35
    v_cvt_pk_bf16_f32 v66, v36, v37
    v_cvt_pk_bf16_f32 v67, v38, v39
    v_exp_f32 v40, v40
    v_exp_f32 v41, v41
    s_waitcnt lgkmcnt(2)
    v_mfma_f32_32x32x16_bf16 v[72:87], v[92:95], v[64:67], v[72:87]
    s_mov_b64 exec, s[50:51]
    ds_read_b128 v[92:95], v6 offset:41984
    s_mov_b64 exec, -1
    v_exp_f32 v42, v42
    v_exp_f32 v43, v43
    v_exp_f32 v44, v44
    v_exp_f32 v45, v45
    v_exp_f32 v46, v46
    v_exp_f32 v47, v47
    v_cvt_pk_bf16_f32 v68, v40, v41
    v_cvt_pk_bf16_f32 v69, v42, v43
    v_cvt_pk_bf16_f32 v70, v44, v45
    v_cvt_pk_bf16_f32 v71, v46, v47
    v_exp_f32 v48, v48
    v_exp_f32 v49, v49
    s_waitcnt lgkmcnt(2)
    v_mfma_f32_32x32x16_bf16 v[72:87], v[96:99], v[68:71], v[72:87]
    s_mov_b64 exec, s[50:51]
    ds_read_b128 v[96:99], v6 offset:42496
    s_mov_b64 exec, -1
    v_exp_f32 v50, v50
    v_exp_f32 v51, v51
    v_exp_f32 v52, v52
    v_exp_f32 v53, v53
    buffer_load_dwordx2 v[224:225], v120, s[52:55], s92 offen offset:0
    buffer_load_dwordx2 v[226:227], v120, s[52:55], s92 offen offset:16
    buffer_load_dwordx2 v[228:229], v120, s[52:55], s92 offen offset:32
    buffer_load_dwordx2 v[230:231], v120, s[52:55], s92 offen offset:48
    s_waitcnt lgkmcnt(2)
    v_mfma_f32_32x32x16_bf16 v[32:47], v[88:91], v[8:11], v[16:31]
    ds_read_b128 v[88:91], v5 offset:44032
    v_exp_f32 v54, v54
    v_exp_f32 v55, v55
    v_cvt_pk_bf16_f32 v64, v48, v49
    v_cvt_pk_bf16_f32 v65, v50, v51
    v_cvt_pk_bf16_f32 v66, v52, v53
    v_cvt_pk_bf16_f32 v67, v54, v55
    v_exp_f32 v56, v56
    v_exp_f32 v57, v57
    s_waitcnt lgkmcnt(2)
    v_mfma_f32_32x32x16_bf16 v[72:87], v[92:95], v[64:67], v[72:87]
    s_mov_b64 exec, s[50:51]
    ds_read_b128 v[92:95], v6 offset:43008
    s_mov_b64 exec, -1
    v_exp_f32 v58, v58
    v_exp_f32 v59, v59
    v_exp_f32 v60, v60
    v_exp_f32 v61, v61
    v_exp_f32 v62, v62
    v_exp_f32 v63, v63
    v_cvt_pk_bf16_f32 v68, v56, v57
    v_cvt_pk_bf16_f32 v69, v58, v59
    v_cvt_pk_bf16_f32 v70, v60, v61
    v_cvt_pk_bf16_f32 v71, v62, v63
    v_exp_f32 v32, v32
    v_exp_f32 v33, v33
    s_waitcnt lgkmcnt(2)
    v_mfma_f32_32x32x16_bf16 v[72:87], v[96:99], v[68:71], v[72:87]
    s_mov_b64 exec, s[50:51]
    ds_read_b128 v[96:99], v6 offset:43520
    s_mov_b64 exec, -1
    v_exp_f32 v34, v34
    v_exp_f32 v35, v35
    v_exp_f32 v36, v36
    v_exp_f32 v37, v37
    s_add_u32 s43, s93, 4227072
    buffer_load_dwordx4 v[200:203], v117, s[28:31], s43 offen
    s_waitcnt lgkmcnt(2)
    v_mfma_f32_32x32x16_bf16 v[48:63], v[88:91], v[8:11], v[16:31]
    ds_read_b128 v[88:91], v5 offset:45056
    v_exp_f32 v38, v38
    v_exp_f32 v39, v39
    v_cvt_pk_bf16_f32 v64, v32, v33
    v_cvt_pk_bf16_f32 v65, v34, v35
    v_cvt_pk_bf16_f32 v66, v36, v37
    v_cvt_pk_bf16_f32 v67, v38, v39
    v_exp_f32 v40, v40
    v_exp_f32 v41, v41
    s_waitcnt lgkmcnt(2)
    v_mfma_f32_32x32x16_bf16 v[72:87], v[92:95], v[64:67], v[72:87]
    s_mov_b64 exec, s[50:51]
    ds_read_b128 v[92:95], v6 offset:44032
    s_mov_b64 exec, -1
    v_exp_f32 v42, v42
    v_exp_f32 v43, v43
    v_exp_f32 v44, v44
    v_exp_f32 v45, v45
    v_exp_f32 v46, v46
    v_exp_f32 v47, v47
    v_cvt_pk_bf16_f32 v68, v40, v41
    v_cvt_pk_bf16_f32 v69, v42, v43
    v_cvt_pk_bf16_f32 v70, v44, v45
    v_cvt_pk_bf16_f32 v71, v46, v47
    v_exp_f32 v48, v48
    v_exp_f32 v49, v49
    s_waitcnt lgkmcnt(2)
    v_mfma_f32_32x32x16_bf16 v[72:87], v[96:99], v[68:71], v[72:87]
    s_mov_b64 exec, s[50:51]
    ds_read_b128 v[96:99], v6 offset:44544
    s_mov_b64 exec, -1
    v_exp_f32 v50, v50
    v_exp_f32 v51, v51
    v_exp_f32 v52, v52
    v_exp_f32 v53, v53
    s_waitcnt lgkmcnt(2)
    v_mfma_f32_32x32x16_bf16 v[32:47], v[88:91], v[8:11], v[16:31]
    ds_read_b128 v[88:91], v5 offset:46080
    v_exp_f32 v54, v54
    v_exp_f32 v55, v55
    v_cvt_pk_bf16_f32 v64, v48, v49
    v_cvt_pk_bf16_f32 v65, v50, v51
    v_cvt_pk_bf16_f32 v66, v52, v53
    v_cvt_pk_bf16_f32 v67, v54, v55
    v_exp_f32 v56, v56
    v_exp_f32 v57, v57
    s_waitcnt lgkmcnt(2)
    v_mfma_f32_32x32x16_bf16 v[72:87], v[92:95], v[64:67], v[72:87]
    s_mov_b64 exec, s[50:51]
    ds_read_b128 v[92:95], v6 offset:45056
    s_mov_b64 exec, -1
    v_exp_f32 v58, v58
    v_exp_f32 v59, v59
    v_exp_f32 v60, v60
    v_exp_f32 v61, v61
    v_exp_f32 v62, v62
    v_exp_f32 v63, v63
    v_cvt_pk_bf16_f32 v68, v56, v57
    v_cvt_pk_bf16_f32 v69, v58, v59
    v_cvt_pk_bf16_f32 v70, v60, v61
    v_cvt_pk_bf16_f32 v71, v62, v63
    v_exp_f32 v32, v32
    v_exp_f32 v33, v33
    s_waitcnt lgkmcnt(2)
    v_mfma_f32_32x32x16_bf16 v[72:87], v[96:99], v[68:71], v[72:87]
    s_mov_b64 exec, s[50:51]
    ds_read_b128 v[96:99], v6 offset:45568
    s_mov_b64 exec, -1
    v_exp_f32 v34, v34
    v_exp_f32 v35, v35
    v_exp_f32 v36, v36
    v_exp_f32 v37, v37
    s_add_u32 s43, s93, 4227072
    buffer_load_dwordx4 v[204:207], v118, s[28:31], s43 offen
    s_waitcnt lgkmcnt(2)
    v_mfma_f32_32x32x16_bf16 v[48:63], v[88:91], v[8:11], v[16:31]
    ds_read_b128 v[88:91], v5 offset:47104
    v_exp_f32 v38, v38
    v_exp_f32 v39, v39
    v_cvt_pk_bf16_f32 v64, v32, v33
    v_cvt_pk_bf16_f32 v65, v34, v35
    v_cvt_pk_bf16_f32 v66, v36, v37
    v_cvt_pk_bf16_f32 v67, v38, v39
    v_exp_f32 v40, v40
    v_exp_f32 v41, v41
    s_waitcnt lgkmcnt(2)
    v_mfma_f32_32x32x16_bf16 v[72:87], v[92:95], v[64:67], v[72:87]
    s_mov_b64 exec, s[50:51]
    ds_read_b128 v[92:95], v6 offset:46080
    s_mov_b64 exec, -1
    v_exp_f32 v42, v42
    v_exp_f32 v43, v43
    v_exp_f32 v44, v44
    v_exp_f32 v45, v45
    v_exp_f32 v46, v46
    v_exp_f32 v47, v47
    v_cvt_pk_bf16_f32 v68, v40, v41
    v_cvt_pk_bf16_f32 v69, v42, v43
    v_cvt_pk_bf16_f32 v70, v44, v45
    v_cvt_pk_bf16_f32 v71, v46, v47
    v_exp_f32 v48, v48
    v_exp_f32 v49, v49
    s_waitcnt lgkmcnt(2)
    v_mfma_f32_32x32x16_bf16 v[72:87], v[96:99], v[68:71], v[72:87]
    s_mov_b64 exec, s[50:51]
    ds_read_b128 v[96:99], v6 offset:46592
    s_mov_b64 exec, -1
    v_exp_f32 v50, v50
    v_exp_f32 v51, v51
    v_exp_f32 v52, v52
    v_exp_f32 v53, v53
    s_waitcnt lgkmcnt(2)
    v_mfma_f32_32x32x16_bf16 v[32:47], v[88:91], v[8:11], v[16:31]
    ds_read_b128 v[88:91], v5 offset:48128
    v_exp_f32 v54, v54
    v_exp_f32 v55, v55
    v_cvt_pk_bf16_f32 v64, v48, v49
    v_cvt_pk_bf16_f32 v65, v50, v51
    v_cvt_pk_bf16_f32 v66, v52, v53
    v_cvt_pk_bf16_f32 v67, v54, v55
    v_exp_f32 v56, v56
    v_exp_f32 v57, v57
    s_waitcnt lgkmcnt(2)
    v_mfma_f32_32x32x16_bf16 v[72:87], v[92:95], v[64:67], v[72:87]
    s_mov_b64 exec, s[50:51]
    ds_read_b128 v[92:95], v6 offset:47104
    s_mov_b64 exec, -1
    v_exp_f32 v58, v58
    v_exp_f32 v59, v59
    v_exp_f32 v60, v60
    v_exp_f32 v61, v61
    v_exp_f32 v62, v62
    v_exp_f32 v63, v63
    v_cvt_pk_bf16_f32 v68, v56, v57
    v_cvt_pk_bf16_f32 v69, v58, v59
    v_cvt_pk_bf16_f32 v70, v60, v61
    v_cvt_pk_bf16_f32 v71, v62, v63
    v_exp_f32 v32, v32
    v_exp_f32 v33, v33
    s_waitcnt lgkmcnt(2)
    v_mfma_f32_32x32x16_bf16 v[72:87], v[96:99], v[68:71], v[72:87]
    s_mov_b64 exec, s[50:51]
    ds_read_b128 v[96:99], v6 offset:47616
    s_mov_b64 exec, -1
    v_exp_f32 v34, v34
    v_exp_f32 v35, v35
    v_exp_f32 v36, v36
    v_exp_f32 v37, v37
    s_add_u32 s43, s93, 4227072
    buffer_load_dwordx4 v[208:211], v119, s[28:31], s43 offen
    s_waitcnt lgkmcnt(2)
    v_mfma_f32_32x32x16_bf16 v[48:63], v[88:91], v[8:11], v[16:31]
    ds_read_b128 v[88:91], v5 offset:49152
    v_exp_f32 v38, v38
    v_exp_f32 v39, v39
    v_cvt_pk_bf16_f32 v64, v32, v33
    v_cvt_pk_bf16_f32 v65, v34, v35
    v_cvt_pk_bf16_f32 v66, v36, v37
    v_cvt_pk_bf16_f32 v67, v38, v39
    v_exp_f32 v40, v40
    v_exp_f32 v41, v41
    s_waitcnt lgkmcnt(2)
    v_mfma_f32_32x32x16_bf16 v[72:87], v[92:95], v[64:67], v[72:87]
    s_mov_b64 exec, s[50:51]
    ds_read_b128 v[92:95], v6 offset:48128
    s_mov_b64 exec, -1
    v_exp_f32 v42, v42
    v_exp_f32 v43, v43
    v_exp_f32 v44, v44
    v_exp_f32 v45, v45
    v_exp_f32 v46, v46
    v_exp_f32 v47, v47
    v_cvt_pk_bf16_f32 v68, v40, v41
    v_cvt_pk_bf16_f32 v69, v42, v43
    v_cvt_pk_bf16_f32 v70, v44, v45
    v_cvt_pk_bf16_f32 v71, v46, v47
    v_exp_f32 v48, v48
    v_exp_f32 v49, v49
    s_waitcnt lgkmcnt(2)
    v_mfma_f32_32x32x16_bf16 v[72:87], v[96:99], v[68:71], v[72:87]
    s_mov_b64 exec, s[50:51]
    ds_read_b128 v[96:99], v6 offset:48640
    s_mov_b64 exec, -1
    v_exp_f32 v50, v50
    v_exp_f32 v51, v51
    v_exp_f32 v52, v52
    v_exp_f32 v53, v53
    s_waitcnt lgkmcnt(2)
    v_mfma_f32_32x32x16_bf16 v[32:47], v[88:91], v[8:11], v[16:31]
    ds_read_b128 v[88:91], v5 offset:50176
    v_exp_f32 v54, v54
    v_exp_f32 v55, v55
    v_cvt_pk_bf16_f32 v64, v48, v49
    v_cvt_pk_bf16_f32 v65, v50, v51
    v_cvt_pk_bf16_f32 v66, v52, v53
    v_cvt_pk_bf16_f32 v67, v54, v55
    v_exp_f32 v56, v56
    v_exp_f32 v57, v57
    s_waitcnt lgkmcnt(2)
    v_mfma_f32_32x32x16_bf16 v[72:87], v[92:95], v[64:67], v[72:87]
    s_mov_b64 exec, s[50:51]
    ds_read_b128 v[92:95], v6 offset:49152
    s_mov_b64 exec, -1
    v_exp_f32 v58, v58
    v_exp_f32 v59, v59
    v_exp_f32 v60, v60
    v_exp_f32 v61, v61
    v_exp_f32 v62, v62
    v_exp_f32 v63, v63
    v_cvt_pk_bf16_f32 v68, v56, v57
    v_cvt_pk_bf16_f32 v69, v58, v59
    v_cvt_pk_bf16_f32 v70, v60, v61
    v_cvt_pk_bf16_f32 v71, v62, v63
    v_exp_f32 v32, v32
    v_exp_f32 v33, v33
    s_waitcnt lgkmcnt(2)
    v_mfma_f32_32x32x16_bf16 v[72:87], v[96:99], v[68:71], v[72:87]
    s_mov_b64 exec, s[50:51]
    ds_read_b128 v[96:99], v6 offset:49664
    s_mov_b64 exec, -1
    v_exp_f32 v34, v34
    v_exp_f32 v35, v35
    v_exp_f32 v36, v36
    v_exp_f32 v37, v37
    s_add_u32 s43, s93, 4931584
    buffer_load_dwordx4 v[212:215], v117, s[28:31], s43 offen
    s_waitcnt lgkmcnt(2)
    v_mfma_f32_32x32x16_bf16 v[48:63], v[88:91], v[8:11], v[16:31]
    ds_read_b128 v[88:91], v5 offset:51200
    v_exp_f32 v38, v38
    v_exp_f32 v39, v39
    v_cvt_pk_bf16_f32 v64, v32, v33
    v_cvt_pk_bf16_f32 v65, v34, v35
    v_cvt_pk_bf16_f32 v66, v36, v37
    v_cvt_pk_bf16_f32 v67, v38, v39
    v_exp_f32 v40, v40
    v_exp_f32 v41, v41
    s_waitcnt lgkmcnt(2)
    v_mfma_f32_32x32x16_bf16 v[72:87], v[92:95], v[64:67], v[72:87]
    s_mov_b64 exec, s[50:51]
    ds_read_b128 v[92:95], v6 offset:50176
    s_mov_b64 exec, -1
    v_exp_f32 v42, v42
    v_exp_f32 v43, v43
    v_exp_f32 v44, v44
    v_exp_f32 v45, v45
    v_exp_f32 v46, v46
    v_exp_f32 v47, v47
    v_cvt_pk_bf16_f32 v68, v40, v41
    v_cvt_pk_bf16_f32 v69, v42, v43
    v_cvt_pk_bf16_f32 v70, v44, v45
    v_cvt_pk_bf16_f32 v71, v46, v47
    v_exp_f32 v48, v48
    v_exp_f32 v49, v49
    s_waitcnt lgkmcnt(2)
    v_mfma_f32_32x32x16_bf16 v[72:87], v[96:99], v[68:71], v[72:87]
    s_mov_b64 exec, s[50:51]
    ds_read_b128 v[96:99], v6 offset:50688
    s_mov_b64 exec, -1
    v_exp_f32 v50, v50
    v_exp_f32 v51, v51
    v_exp_f32 v52, v52
    v_exp_f32 v53, v53
    s_waitcnt lgkmcnt(2)
    v_mfma_f32_32x32x16_bf16 v[32:47], v[88:91], v[8:11], v[16:31]
    ds_read_b128 v[88:91], v5 offset:52224
    v_exp_f32 v54, v54
    v_exp_f32 v55, v55
    v_cvt_pk_bf16_f32 v64, v48, v49
    v_cvt_pk_bf16_f32 v65, v50, v51
    v_cvt_pk_bf16_f32 v66, v52, v53
    v_cvt_pk_bf16_f32 v67, v54, v55
    v_exp_f32 v56, v56
    v_exp_f32 v57, v57
    s_waitcnt lgkmcnt(2)
    v_mfma_f32_32x32x16_bf16 v[72:87], v[92:95], v[64:67], v[72:87]
    s_mov_b64 exec, s[50:51]
    ds_read_b128 v[92:95], v6 offset:51200
    s_mov_b64 exec, -1
    v_exp_f32 v58, v58
    v_exp_f32 v59, v59
    v_exp_f32 v60, v60
    v_exp_f32 v61, v61
    v_exp_f32 v62, v62
    v_exp_f32 v63, v63
    v_cvt_pk_bf16_f32 v68, v56, v57
    v_cvt_pk_bf16_f32 v69, v58, v59
    v_cvt_pk_bf16_f32 v70, v60, v61
    v_cvt_pk_bf16_f32 v71, v62, v63
    v_exp_f32 v32, v32
    v_exp_f32 v33, v33
    s_waitcnt lgkmcnt(2)
    v_mfma_f32_32x32x16_bf16 v[72:87], v[96:99], v[68:71], v[72:87]
    s_mov_b64 exec, s[50:51]
    ds_read_b128 v[96:99], v6 offset:51712
    s_mov_b64 exec, -1
    v_exp_f32 v34, v34
    v_exp_f32 v35, v35
    v_exp_f32 v36, v36
    v_exp_f32 v37, v37
    s_lshr_b32 s100, s27, 1
    s_lshl_b32 s100, s100, 1
    s_lshr_b32 s47, s3, 4
    s_add_u32 s100, s100, s47
    s_lshl_b32 s100, s100, 11
    s_add_u32 s100, s100, 14434304
    s_xor_b32 s47, s3, s27
    s_and_b32 s47, s47, 7
    s_lshl_b32 s47, s47, 8
    s_add_u32 s100, s100, s47
    v_mov_b32 v124, 0
    buffer_load_dword v123, v124, s[36:39], s100 offen sc1
    s_add_u32 s43, s93, 4931584
    buffer_load_dwordx4 v[216:219], v118, s[28:31], s43 offen
    s_waitcnt lgkmcnt(2)
    v_mfma_f32_32x32x16_bf16 v[48:63], v[88:91], v[8:11], v[16:31]
    ds_read_b128 v[88:91], v5 offset:53248
    v_exp_f32 v38, v38
    v_exp_f32 v39, v39
    v_cvt_pk_bf16_f32 v64, v32, v33
    v_cvt_pk_bf16_f32 v65, v34, v35
    v_cvt_pk_bf16_f32 v66, v36, v37
    v_cvt_pk_bf16_f32 v67, v38, v39
    v_exp_f32 v40, v40
    v_exp_f32 v41, v41
    s_waitcnt lgkmcnt(2)
    v_mfma_f32_32x32x16_bf16 v[72:87], v[92:95], v[64:67], v[72:87]
    s_mov_b64 exec, s[50:51]
    ds_read_b128 v[92:95], v6 offset:52224
    s_mov_b64 exec, -1
    v_exp_f32 v42, v42
    v_exp_f32 v43, v43
    v_exp_f32 v44, v44
    v_exp_f32 v45, v45
    v_exp_f32 v46, v46
    v_exp_f32 v47, v47
    v_cvt_pk_bf16_f32 v68, v40, v41
    v_cvt_pk_bf16_f32 v69, v42, v43
    v_cvt_pk_bf16_f32 v70, v44, v45
    v_cvt_pk_bf16_f32 v71, v46, v47
    v_exp_f32 v48, v48
    v_exp_f32 v49, v49
    s_waitcnt lgkmcnt(2)
    v_mfma_f32_32x32x16_bf16 v[72:87], v[96:99], v[68:71], v[72:87]
    s_mov_b64 exec, s[50:51]
    ds_read_b128 v[96:99], v6 offset:52736
    s_mov_b64 exec, -1
    v_exp_f32 v50, v50
    v_exp_f32 v51, v51
    v_exp_f32 v52, v52
    v_exp_f32 v53, v53
    s_waitcnt lgkmcnt(2)
    v_mfma_f32_32x32x16_bf16 v[32:47], v[88:91], v[8:11], v[16:31]
    ds_read_b128 v[88:91], v5 offset:54272
    v_exp_f32 v54, v54
    v_exp_f32 v55, v55
    v_cvt_pk_bf16_f32 v64, v48, v49
    v_cvt_pk_bf16_f32 v65, v50, v51
    v_cvt_pk_bf16_f32 v66, v52, v53
    v_cvt_pk_bf16_f32 v67, v54, v55
    v_exp_f32 v56, v56
    v_exp_f32 v57, v57
    s_waitcnt lgkmcnt(2)
    v_mfma_f32_32x32x16_bf16 v[72:87], v[92:95], v[64:67], v[72:87]
    s_mov_b64 exec, s[50:51]
    ds_read_b128 v[92:95], v6 offset:53248
    s_mov_b64 exec, -1
    v_exp_f32 v58, v58
    v_exp_f32 v59, v59
    v_exp_f32 v60, v60
    v_exp_f32 v61, v61
    v_exp_f32 v62, v62
    v_exp_f32 v63, v63
    v_cvt_pk_bf16_f32 v68, v56, v57
    v_cvt_pk_bf16_f32 v69, v58, v59
    v_cvt_pk_bf16_f32 v70, v60, v61
    v_cvt_pk_bf16_f32 v71, v62, v63
    v_exp_f32 v32, v32
    v_exp_f32 v33, v33
    s_waitcnt lgkmcnt(2)
    v_mfma_f32_32x32x16_bf16 v[72:87], v[96:99], v[68:71], v[72:87]
    s_mov_b64 exec, s[50:51]
    ds_read_b128 v[96:99], v6 offset:53760
    s_mov_b64 exec, -1
    v_exp_f32 v34, v34
    v_exp_f32 v35, v35
    v_exp_f32 v36, v36
    v_exp_f32 v37, v37
    s_add_u32 s43, s93, 4931584
    buffer_load_dwordx4 v[220:223], v119, s[28:31], s43 offen
    s_waitcnt lgkmcnt(2)
    v_mfma_f32_32x32x16_bf16 v[48:63], v[88:91], v[8:11], v[16:31]
    ds_read_b128 v[88:91], v5 offset:55296
    v_exp_f32 v38, v38
    v_exp_f32 v39, v39
    v_cvt_pk_bf16_f32 v64, v32, v33
    v_cvt_pk_bf16_f32 v65, v34, v35
    v_cvt_pk_bf16_f32 v66, v36, v37
    v_cvt_pk_bf16_f32 v67, v38, v39
    v_exp_f32 v40, v40
    v_exp_f32 v41, v41
    s_waitcnt lgkmcnt(2)
    v_mfma_f32_32x32x16_bf16 v[72:87], v[92:95], v[64:67], v[72:87]
    s_mov_b64 exec, s[50:51]
    ds_read_b128 v[92:95], v6 offset:54272
    s_mov_b64 exec, -1
    v_exp_f32 v42, v42
    v_exp_f32 v43, v43
    v_exp_f32 v44, v44
    v_exp_f32 v45, v45
    v_exp_f32 v46, v46
    v_exp_f32 v47, v47
    v_cvt_pk_bf16_f32 v68, v40, v41
    v_cvt_pk_bf16_f32 v69, v42, v43
    v_cvt_pk_bf16_f32 v70, v44, v45
    v_cvt_pk_bf16_f32 v71, v46, v47
    v_exp_f32 v48, v48
    v_exp_f32 v49, v49
    s_waitcnt lgkmcnt(2)
    v_mfma_f32_32x32x16_bf16 v[72:87], v[96:99], v[68:71], v[72:87]
    s_mov_b64 exec, s[50:51]
    ds_read_b128 v[96:99], v6 offset:54784
    s_mov_b64 exec, -1
    v_exp_f32 v50, v50
    v_exp_f32 v51, v51
    v_exp_f32 v52, v52
    v_exp_f32 v53, v53
    s_waitcnt lgkmcnt(2)
    v_mfma_f32_32x32x16_bf16 v[32:47], v[88:91], v[8:11], v[16:31]
    ds_read_b128 v[88:91], v5 offset:56320
    v_exp_f32 v54, v54
    v_exp_f32 v55, v55
    v_cvt_pk_bf16_f32 v64, v48, v49
    v_cvt_pk_bf16_f32 v65, v50, v51
    v_cvt_pk_bf16_f32 v66, v52, v53
    v_cvt_pk_bf16_f32 v67, v54, v55
    v_exp_f32 v56, v56
    v_exp_f32 v57, v57
    s_waitcnt lgkmcnt(2)
    v_mfma_f32_32x32x16_bf16 v[72:87], v[92:95], v[64:67], v[72:87]
    s_mov_b64 exec, s[50:51]
    ds_read_b128 v[92:95], v6 offset:55296
    s_mov_b64 exec, -1
    v_exp_f32 v58, v58
    v_exp_f32 v59, v59
    v_exp_f32 v60, v60
    v_exp_f32 v61, v61
    v_exp_f32 v62, v62
    v_exp_f32 v63, v63
    v_cvt_pk_bf16_f32 v68, v56, v57
    v_cvt_pk_bf16_f32 v69, v58, v59
    v_cvt_pk_bf16_f32 v70, v60, v61
    v_cvt_pk_bf16_f32 v71, v62, v63
    v_exp_f32 v32, v32
    v_exp_f32 v33, v33
    s_waitcnt lgkmcnt(2)
    v_mfma_f32_32x32x16_bf16 v[72:87], v[96:99], v[68:71], v[72:87]
    s_mov_b64 exec, s[50:51]
    ds_read_b128 v[96:99], v6 offset:55808
    s_mov_b64 exec, -1
    v_exp_f32 v34, v34
    v_exp_f32 v35, v35
    v_exp_f32 v36, v36
    v_exp_f32 v37, v37
    s_mov_b32 s32, s16
    s_and_b32 s33, s17, 0xffff
    s_mov_b32 s34, 0x560000
    s_mov_b32 s35, 0x20000
    s_lshr_b32 s43, s27, 1
    s_mul_i32 s47, s43, 7
    s_add_u32 s47, s47, 1
    s_cmp_eq_u32 s43, 0
    s_cselect_b32 s47, 0, s47
    s_mul_i32 s47, s47, 96
    s_lshl_b32 s48, s3, 3
    s_add_u32 s48, s48, s26
    s_mul_i32 s48, s48, 22016
    s_add_u32 s47, s47, s48
    s_lshl_b32 s47, s43, 10
    s_mul_i32 s48, s3, 43
    s_mul_i32 s43, s26, 6
    s_add_u32 s48, s48, s43
    s_lshl_b32 s48, s48, 12
    s_add_u32 s47, s47, s48
    v_add_u32 v110, 0, v1
    v_lshrrev_b32 v111, 3, v110
    v_and_b32 v112, 7, v110
    v_lshlrev_b32 v111, 12, v111
    v_mul_u32_u24 v112, 128, v112
    v_add_u32 v111, v111, v112
    v_cmp_gt_u32 vcc, 48, v110
    s_nop 1
    s_mov_b64 exec, vcc
    buffer_load_dword v113, v111, s[32:35], s47 offen
    s_mov_b64 exec, -1
    s_mov_b32 s32, s8
    s_and_b32 s33, s9, 0xffff
    s_mov_b32 s34, 0x80000
    s_mov_b32 s35, 0x20000
    s_and_b32 s47, s27, 1
    s_lshl_b32 s47, s47, 2
    s_and_b32 s48, s3, 3
    s_add_u32 s47, s47, s48
    s_lshl_b32 s47, s47, 7
    s_lshl_b32 s48, s26, 16
    s_add_u32 s47, s47, s48
    v_lshlrev_b32 v111, 10, v1
    buffer_load_dword v113, v111, s[32:35], s47 offen
    s_waitcnt lgkmcnt(2)
    v_mfma_f32_32x32x16_bf16 v[48:63], v[88:91], v[8:11], v[16:31]
    ds_read_b128 v[88:91], v5 offset:57344
    v_exp_f32 v38, v38
    v_exp_f32 v39, v39
    v_cvt_pk_bf16_f32 v64, v32, v33
    v_cvt_pk_bf16_f32 v65, v34, v35
    v_cvt_pk_bf16_f32 v66, v36, v37
    v_cvt_pk_bf16_f32 v67, v38, v39
    v_exp_f32 v40, v40
    v_exp_f32 v41, v41
    s_waitcnt lgkmcnt(2)
    v_mfma_f32_32x32x16_bf16 v[72:87], v[92:95], v[64:67], v[72:87]
    s_mov_b64 exec, s[50:51]
    ds_read_b128 v[92:95], v6 offset:56320
    s_mov_b64 exec, -1
    v_exp_f32 v42, v42
    v_exp_f32 v43, v43
    v_exp_f32 v44, v44
    v_exp_f32 v45, v45
    v_exp_f32 v46, v46
    v_exp_f32 v47, v47
    v_cvt_pk_bf16_f32 v68, v40, v41
    v_cvt_pk_bf16_f32 v69, v42, v43
    v_cvt_pk_bf16_f32 v70, v44, v45
    v_cvt_pk_bf16_f32 v71, v46, v47
    v_exp_f32 v48, v48
    v_exp_f32 v49, v49
    s_waitcnt lgkmcnt(2)
    v_mfma_f32_32x32x16_bf16 v[72:87], v[96:99], v[68:71], v[72:87]
    s_mov_b64 exec, s[50:51]
    ds_read_b128 v[96:99], v6 offset:56832
    s_mov_b64 exec, -1
    v_exp_f32 v50, v50
    v_exp_f32 v51, v51
    v_exp_f32 v52, v52
    v_exp_f32 v53, v53
    s_waitcnt lgkmcnt(2)
    v_mfma_f32_32x32x16_bf16 v[32:47], v[88:91], v[8:11], v[16:31]
    ds_read_b128 v[88:91], v5 offset:58368
    v_exp_f32 v54, v54
    v_exp_f32 v55, v55
    v_cvt_pk_bf16_f32 v64, v48, v49
    v_cvt_pk_bf16_f32 v65, v50, v51
    v_cvt_pk_bf16_f32 v66, v52, v53
    v_cvt_pk_bf16_f32 v67, v54, v55
    v_exp_f32 v56, v56
    v_exp_f32 v57, v57
    s_waitcnt lgkmcnt(2)
    v_mfma_f32_32x32x16_bf16 v[72:87], v[92:95], v[64:67], v[72:87]
    s_mov_b64 exec, s[50:51]
    ds_read_b128 v[92:95], v6 offset:57344
    s_mov_b64 exec, -1
    v_exp_f32 v58, v58
    v_exp_f32 v59, v59
    v_exp_f32 v60, v60
    v_exp_f32 v61, v61
    v_exp_f32 v62, v62
    v_exp_f32 v63, v63
    v_cvt_pk_bf16_f32 v68, v56, v57
    v_cvt_pk_bf16_f32 v69, v58, v59
    v_cvt_pk_bf16_f32 v70, v60, v61
    v_cvt_pk_bf16_f32 v71, v62, v63
    v_exp_f32 v32, v32
    v_exp_f32 v33, v33
    s_waitcnt lgkmcnt(2)
    v_mfma_f32_32x32x16_bf16 v[72:87], v[96:99], v[68:71], v[72:87]
    s_mov_b64 exec, s[50:51]
    ds_read_b128 v[96:99], v6 offset:57856
    s_mov_b64 exec, -1
    v_exp_f32 v34, v34
    v_exp_f32 v35, v35
    v_exp_f32 v36, v36
    v_exp_f32 v37, v37
    s_waitcnt lgkmcnt(2)
    v_mfma_f32_32x32x16_bf16 v[48:63], v[88:91], v[8:11], v[16:31]
    ds_read_b128 v[88:91], v5 offset:59392
    v_exp_f32 v38, v38
    v_exp_f32 v39, v39
    v_cvt_pk_bf16_f32 v64, v32, v33
    v_cvt_pk_bf16_f32 v65, v34, v35
    v_cvt_pk_bf16_f32 v66, v36, v37
    v_cvt_pk_bf16_f32 v67, v38, v39
    v_exp_f32 v40, v40
    v_exp_f32 v41, v41
    s_waitcnt lgkmcnt(2)
    v_mfma_f32_32x32x16_bf16 v[72:87], v[92:95], v[64:67], v[72:87]
    s_mov_b64 exec, s[50:51]
    ds_read_b128 v[92:95], v6 offset:58368
    s_mov_b64 exec, -1
    v_exp_f32 v42, v42
    v_exp_f32 v43, v43
    v_exp_f32 v44, v44
    v_exp_f32 v45, v45
    v_exp_f32 v46, v46
    v_exp_f32 v47, v47
    v_cvt_pk_bf16_f32 v68, v40, v41
    v_cvt_pk_bf16_f32 v69, v42, v43
    v_cvt_pk_bf16_f32 v70, v44, v45
    v_cvt_pk_bf16_f32 v71, v46, v47
    v_exp_f32 v48, v48
    v_exp_f32 v49, v49
    s_waitcnt lgkmcnt(2)
    v_mfma_f32_32x32x16_bf16 v[72:87], v[96:99], v[68:71], v[72:87]
    s_mov_b64 exec, s[50:51]
    ds_read_b128 v[96:99], v6 offset:58880
    s_mov_b64 exec, -1
    v_exp_f32 v50, v50
    v_exp_f32 v51, v51
    v_exp_f32 v52, v52
    v_exp_f32 v53, v53
    s_waitcnt lgkmcnt(2)
    v_mfma_f32_32x32x16_bf16 v[32:47], v[88:91], v[8:11], v[16:31]
    ds_read_b128 v[88:91], v5 offset:60416
    v_exp_f32 v54, v54
    v_exp_f32 v55, v55
    v_cvt_pk_bf16_f32 v64, v48, v49
    v_cvt_pk_bf16_f32 v65, v50, v51
    v_cvt_pk_bf16_f32 v66, v52, v53
    v_cvt_pk_bf16_f32 v67, v54, v55
    v_exp_f32 v56, v56
    v_exp_f32 v57, v57
    s_waitcnt lgkmcnt(2)
    v_mfma_f32_32x32x16_bf16 v[72:87], v[92:95], v[64:67], v[72:87]
    s_mov_b64 exec, s[50:51]
    ds_read_b128 v[92:95], v6 offset:59392
    s_mov_b64 exec, -1
    v_exp_f32 v58, v58
    v_exp_f32 v59, v59
    v_exp_f32 v60, v60
    v_exp_f32 v61, v61
    v_exp_f32 v62, v62
    v_exp_f32 v63, v63
    v_cvt_pk_bf16_f32 v68, v56, v57
    v_cvt_pk_bf16_f32 v69, v58, v59
    v_cvt_pk_bf16_f32 v70, v60, v61
    v_cvt_pk_bf16_f32 v71, v62, v63
    v_exp_f32 v32, v32
    v_exp_f32 v33, v33
    s_waitcnt lgkmcnt(2)
    v_mfma_f32_32x32x16_bf16 v[72:87], v[96:99], v[68:71], v[72:87]
    s_mov_b64 exec, s[50:51]
    ds_read_b128 v[96:99], v6 offset:59904
    s_mov_b64 exec, -1
    v_exp_f32 v34, v34
    v_exp_f32 v35, v35
    v_exp_f32 v36, v36
    v_exp_f32 v37, v37
    s_waitcnt lgkmcnt(2)
    v_mfma_f32_32x32x16_bf16 v[48:63], v[88:91], v[8:11], v[16:31]
    ds_read_b128 v[88:91], v5 offset:61440
    v_exp_f32 v38, v38
    v_exp_f32 v39, v39
    v_cvt_pk_bf16_f32 v64, v32, v33
    v_cvt_pk_bf16_f32 v65, v34, v35
    v_cvt_pk_bf16_f32 v66, v36, v37
    v_cvt_pk_bf16_f32 v67, v38, v39
    v_exp_f32 v40, v40
    v_exp_f32 v41, v41
    s_waitcnt lgkmcnt(2)
    v_mfma_f32_32x32x16_bf16 v[72:87], v[92:95], v[64:67], v[72:87]
    s_mov_b64 exec, s[50:51]
    ds_read_b128 v[92:95], v6 offset:60416
    s_mov_b64 exec, -1
    v_exp_f32 v42, v42
    v_exp_f32 v43, v43
    v_exp_f32 v44, v44
    v_exp_f32 v45, v45
    v_exp_f32 v46, v46
    v_exp_f32 v47, v47
    v_cvt_pk_bf16_f32 v68, v40, v41
    v_cvt_pk_bf16_f32 v69, v42, v43
    v_cvt_pk_bf16_f32 v70, v44, v45
    v_cvt_pk_bf16_f32 v71, v46, v47
    v_exp_f32 v48, v48
    v_exp_f32 v49, v49
    s_waitcnt lgkmcnt(2)
    v_mfma_f32_32x32x16_bf16 v[72:87], v[96:99], v[68:71], v[72:87]
    s_mov_b64 exec, s[50:51]
    ds_read_b128 v[96:99], v6 offset:60928
    s_mov_b64 exec, -1
    v_exp_f32 v50, v50
    v_exp_f32 v51, v51
    v_exp_f32 v52, v52
    v_exp_f32 v53, v53
    s_waitcnt lgkmcnt(2)
    v_mfma_f32_32x32x16_bf16 v[32:47], v[88:91], v[8:11], v[16:31]
    ds_read_b128 v[88:91], v5 offset:62464
    v_exp_f32 v54, v54
    v_exp_f32 v55, v55
    v_cvt_pk_bf16_f32 v64, v48, v49
    v_cvt_pk_bf16_f32 v65, v50, v51
    v_cvt_pk_bf16_f32 v66, v52, v53
    v_cvt_pk_bf16_f32 v67, v54, v55
    v_exp_f32 v56, v56
    v_exp_f32 v57, v57
    s_waitcnt lgkmcnt(2)
    v_mfma_f32_32x32x16_bf16 v[72:87], v[92:95], v[64:67], v[72:87]
    s_mov_b64 exec, s[50:51]
    ds_read_b128 v[92:95], v6 offset:61440
    s_mov_b64 exec, -1
    v_exp_f32 v58, v58
    v_exp_f32 v59, v59
    v_exp_f32 v60, v60
    v_exp_f32 v61, v61
    v_exp_f32 v62, v62
    v_exp_f32 v63, v63
    v_cvt_pk_bf16_f32 v68, v56, v57
    v_cvt_pk_bf16_f32 v69, v58, v59
    v_cvt_pk_bf16_f32 v70, v60, v61
    v_cvt_pk_bf16_f32 v71, v62, v63
    v_exp_f32 v32, v32
    v_exp_f32 v33, v33
    s_waitcnt lgkmcnt(2)
    v_mfma_f32_32x32x16_bf16 v[72:87], v[96:99], v[68:71], v[72:87]
    s_mov_b64 exec, s[50:51]
    ds_read_b128 v[96:99], v6 offset:61952
    s_mov_b64 exec, -1
    v_exp_f32 v34, v34
    v_exp_f32 v35, v35
    v_exp_f32 v36, v36
    v_exp_f32 v37, v37
    ds_read_b32 v126, v101 offset:4
    s_waitcnt lgkmcnt(3)
    v_mfma_f32_32x32x16_bf16 v[48:63], v[88:91], v[8:11], v[16:31]
    ds_read_b128 v[88:91], v5 offset:63488
    v_exp_f32 v38, v38
    v_exp_f32 v39, v39
    v_cvt_pk_bf16_f32 v64, v32, v33
    v_cvt_pk_bf16_f32 v65, v34, v35
    v_cvt_pk_bf16_f32 v66, v36, v37
    v_cvt_pk_bf16_f32 v67, v38, v39
    v_exp_f32 v40, v40
    v_exp_f32 v41, v41
    s_waitcnt lgkmcnt(3)
    v_mfma_f32_32x32x16_bf16 v[72:87], v[92:95], v[64:67], v[72:87]
    s_mov_b64 exec, s[50:51]
    ds_read_b128 v[92:95], v6 offset:62464
    s_mov_b64 exec, -1
    v_exp_f32 v42, v42
    v_exp_f32 v43, v43
    v_exp_f32 v44, v44
    v_exp_f32 v45, v45
    v_exp_f32 v46, v46
    v_exp_f32 v47, v47
    v_cvt_pk_bf16_f32 v68, v40, v41
    v_cvt_pk_bf16_f32 v69, v42, v43
    v_cvt_pk_bf16_f32 v70, v44, v45
    v_cvt_pk_bf16_f32 v71, v46, v47
    v_exp_f32 v48, v48
    v_exp_f32 v49, v49
    s_waitcnt lgkmcnt(3)
    v_mfma_f32_32x32x16_bf16 v[72:87], v[96:99], v[68:71], v[72:87]
    s_mov_b64 exec, s[50:51]
    ds_read_b128 v[96:99], v6 offset:62976
    s_mov_b64 exec, -1
    v_exp_f32 v50, v50
    v_exp_f32 v51, v51
    v_exp_f32 v52, v52
    v_exp_f32 v53, v53
    s_waitcnt lgkmcnt(2)
    v_mfma_f32_32x32x16_bf16 v[32:47], v[88:91], v[8:11], v[16:31]
    ds_read_b128 v[88:91], v5 offset:64512
    v_exp_f32 v54, v54
    v_exp_f32 v55, v55
    v_cvt_pk_bf16_f32 v64, v48, v49
    v_cvt_pk_bf16_f32 v65, v50, v51
    v_cvt_pk_bf16_f32 v66, v52, v53
    v_cvt_pk_bf16_f32 v67, v54, v55
    v_exp_f32 v56, v56
    v_exp_f32 v57, v57
    s_waitcnt lgkmcnt(2)
    v_mfma_f32_32x32x16_bf16 v[72:87], v[92:95], v[64:67], v[72:87]
    s_mov_b64 exec, s[50:51]
    ds_read_b128 v[92:95], v6 offset:63488
    s_mov_b64 exec, -1
    v_exp_f32 v58, v58
    v_exp_f32 v59, v59
    v_exp_f32 v60, v60
    v_exp_f32 v61, v61
    v_exp_f32 v62, v62
    v_exp_f32 v63, v63
    v_cvt_pk_bf16_f32 v68, v56, v57
    v_cvt_pk_bf16_f32 v69, v58, v59
    v_cvt_pk_bf16_f32 v70, v60, v61
    v_cvt_pk_bf16_f32 v71, v62, v63
    v_exp_f32 v32, v32
    v_exp_f32 v33, v33
    s_waitcnt lgkmcnt(2)
    v_mfma_f32_32x32x16_bf16 v[72:87], v[96:99], v[68:71], v[72:87]
    s_mov_b64 exec, s[50:51]
    ds_read_b128 v[96:99], v6 offset:64000
    s_mov_b64 exec, -1
    v_exp_f32 v34, v34
    v_exp_f32 v35, v35
    v_exp_f32 v36, v36
    v_exp_f32 v37, v37
    s_waitcnt lgkmcnt(2)
    v_mfma_f32_32x32x16_bf16 v[48:63], v[88:91], v[8:11], v[16:31]
    v_exp_f32 v38, v38
    v_exp_f32 v39, v39
    v_cvt_pk_bf16_f32 v64, v32, v33
    v_cvt_pk_bf16_f32 v65, v34, v35
    v_cvt_pk_bf16_f32 v66, v36, v37
    v_cvt_pk_bf16_f32 v67, v38, v39
    v_exp_f32 v40, v40
    v_exp_f32 v41, v41
    s_waitcnt lgkmcnt(1)
    v_mfma_f32_32x32x16_bf16 v[72:87], v[92:95], v[64:67], v[72:87]
    s_mov_b64 exec, s[50:51]
    ds_read_b128 v[92:95], v6 offset:64512
    s_mov_b64 exec, -1
    v_exp_f32 v42, v42
    v_exp_f32 v43, v43
    v_exp_f32 v44, v44
    v_exp_f32 v45, v45
    v_exp_f32 v46, v46
    v_exp_f32 v47, v47
    v_cvt_pk_bf16_f32 v68, v40, v41
    v_cvt_pk_bf16_f32 v69, v42, v43
    v_cvt_pk_bf16_f32 v70, v44, v45
    v_cvt_pk_bf16_f32 v71, v46, v47
    v_exp_f32 v48, v48
    v_exp_f32 v49, v49
    s_waitcnt lgkmcnt(1)
    v_mfma_f32_32x32x16_bf16 v[72:87], v[96:99], v[68:71], v[72:87]
    s_mov_b64 exec, s[50:51]
    ds_read_b128 v[96:99], v6 offset:65024
    s_mov_b64 exec, -1
    v_exp_f32 v50, v50
    v_exp_f32 v51, v51
    v_exp_f32 v52, v52
    v_exp_f32 v53, v53
    v_exp_f32 v54, v54
    v_exp_f32 v55, v55
    v_cvt_pk_bf16_f32 v64, v48, v49
    v_cvt_pk_bf16_f32 v65, v50, v51
    v_cvt_pk_bf16_f32 v66, v52, v53
    v_cvt_pk_bf16_f32 v67, v54, v55
    v_exp_f32 v56, v56
    v_exp_f32 v57, v57
    s_waitcnt lgkmcnt(1)
    v_mfma_f32_32x32x16_bf16 v[72:87], v[92:95], v[64:67], v[72:87]
    v_exp_f32 v58, v58
    v_exp_f32 v59, v59
    v_exp_f32 v60, v60
    v_exp_f32 v61, v61
    v_exp_f32 v62, v62
    v_exp_f32 v63, v63
    v_cvt_pk_bf16_f32 v68, v56, v57
    v_cvt_pk_bf16_f32 v69, v58, v59
    v_cvt_pk_bf16_f32 v70, v60, v61
    v_cvt_pk_bf16_f32 v71, v62, v63
    s_waitcnt lgkmcnt(0)
    s_nop 0
    v_mfma_f32_32x32x16_bf16 v[72:87], v[96:99], v[68:71], v[72:87]
    s_setprio 0
    s_lshl_b32 s43, s41, 15
    s_lshl_b32 s45, s40, 10
    s_add_u32 s43, s43, s45
    s_add_u32 s43, s43, 6553600
    s_nop 7
    s_nop 3
    v_rcp_f32 v7, v80
    s_nop 0
    v_mul_f32 v72, v7, v72
    v_mul_f32 v73, v7, v73
    v_mul_f32 v74, v7, v74
    v_mul_f32 v75, v7, v75
    v_mul_f32 v76, v7, v76
    v_mul_f32 v77, v7, v77
    v_mul_f32 v78, v7, v78
    v_mul_f32 v79, v7, v79
    v_cvt_pk_bf16_f32 v64, v72, v73
    v_cvt_pk_bf16_f32 v65, v74, v75
    v_cvt_pk_bf16_f32 v66, v76, v77
    v_cvt_pk_bf16_f32 v67, v78, v79
    s_mov_b32 s57, 0
L_pfw_17:
    v_readfirstlane_b32 s56, v126
    s_add_u32 s57, s57, 1
    s_cmp_lg_u32 s56, 0
    s_cbranch_scc1 L_pfd_18
    s_cmp_gt_u32 s57, 600000
    s_cbranch_scc1 L_pfd_18
    ds_read_b32 v126, v101 offset:4
    s_waitcnt lgkmcnt(0)
    s_branch L_pfw_17
L_pfd_18:
    buffer_store_dwordx4 v[64:67], v4, s[36:39], s43 offen sc1
    s_waitcnt vmcnt(1)
    s_cmp_lg_u32 s26, 0
    s_cbranch_scc1 L_c1d_20
    s_mov_b32 s57, 0
L_c1p_19:
    v_cmp_gt_u32 vcc, 32, v123
    s_add_u32 s57, s57, 1
    s_cbranch_vccz L_c1d_20
    s_cmp_gt_u32 s57, 30000
    s_cbranch_scc1 L_c1d_20
    buffer_load_dword v123, v124, s[36:39], s100 offen sc1
    s_waitcnt vmcnt(0)
    s_branch L_c1p_19
L_c1d_20:
    s_barrier
    s_and_b32 s40, s27, 1
    s_lshl_b32 s40, s40, 2
    s_and_b32 s42, s3, 3
    s_add_u32 s40, s40, s42
    s_lshr_b32 s41, s27, 1
    s_lshl_b32 s41, s41, 3
    s_lshr_b32 s42, s3, 2
    s_add_u32 s41, s41, s42
    s_and_b32 s42, s26, 1
    s_bfe_u32 s43, s26, 0x10001
    s_mov_b32 s28, s4
    s_and_b32 s29, s5, 0xffff
    s_mov_b32 s30, 0x200000
    s_mov_b32 s31, 0x20000
    s_mov_b32 s32, s8
    s_and_b32 s33, s9, 0xffff
    s_mov_b32 s34, 0x80000
    s_mov_b32 s35, 0x20000
    v_lshlrev_b32 v4, 4, v1
    v_lshrrev_b32 v16, 3, v1
    v_mul_u32_u24 v5, 1024, v16
    v_bfe_u32 v16, v1, 4, 1
    v_lshlrev_b32 v16, 2, v16
    v_and_b32 v17, 7, v1
    v_xor_b32 v16, v16, v17
    v_lshl_add_u32 v5, v16, 4, v5
    s_lshl_b32 s45, s26, 13
    s_lshl_b32 s46, s40, 7
    s_add_u32 s45, s45, s46
    s_lshl_b32 s46, s26, 10
    s_add_u32 m0, s46, 0
    s_add_u32 s47, s45, 0
    buffer_load_dwordx4 v5, s[32:35], s47 offen lds
    s_add_u32 m0, s46, 8192
    s_add_u32 s47, s45, 65536
    buffer_load_dwordx4 v5, s[32:35], s47 offen lds
    s_add_u32 m0, s46, 16384
    s_add_u32 s47, s45, 131072
    buffer_load_dwordx4 v5, s[32:35], s47 offen lds
    s_add_u32 m0, s46, 24576
    s_add_u32 s47, s45, 196608
    buffer_load_dwordx4 v5, s[32:35], s47 offen lds
    s_add_u32 m0, s46, 32768
    s_add_u32 s47, s45, 262144
    buffer_load_dwordx4 v5, s[32:35], s47 offen lds
    s_add_u32 m0, s46, 40960
    s_add_u32 s47, s45, 327680
    buffer_load_dwordx4 v5, s[32:35], s47 offen lds
    s_add_u32 m0, s46, 49152
    s_add_u32 s47, s45, 393216
    buffer_load_dwordx4 v5, s[32:35], s47 offen lds
    s_add_u32 m0, s46, 57344
    s_add_u32 s47, s45, 458752
    buffer_load_dwordx4 v5, s[32:35], s47 offen lds
L_k3w_21:
    v_and_b32 v16, 31, v1
    v_lshlrev_b32 v30, 10, v16
    v_and_b32 v16, 15, v1
    v_lshrrev_b32 v16, 2, v16
    v_lshrrev_b32 v17, 5, v1
    v_lshl_add_u32 v6, v17, 2, v16
    v_mul_u32_u24 v6, 128, v6
    v_lshrrev_b32 v16, 1, v16
    v_xor_b32 v16, s42, v16
    v_lshl_add_u32 v6, v16, 6, v6
    v_bfe_u32 v16, v1, 4, 1
    v_lshl_add_u32 v6, v16, 5, v6
    v_and_b32 v16, 3, v1
    v_lshl_add_u32 v6, v16, 3, v6
    s_lshl_b32 s45, s43, 15
    s_add_u32 s45, s45, 65536
    v_add_u32 v7, s45, v4
    v_lshlrev_b32 v32, 16, v224
    v_and_b32 v33, 0xffff0000, v224
    v_lshlrev_b32 v34, 16, v225
    v_and_b32 v35, 0xffff0000, v225
    v_lshlrev_b32 v36, 16, v226
    v_and_b32 v37, 0xffff0000, v226
    v_lshlrev_b32 v38, 16, v227
    v_and_b32 v39, 0xffff0000, v227
    v_lshlrev_b32 v40, 16, v228
    v_and_b32 v41, 0xffff0000, v228
    v_lshlrev_b32 v42, 16, v229
    v_and_b32 v43, 0xffff0000, v229
    v_lshlrev_b32 v44, 16, v230
    v_and_b32 v45, 0xffff0000, v230
    v_lshlrev_b32 v46, 16, v231
    v_and_b32 v47, 0xffff0000, v231
    s_cmp_ge_u32 s26, 4
    s_cbranch_scc1 L_k3_helper
    s_lshl_b32 s44, s41, 1
    s_add_u32 s44, s44, s43
    s_lshl_b32 s44, s44, 15
    s_lshl_b32 s45, s42, 14
    s_add_u32 s44, s44, s45
    s_add_u32 s44, s44, 6553600
    buffer_load_dwordx4 v[64:67], v4, s[36:39], s44 offen offset:0 sc1
    buffer_load_dwordx4 v[68:71], v4, s[36:39], s44 offen offset:1024 sc1
    buffer_load_dwordx4 v[72:75], v4, s[36:39], s44 offen offset:2048 sc1
    buffer_load_dwordx4 v[76:79], v4, s[36:39], s44 offen offset:3072 sc1
    s_add_u32 s45, s44, 4096
    buffer_load_dwordx4 v[80:83], v4, s[36:39], s45 offen offset:0 sc1
    s_add_u32 s45, s44, 4096
    buffer_load_dwordx4 v[84:87], v4, s[36:39], s45 offen offset:1024 sc1
    s_add_u32 s45, s44, 4096
    buffer_load_dwordx4 v[88:91], v4, s[36:39], s45 offen offset:2048 sc1
    s_add_u32 s45, s44, 4096
    buffer_load_dwordx4 v[92:95], v4, s[36:39], s45 offen offset:3072 sc1
    s_xor_b32 s46, s42, 1
    v_and_b32 v16, 15, v1
    v_lshrrev_b32 v16, 2, v16
    v_lshrrev_b32 v17, 5, v1
    v_lshl_add_u32 v31, v17, 2, v16
    v_mul_u32_u24 v31, 128, v31
    v_lshrrev_b32 v16, 1, v16
    v_xor_b32 v16, s46, v16
    v_lshl_add_u32 v31, v16, 6, v31
    v_bfe_u32 v16, v1, 4, 1
    v_lshl_add_u32 v31, v16, 5, v31
    v_and_b32 v16, 3, v1
    v_lshl_add_u32 v31, v16, 3, v31
    s_lshl_b32 s45, s42, 15
    v_add_u32 v6, s45, v6
    v_add_u32 v31, s45, v31
    v_mov_b32 v112, 0
    v_mov_b32 v113, 0
    v_mov_b32 v114, 0
    v_mov_b32 v115, 0
    v_mov_b32 v116, 0
    v_mov_b32 v117, 0
    v_mov_b32 v118, 0
    v_mov_b32 v119, 0
    v_mov_b32 v120, 0
    v_mov_b32 v121, 0
    v_mov_b32 v122, 0
    v_mov_b32 v123, 0
    v_mov_b32 v124, 0
    v_mov_b32 v125, 0
    v_mov_b32 v126, 0
    v_mov_b32 v127, 0
    s_waitcnt vmcnt(8)
    s_barrier
    ds_read_b64_tr_b16 v[96:97], v6 offset:0
    ds_read_b64_tr_b16 v[98:99], v6 offset:1024
    ds_read_b64_tr_b16 v[100:101], v31 offset:0
    ds_read_b64_tr_b16 v[102:103], v31 offset:1024
    ds_read_b64_tr_b16 v[104:105], v6 offset:2048
    ds_read_b64_tr_b16 v[106:107], v6 offset:3072
    ds_read_b64_tr_b16 v[108:109], v31 offset:2048
    ds_read_b64_tr_b16 v[110:111], v31 offset:3072
    s_waitcnt vmcnt(7)
    s_mov_b32 s57, 0
L_k3c_22:
    v_max_u32 v16, v64, v66
    v_cmp_eq_u32 vcc, -1, v16
    s_add_u32 s57, s57, 1
    s_cbranch_vccz L_k3o_23
    s_cmp_gt_u32 s57, 30000
    s_cbranch_scc1 L_k3o_23
    buffer_load_dwordx4 v[64:67], v4, s[36:39], s44 offen offset:0 sc1
    s_waitcnt vmcnt(0)
    s_branch L_k3c_22
L_k3o_23:
    s_waitcnt lgkmcnt(4)
    v_mfma_f32_32x32x16_bf16 v[32:47], v[96:99], v[64:67], v[32:47]
    v_mfma_f32_32x32x16_bf16 v[112:127], v[100:103], v[64:67], v[112:127]
    ds_read_b64_tr_b16 v[96:97], v6 offset:4096
    ds_read_b64_tr_b16 v[98:99], v6 offset:5120
    ds_read_b64_tr_b16 v[100:101], v31 offset:4096
    ds_read_b64_tr_b16 v[102:103], v31 offset:5120
    s_add_u32 s45, s44, 8192
    buffer_load_dwordx4 v[64:67], v4, s[36:39], s45 offen offset:0 sc1
    s_waitcnt vmcnt(7)
    s_mov_b32 s57, 0
L_k3c_24:
    v_max_u32 v16, v68, v70
    v_cmp_eq_u32 vcc, -1, v16
    s_add_u32 s57, s57, 1
    s_cbranch_vccz L_k3o_25
    s_cmp_gt_u32 s57, 30000
    s_cbranch_scc1 L_k3o_25
    buffer_load_dwordx4 v[68:71], v4, s[36:39], s44 offen offset:1024 sc1
    s_waitcnt vmcnt(0)
    s_branch L_k3c_24
L_k3o_25:
    s_waitcnt lgkmcnt(4)
    v_mfma_f32_32x32x16_bf16 v[32:47], v[104:107], v[68:71], v[32:47]
    v_mfma_f32_32x32x16_bf16 v[112:127], v[108:111], v[68:71], v[112:127]
    ds_read_b64_tr_b16 v[104:105], v6 offset:6144
    ds_read_b64_tr_b16 v[106:107], v6 offset:7168
    ds_read_b64_tr_b16 v[108:109], v31 offset:6144
    ds_read_b64_tr_b16 v[110:111], v31 offset:7168
    s_add_u32 s45, s44, 8192
    buffer_load_dwordx4 v[68:71], v4, s[36:39], s45 offen offset:1024 sc1
    s_waitcnt vmcnt(7)
    s_mov_b32 s57, 0
L_k3c_26:
    v_max_u32 v16, v72, v74
    v_cmp_eq_u32 vcc, -1, v16
    s_add_u32 s57, s57, 1
    s_cbranch_vccz L_k3o_27
    s_cmp_gt_u32 s57, 30000
    s_cbranch_scc1 L_k3o_27
    buffer_load_dwordx4 v[72:75], v4, s[36:39], s44 offen offset:2048 sc1
    s_waitcnt vmcnt(0)
    s_branch L_k3c_26
L_k3o_27:
    s_waitcnt lgkmcnt(4)
    v_mfma_f32_32x32x16_bf16 v[32:47], v[96:99], v[72:75], v[32:47]
    v_mfma_f32_32x32x16_bf16 v[112:127], v[100:103], v[72:75], v[112:127]
    ds_read_b64_tr_b16 v[96:97], v6 offset:8192
    ds_read_b64_tr_b16 v[98:99], v6 offset:9216
    ds_read_b64_tr_b16 v[100:101], v31 offset:8192
    ds_read_b64_tr_b16 v[102:103], v31 offset:9216
    s_add_u32 s45, s44, 8192
    buffer_load_dwordx4 v[72:75], v4, s[36:39], s45 offen offset:2048 sc1
    s_waitcnt vmcnt(7)
    s_mov_b32 s57, 0
L_k3c_28:
    v_max_u32 v16, v76, v78
    v_cmp_eq_u32 vcc, -1, v16
    s_add_u32 s57, s57, 1
    s_cbranch_vccz L_k3o_29
    s_cmp_gt_u32 s57, 30000
    s_cbranch_scc1 L_k3o_29
    buffer_load_dwordx4 v[76:79], v4, s[36:39], s44 offen offset:3072 sc1
    s_waitcnt vmcnt(0)
    s_branch L_k3c_28
L_k3o_29:
    s_waitcnt lgkmcnt(4)
    v_mfma_f32_32x32x16_bf16 v[32:47], v[104:107], v[76:79], v[32:47]
    v_mfma_f32_32x32x16_bf16 v[112:127], v[108:111], v[76:79], v[112:127]
    ds_read_b64_tr_b16 v[104:105], v6 offset:10240
    ds_read_b64_tr_b16 v[106:107], v6 offset:11264
    ds_read_b64_tr_b16 v[108:109], v31 offset:10240
    ds_read_b64_tr_b16 v[110:111], v31 offset:11264
    s_add_u32 s45, s44, 8192
    buffer_load_dwordx4 v[76:79], v4, s[36:39], s45 offen offset:3072 sc1
    s_waitcnt vmcnt(7)
    s_mov_b32 s57, 0
L_k3c_30:
    v_max_u32 v16, v80, v82
    v_cmp_eq_u32 vcc, -1, v16
    s_add_u32 s57, s57, 1
    s_cbranch_vccz L_k3o_31
    s_cmp_gt_u32 s57, 30000
    s_cbranch_scc1 L_k3o_31
    s_add_u32 s45, s44, 4096
    buffer_load_dwordx4 v[80:83], v4, s[36:39], s45 offen offset:0 sc1
    s_waitcnt vmcnt(0)
    s_branch L_k3c_30
L_k3o_31:
    s_waitcnt lgkmcnt(4)
    v_mfma_f32_32x32x16_bf16 v[32:47], v[96:99], v[80:83], v[32:47]
    v_mfma_f32_32x32x16_bf16 v[112:127], v[100:103], v[80:83], v[112:127]
    ds_read_b64_tr_b16 v[96:97], v6 offset:12288
    ds_read_b64_tr_b16 v[98:99], v6 offset:13312
    ds_read_b64_tr_b16 v[100:101], v31 offset:12288
    ds_read_b64_tr_b16 v[102:103], v31 offset:13312
    s_add_u32 s45, s44, 12288
    buffer_load_dwordx4 v[80:83], v4, s[36:39], s45 offen offset:0 sc1
    s_waitcnt vmcnt(7)
    s_mov_b32 s57, 0
L_k3c_32:
    v_max_u32 v16, v84, v86
    v_cmp_eq_u32 vcc, -1, v16
    s_add_u32 s57, s57, 1
    s_cbranch_vccz L_k3o_33
    s_cmp_gt_u32 s57, 30000
    s_cbranch_scc1 L_k3o_33
    s_add_u32 s45, s44, 4096
    buffer_load_dwordx4 v[84:87], v4, s[36:39], s45 offen offset:1024 sc1
    s_waitcnt vmcnt(0)
    s_branch L_k3c_32
L_k3o_33:
    s_waitcnt lgkmcnt(4)
    v_mfma_f32_32x32x16_bf16 v[32:47], v[104:107], v[84:87], v[32:47]
    v_mfma_f32_32x32x16_bf16 v[112:127], v[108:111], v[84:87], v[112:127]
    ds_read_b64_tr_b16 v[104:105], v6 offset:14336
    ds_read_b64_tr_b16 v[106:107], v6 offset:15360
    ds_read_b64_tr_b16 v[108:109], v31 offset:14336
    ds_read_b64_tr_b16 v[110:111], v31 offset:15360
    s_add_u32 s45, s44, 12288
    buffer_load_dwordx4 v[84:87], v4, s[36:39], s45 offen offset:1024 sc1
    s_waitcnt vmcnt(7)
    s_mov_b32 s57, 0
L_k3c_34:
    v_max_u32 v16, v88, v90
    v_cmp_eq_u32 vcc, -1, v16
    s_add_u32 s57, s57, 1
    s_cbranch_vccz L_k3o_35
    s_cmp_gt_u32 s57, 30000
    s_cbranch_scc1 L_k3o_35
    s_add_u32 s45, s44, 4096
    buffer_load_dwordx4 v[88:91], v4, s[36:39], s45 offen offset:2048 sc1
    s_waitcnt vmcnt(0)
    s_branch L_k3c_34
L_k3o_35:
    s_waitcnt lgkmcnt(4)
    v_mfma_f32_32x32x16_bf16 v[32:47], v[96:99], v[88:91], v[32:47]
    v_mfma_f32_32x32x16_bf16 v[112:127], v[100:103], v[88:91], v[112:127]
    ds_read_b64_tr_b16 v[96:97], v6 offset:16384
    ds_read_b64_tr_b16 v[98:99], v6 offset:17408
    ds_read_b64_tr_b16 v[100:101], v31 offset:16384
    ds_read_b64_tr_b16 v[102:103], v31 offset:17408
    s_add_u32 s45, s44, 12288
    buffer_load_dwordx4 v[88:91], v4, s[36:39], s45 offen offset:2048 sc1
    s_waitcnt vmcnt(7)
    s_mov_b32 s57, 0
L_k3c_36:
    v_max_u32 v16, v92, v94
    v_cmp_eq_u32 vcc, -1, v16
    s_add_u32 s57, s57, 1
    s_cbranch_vccz L_k3o_37
    s_cmp_gt_u32 s57, 30000
    s_cbranch_scc1 L_k3o_37
    s_add_u32 s45, s44, 4096
    buffer_load_dwordx4 v[92:95], v4, s[36:39], s45 offen offset:3072 sc1
    s_waitcnt vmcnt(0)
    s_branch L_k3c_36
L_k3o_37:
    s_waitcnt lgkmcnt(4)
    v_mfma_f32_32x32x16_bf16 v[32:47], v[104:107], v[92:95], v[32:47]
    v_mfma_f32_32x32x16_bf16 v[112:127], v[108:111], v[92:95], v[112:127]
    ds_read_b64_tr_b16 v[104:105], v6 offset:18432
    ds_read_b64_tr_b16 v[106:107], v6 offset:19456
    ds_read_b64_tr_b16 v[108:109], v31 offset:18432
    ds_read_b64_tr_b16 v[110:111], v31 offset:19456
    s_add_u32 s45, s44, 12288
    buffer_load_dwordx4 v[92:95], v4, s[36:39], s45 offen offset:3072 sc1
    s_waitcnt vmcnt(7)
    s_mov_b32 s57, 0
L_k3c_38:
    v_max_u32 v16, v64, v66
    v_cmp_eq_u32 vcc, -1, v16
    s_add_u32 s57, s57, 1
    s_cbranch_vccz L_k3o_39
    s_cmp_gt_u32 s57, 30000
    s_cbranch_scc1 L_k3o_39
    s_add_u32 s45, s44, 8192
    buffer_load_dwordx4 v[64:67], v4, s[36:39], s45 offen offset:0 sc1
    s_waitcnt vmcnt(0)
    s_branch L_k3c_38
L_k3o_39:
    s_waitcnt lgkmcnt(4)
    v_mfma_f32_32x32x16_bf16 v[32:47], v[96:99], v[64:67], v[32:47]
    v_mfma_f32_32x32x16_bf16 v[112:127], v[100:103], v[64:67], v[112:127]
    ds_read_b64_tr_b16 v[96:97], v6 offset:20480
    ds_read_b64_tr_b16 v[98:99], v6 offset:21504
    ds_read_b64_tr_b16 v[100:101], v31 offset:20480
    ds_read_b64_tr_b16 v[102:103], v31 offset:21504
    s_waitcnt vmcnt(6)
    s_mov_b32 s57, 0
L_k3c_40:
    v_max_u32 v16, v68, v70
    v_cmp_eq_u32 vcc, -1, v16
    s_add_u32 s57, s57, 1
    s_cbranch_vccz L_k3o_41
    s_cmp_gt_u32 s57, 30000
    s_cbranch_scc1 L_k3o_41
    s_add_u32 s45, s44, 8192
    buffer_load_dwordx4 v[68:71], v4, s[36:39], s45 offen offset:1024 sc1
    s_waitcnt vmcnt(0)
    s_branch L_k3c_40
L_k3o_41:
    s_waitcnt lgkmcnt(4)
    v_mfma_f32_32x32x16_bf16 v[32:47], v[104:107], v[68:71], v[32:47]
    v_mfma_f32_32x32x16_bf16 v[112:127], v[108:111], v[68:71], v[112:127]
    ds_read_b64_tr_b16 v[104:105], v6 offset:22528
    ds_read_b64_tr_b16 v[106:107], v6 offset:23552
    ds_read_b64_tr_b16 v[108:109], v31 offset:22528
    ds_read_b64_tr_b16 v[110:111], v31 offset:23552
    s_waitcnt vmcnt(5)
    s_mov_b32 s57, 0
L_k3c_42:
    v_max_u32 v16, v72, v74
    v_cmp_eq_u32 vcc, -1, v16
    s_add_u32 s57, s57, 1
    s_cbranch_vccz L_k3o_43
    s_cmp_gt_u32 s57, 30000
    s_cbranch_scc1 L_k3o_43
    s_add_u32 s45, s44, 8192
    buffer_load_dwordx4 v[72:75], v4, s[36:39], s45 offen offset:2048 sc1
    s_waitcnt vmcnt(0)
    s_branch L_k3c_42
L_k3o_43:
    s_waitcnt lgkmcnt(4)
    v_mfma_f32_32x32x16_bf16 v[32:47], v[96:99], v[72:75], v[32:47]
    v_mfma_f32_32x32x16_bf16 v[112:127], v[100:103], v[72:75], v[112:127]
    ds_read_b64_tr_b16 v[96:97], v6 offset:24576
    ds_read_b64_tr_b16 v[98:99], v6 offset:25600
    ds_read_b64_tr_b16 v[100:101], v31 offset:24576
    ds_read_b64_tr_b16 v[102:103], v31 offset:25600
    s_waitcnt vmcnt(4)
    s_mov_b32 s57, 0
L_k3c_44:
    v_max_u32 v16, v76, v78
    v_cmp_eq_u32 vcc, -1, v16
    s_add_u32 s57, s57, 1
    s_cbranch_vccz L_k3o_45
    s_cmp_gt_u32 s57, 30000
    s_cbranch_scc1 L_k3o_45
    s_add_u32 s45, s44, 8192
    buffer_load_dwordx4 v[76:79], v4, s[36:39], s45 offen offset:3072 sc1
    s_waitcnt vmcnt(0)
    s_branch L_k3c_44
L_k3o_45:
    s_waitcnt lgkmcnt(4)
    v_mfma_f32_32x32x16_bf16 v[32:47], v[104:107], v[76:79], v[32:47]
    v_mfma_f32_32x32x16_bf16 v[112:127], v[108:111], v[76:79], v[112:127]
    ds_read_b64_tr_b16 v[104:105], v6 offset:26624
    ds_read_b64_tr_b16 v[106:107], v6 offset:27648
    ds_read_b64_tr_b16 v[108:109], v31 offset:26624
    ds_read_b64_tr_b16 v[110:111], v31 offset:27648
    s_waitcnt vmcnt(3)
    s_mov_b32 s57, 0
L_k3c_46:
    v_max_u32 v16, v80, v82
    v_cmp_eq_u32 vcc, -1, v16
    s_add_u32 s57, s57, 1
    s_cbranch_vccz L_k3o_47
    s_cmp_gt_u32 s57, 30000
    s_cbranch_scc1 L_k3o_47
    s_add_u32 s45, s44, 12288
    buffer_load_dwordx4 v[80:83], v4, s[36:39], s45 offen offset:0 sc1
    s_waitcnt vmcnt(0)
    s_branch L_k3c_46
L_k3o_47:
    s_waitcnt lgkmcnt(4)
    v_mfma_f32_32x32x16_bf16 v[32:47], v[96:99], v[80:83], v[32:47]
    v_mfma_f32_32x32x16_bf16 v[112:127], v[100:103], v[80:83], v[112:127]
    ds_read_b64_tr_b16 v[96:97], v6 offset:28672
    ds_read_b64_tr_b16 v[98:99], v6 offset:29696
    ds_read_b64_tr_b16 v[100:101], v31 offset:28672
    ds_read_b64_tr_b16 v[102:103], v31 offset:29696
    s_waitcnt vmcnt(2)
    s_mov_b32 s57, 0
L_k3c_48:
    v_max_u32 v16, v84, v86
    v_cmp_eq_u32 vcc, -1, v16
    s_add_u32 s57, s57, 1
    s_cbranch_vccz L_k3o_49
    s_cmp_gt_u32 s57, 30000
    s_cbranch_scc1 L_k3o_49
    s_add_u32 s45, s44, 12288
    buffer_load_dwordx4 v[84:87], v4, s[36:39], s45 offen offset:1024 sc1
    s_waitcnt vmcnt(0)
    s_branch L_k3c_48
L_k3o_49:
    s_waitcnt lgkmcnt(4)
    v_mfma_f32_32x32x16_bf16 v[32:47], v[104:107], v[84:87], v[32:47]
    v_mfma_f32_32x32x16_bf16 v[112:127], v[108:111], v[84:87], v[112:127]
    ds_read_b64_tr_b16 v[104:105], v6 offset:30720
    ds_read_b64_tr_b16 v[106:107], v6 offset:31744
    ds_read_b64_tr_b16 v[108:109], v31 offset:30720
    ds_read_b64_tr_b16 v[110:111], v31 offset:31744
    s_waitcnt vmcnt(1)
    s_mov_b32 s57, 0
L_k3c_50:
    v_max_u32 v16, v88, v90
    v_cmp_eq_u32 vcc, -1, v16
    s_add_u32 s57, s57, 1
    s_cbranch_vccz L_k3o_51
    s_cmp_gt_u32 s57, 30000
    s_cbranch_scc1 L_k3o_51
    s_add_u32 s45, s44, 12288
    buffer_load_dwordx4 v[88:91], v4, s[36:39], s45 offen offset:2048 sc1
    s_waitcnt vmcnt(0)
    s_branch L_k3c_50
L_k3o_51:
    s_waitcnt lgkmcnt(4)
    v_mfma_f32_32x32x16_bf16 v[32:47], v[96:99], v[88:91], v[32:47]
    v_mfma_f32_32x32x16_bf16 v[112:127], v[100:103], v[88:91], v[112:127]
    s_waitcnt vmcnt(0)
    s_mov_b32 s57, 0
L_k3c_52:
    v_max_u32 v16, v92, v94
    v_cmp_eq_u32 vcc, -1, v16
    s_add_u32 s57, s57, 1
    s_cbranch_vccz L_k3o_53
    s_cmp_gt_u32 s57, 30000
    s_cbranch_scc1 L_k3o_53
    s_add_u32 s45, s44, 12288
    buffer_load_dwordx4 v[92:95], v4, s[36:39], s45 offen offset:3072 sc1
    s_waitcnt vmcnt(0)
    s_branch L_k3c_52
L_k3o_53:
    s_waitcnt lgkmcnt(0)
    v_mfma_f32_32x32x16_bf16 v[32:47], v[104:107], v[92:95], v[32:47]
    v_mfma_f32_32x32x16_bf16 v[112:127], v[108:111], v[92:95], v[112:127]
    s_lshl_b32 s45, s26, 12
    s_add_u32 s45, s45, 65536
    v_add_u32 v16, s45, v4
    s_xor_b32 s45, s45, 4096
    v_add_u32 v17, s45, v4
    s_nop 7
    ds_write_b128 v16, v[112:115] offset:0
    ds_write_b128 v16, v[116:119] offset:1024
    ds_write_b128 v16, v[120:123] offset:2048
    ds_write_b128 v16, v[124:127] offset:3072
    s_waitcnt lgkmcnt(0)
    s_barrier
    ds_read_b128 v[64:67], v17 offset:0
    ds_read_b128 v[68:71], v17 offset:1024
    ds_read_b128 v[72:75], v17 offset:2048
    ds_read_b128 v[76:79], v17 offset:3072
    s_waitcnt lgkmcnt(0)
    v_pk_add_f32 v[32:33], v[32:33], v[64:65]
    v_pk_add_f32 v[34:35], v[34:35], v[66:67]
    v_pk_add_f32 v[36:37], v[36:37], v[68:69]
    v_pk_add_f32 v[38:39], v[38:39], v[70:71]
    v_pk_add_f32 v[40:41], v[40:41], v[72:73]
    v_pk_add_f32 v[42:43], v[42:43], v[74:75]
    v_pk_add_f32 v[44:45], v[44:45], v[76:77]
    v_pk_add_f32 v[46:47], v[46:47], v[78:79]
    s_nop 7
    s_nop 3
    v_pk_add_f32 v[60:61], v[32:33], v[34:35]
    v_pk_mul_f32 v[62:63], v[32:33], v[32:33]
    v_pk_fma_f32 v[62:63], v[34:35], v[34:35], v[62:63]
    v_pk_add_f32 v[60:61], v[60:61], v[36:37]
    v_pk_fma_f32 v[62:63], v[36:37], v[36:37], v[62:63]
    v_pk_add_f32 v[60:61], v[60:61], v[38:39]
    v_pk_fma_f32 v[62:63], v[38:39], v[38:39], v[62:63]
    v_pk_add_f32 v[60:61], v[60:61], v[40:41]
    v_pk_fma_f32 v[62:63], v[40:41], v[40:41], v[62:63]
    v_pk_add_f32 v[60:61], v[60:61], v[42:43]
    v_pk_fma_f32 v[62:63], v[42:43], v[42:43], v[62:63]
    v_pk_add_f32 v[60:61], v[60:61], v[44:45]
    v_pk_fma_f32 v[62:63], v[44:45], v[44:45], v[62:63]
    v_pk_add_f32 v[60:61], v[60:61], v[46:47]
    v_pk_fma_f32 v[62:63], v[46:47], v[46:47], v[62:63]
    v_add_f32 v56, v60, v61
    v_add_f32 v57, v62, v63
    v_mov_b32 v58, v56
    s_nop 1
    v_permlane32_swap_b32 v58, v56
    s_nop 1
    v_add_f32 v56, v56, v58
    v_mov_b32 v59, v57
    s_nop 1
    v_permlane32_swap_b32 v59, v57
    s_nop 1
    v_add_f32 v57, v57, v59
    v_and_b32 v16, 31, v1
    s_lshl_b32 s45, s43, 5
    v_add_u32 v16, s45, v16
    v_lshlrev_b32 v17, 3, v16
    s_lshl_b32 s45, s42, 9
    v_add_u32 v18, s45, v17
    v_add_u32 v18, 131072, v18
    ds_write_b64 v18, v[56:57]
    s_waitcnt lgkmcnt(0)
    s_barrier
    s_cmp_lg_u32 s42, 0
    s_cbranch_scc1 L_k3_nopub
    v_add_u32 v18, 131072, v17
    ds_read_b64 v[56:57], v18
    ds_read_b64 v[58:59], v18 offset:512
    s_waitcnt lgkmcnt(0)
    v_add_f32 v56, v56, v58
    v_add_f32 v58, v57, v59
    v_mov_b32 v57, s96
    v_mov_b32 v59, s96
    s_lshl_b32 s45, s41, 13
    s_lshl_b32 s46, s40, 10
    s_add_u32 s45, s45, s46
    s_add_u32 s45, s45, 8650752
    v_lshlrev_b32 v19, 1, v17
    buffer_store_dwordx4 v[56:59], v19, s[36:39], s45 offen sc1
L_k3_nopub:
    v_cvt_pk_bf16_f32 v248, v32, v33
    v_cvt_pk_bf16_f32 v249, v34, v35
    v_cvt_pk_bf16_f32 v250, v36, v37
    v_cvt_pk_bf16_f32 v251, v38, v39
    v_cvt_pk_bf16_f32 v252, v40, v41
    v_cvt_pk_bf16_f32 v253, v42, v43
    v_cvt_pk_bf16_f32 v254, v44, v45
    v_cvt_pk_bf16_f32 v255, v46, v47
    s_lshl_b32 s49, s41, 13
    s_add_u32 s49, s49, 8650752
    v_lshlrev_b32 v19, 1, v17
    v_add_u32 v20, 4096, v19
    s_mov_b32 s57, 0
    s_cmp_eq_u32 s98, 0
    s_cbranch_scc1 L_k3t_59
    s_mul_i32 s45, s26, 6144
    v_lshlrev_b32 v24, 4, v1
    v_add_u32 v24, s45, v24
    v_lshrrev_b32 v26, 4, v1
    v_and_b32 v27, 15, v1
    v_lshrrev_b32 v27, 2, v27
    v_lshl_add_u32 v26, v26, 2, v27
    v_mul_u32_u24 v25, 96, v26
    v_and_b32 v27, 3, v1
    v_lshl_add_u32 v25, v27, 3, v25
    v_add_u32 v25, s45, v25
    ds_write_b128 v24, v[128:131] offset:0
    ds_write_b128 v24, v[132:135] offset:1024
    ds_write_b128 v24, v[136:139] offset:2048
    s_waitcnt lgkmcnt(0)
    ds_read_b64_tr_b16 v[128:129], v25 offset:0
    ds_read_b64_tr_b16 v[130:131], v25 offset:1536
    ds_read_b64_tr_b16 v[132:133], v25 offset:32
    ds_read_b64_tr_b16 v[134:135], v25 offset:1568
    ds_read_b64_tr_b16 v[136:137], v25 offset:64
    ds_read_b64_tr_b16 v[138:139], v25 offset:1600
    ds_write_b128 v24, v[140:143] offset:3072
    ds_write_b128 v24, v[144:147] offset:4096
    ds_write_b128 v24, v[148:151] offset:5120
    s_waitcnt lgkmcnt(0)
    ds_read_b64_tr_b16 v[140:141], v25 offset:3072
    ds_read_b64_tr_b16 v[142:143], v25 offset:4608
    ds_read_b64_tr_b16 v[144:145], v25 offset:3104
    ds_read_b64_tr_b16 v[146:147], v25 offset:4640
    ds_read_b64_tr_b16 v[148:149], v25 offset:3136
    ds_read_b64_tr_b16 v[150:151], v25 offset:4672
    s_waitcnt lgkmcnt(0)
    buffer_load_dwordx4 v[96:99], v19, s[36:39], s49 offen offset:0 sc1
    buffer_load_dwordx4 v[100:103], v19, s[36:39], s49 offen offset:1024 sc1
    buffer_load_dwordx4 v[104:107], v19, s[36:39], s49 offen offset:2048 sc1
    buffer_load_dwordx4 v[108:111], v19, s[36:39], s49 offen offset:3072 sc1
    buffer_load_dwordx4 v[112:115], v20, s[36:39], s49 offen offset:0 sc1
    buffer_load_dwordx4 v[116:119], v20, s[36:39], s49 offen offset:1024 sc1
    buffer_load_dwordx4 v[120:123], v20, s[36:39], s49 offen offset:2048 sc1
    buffer_load_dwordx4 v[124:127], v20, s[36:39], s49 offen offset:3072 sc1
    ds_write_b128 v24, v[152:155] offset:0
    ds_write_b128 v24, v[156:159] offset:1024
    ds_write_b128 v24, v[160:163] offset:2048
    s_waitcnt lgkmcnt(0)
    ds_read_b64_tr_b16 v[152:153], v25 offset:0
    ds_read_b64_tr_b16 v[154:155], v25 offset:1536
    ds_read_b64_tr_b16 v[156:157], v25 offset:32
    ds_read_b64_tr_b16 v[158:159], v25 offset:1568
    ds_read_b64_tr_b16 v[160:161], v25 offset:64
    ds_read_b64_tr_b16 v[162:163], v25 offset:1600
    ds_write_b128 v24, v[164:167] offset:3072
    ds_write_b128 v24, v[168:171] offset:4096
    ds_write_b128 v24, v[172:175] offset:5120
    s_waitcnt lgkmcnt(0)
    ds_read_b64_tr_b16 v[164:165], v25 offset:3072
    ds_read_b64_tr_b16 v[166:167], v25 offset:4608
    ds_read_b64_tr_b16 v[168:169], v25 offset:3104
    ds_read_b64_tr_b16 v[170:171], v25 offset:4640
    ds_read_b64_tr_b16 v[172:173], v25 offset:3136
    ds_read_b64_tr_b16 v[174:175], v25 offset:4672
    s_waitcnt lgkmcnt(0)
    s_branch L_s3c_56
L_k3t_59:
L_s3p_54:
    buffer_load_dwordx4 v[96:99], v19, s[36:39], s49 offen offset:0 sc1
    buffer_load_dwordx4 v[100:103], v19, s[36:39], s49 offen offset:1024 sc1
    buffer_load_dwordx4 v[104:107], v19, s[36:39], s49 offen offset:2048 sc1
    buffer_load_dwordx4 v[108:111], v19, s[36:39], s49 offen offset:3072 sc1
    buffer_load_dwordx4 v[112:115], v20, s[36:39], s49 offen offset:0 sc1
    buffer_load_dwordx4 v[116:119], v20, s[36:39], s49 offen offset:1024 sc1
    buffer_load_dwordx4 v[120:123], v20, s[36:39], s49 offen offset:2048 sc1
    buffer_load_dwordx4 v[124:127], v20, s[36:39], s49 offen offset:3072 sc1
L_s3c_56:
    s_waitcnt vmcnt(0)
    v_xor_b32 v21, s96, v97
    v_xor_b32 v22, s96, v99
    v_or_b32 v21, v21, v22
    v_xor_b32 v22, s96, v101
    v_or_b32 v21, v21, v22
    v_xor_b32 v22, s96, v103
    v_or_b32 v21, v21, v22
    v_xor_b32 v22, s96, v105
    v_or_b32 v21, v21, v22
    v_xor_b32 v22, s96, v107
    v_or_b32 v21, v21, v22
    v_xor_b32 v22, s96, v109
    v_or_b32 v21, v21, v22
    v_xor_b32 v22, s96, v111
    v_or_b32 v21, v21, v22
    v_xor_b32 v22, s96, v113
    v_or_b32 v21, v21, v22
    v_xor_b32 v22, s96, v115
    v_or_b32 v21, v21, v22
    v_xor_b32 v22, s96, v117
    v_or_b32 v21, v21, v22
    v_xor_b32 v22, s96, v119
    v_or_b32 v21, v21, v22
    v_xor_b32 v22, s96, v121
    v_or_b32 v21, v21, v22
    v_xor_b32 v22, s96, v123
    v_or_b32 v21, v21, v22
    v_xor_b32 v22, s96, v125
    v_or_b32 v21, v21, v22
    v_xor_b32 v22, s96, v127
    v_or_b32 v21, v21, v22
    v_cmp_ne_u32 vcc, 0, v21
    s_add_u32 s57, s57, 1
    s_cbranch_vccz L_s3d_55
    s_cmp_gt_u32 s57, 30000
    s_cbranch_scc1 L_s3d_55
    s_branch L_s3p_54
L_s3d_55:
    v_add_f32 v96, v96, v100
    v_add_f32 v98, v98, v102
    v_add_f32 v96, v96, v104
    v_add_f32 v98, v98, v106
    v_add_f32 v96, v96, v108
    v_add_f32 v98, v98, v110
    v_add_f32 v96, v96, v112
    v_add_f32 v98, v98, v114
    v_add_f32 v96, v96, v116
    v_add_f32 v98, v98, v118
    v_add_f32 v96, v96, v120
    v_add_f32 v98, v98, v122
    v_add_f32 v96, v96, v124
    v_add_f32 v98, v98, v126
    v_mov_b32 v97, v98
    v_mul_f32 v96, 0x3b000000, v96
    v_mul_f32 v97, 0x3b000000, v97
    v_fma_f32 v97, -v96, v96, v97
    v_max_f32 v97, 0, v97
    v_add_f32 v98, 0x3727c5ac, v97
    v_rsq_f32 v98, v98
    s_nop 0
    v_mul_f32 v99, v98, v98
    v_mul_f32 v99, v99, v97
    v_add_f32 v99, 0x3727c5ac, v99
    v_rsq_f32 v99, v99
    s_nop 0
    v_mul_f32 v98, v98, v99
    v_mul_f32 v100, -v96, v98
    v_fma_f32 v32, v32, v98, v100
    v_fma_f32 v33, v33, v98, v100
    v_fma_f32 v34, v34, v98, v100
    v_fma_f32 v35, v35, v98, v100
    v_fma_f32 v36, v36, v98, v100
    v_fma_f32 v37, v37, v98, v100
    v_fma_f32 v38, v38, v98, v100
    v_fma_f32 v39, v39, v98, v100
    v_fma_f32 v40, v40, v98, v100
    v_fma_f32 v41, v41, v98, v100
    v_fma_f32 v42, v42, v98, v100
    v_fma_f32 v43, v43, v98, v100
    v_fma_f32 v44, v44, v98, v100
    v_fma_f32 v45, v45, v98, v100
    v_fma_f32 v46, v46, v98, v100
    v_fma_f32 v47, v47, v98, v100
    v_cvt_pk_bf16_f32 v64, v32, v33
    v_cvt_pk_bf16_f32 v65, v34, v35
    v_cvt_pk_bf16_f32 v66, v36, v37
    v_cvt_pk_bf16_f32 v67, v38, v39
    v_cvt_pk_bf16_f32 v68, v40, v41
    v_cvt_pk_bf16_f32 v69, v42, v43
    v_cvt_pk_bf16_f32 v70, v44, v45
    v_cvt_pk_bf16_f32 v71, v46, v47
    s_mul_i32 s45, s26, 2560
    s_add_u32 s45, s45, 133120
    v_and_b32 v16, 31, v1
    v_mul_u32_u24 v16, 80, v16
    v_lshrrev_b32 v17, 5, v1
    v_lshl_add_u32 v16, v17, 3, v16
    v_add_u32 v16, s45, v16
    ds_write_b64 v16, v[64:65] offset:0
    ds_write_b64 v16, v[66:67] offset:16
    ds_write_b64 v16, v[68:69] offset:32
    ds_write_b64 v16, v[70:71] offset:48
    v_lshrrev_b32 v17, 4, v1
    v_and_b32 v18, 15, v1
    v_lshrrev_b32 v18, 2, v18
    v_lshl_add_u32 v17, v17, 2, v18
    v_mul_u32_u24 v17, 80, v17
    v_and_b32 v18, 3, v1
    v_lshl_add_u32 v17, v18, 3, v17
    v_add_u32 v17, s45, v17
    s_lshl_b32 s44, s40, 18
    s_lshl_b32 s45, s41, 1
    s_add_u32 s45, s45, s43
    s_lshl_b32 s45, s45, 12
    s_add_u32 s44, s44, s45
    s_lshl_b32 s45, s42, 11
    s_add_u32 s44, s44, s45
    s_add_u32 s44, s44, 10747904
    s_waitcnt lgkmcnt(0)
    ds_read_b64_tr_b16 v[72:73], v17 offset:0
    ds_read_b64_tr_b16 v[74:75], v17 offset:1280
    ds_read_b64_tr_b16 v[76:77], v17 offset:32
    ds_read_b64_tr_b16 v[78:79], v17 offset:1312
    s_waitcnt lgkmcnt(0)
    buffer_store_dwordx4 v[72:75], v4, s[36:39], s44 offen sc1
    buffer_store_dwordx4 v[76:79], v4, s[36:39], s44 offen offset:1024 sc1
    s_branch L_k3_join
L_k3_helper:
    s_waitcnt vmcnt(0)
    s_barrier
    s_barrier
    s_barrier
    s_cmp_eq_u32 s98, 0
    s_cbranch_scc1 L_k3h_60
    s_waitcnt vmcnt(0)
    s_mul_i32 s45, s26, 6144
    v_lshlrev_b32 v24, 4, v1
    v_add_u32 v24, s45, v24
    v_lshrrev_b32 v26, 4, v1
    v_and_b32 v27, 15, v1
    v_lshrrev_b32 v27, 2, v27
    v_lshl_add_u32 v26, v26, 2, v27
    v_mul_u32_u24 v25, 96, v26
    v_and_b32 v27, 3, v1
    v_lshl_add_u32 v25, v27, 3, v25
    v_add_u32 v25, s45, v25
    ds_write_b128 v24, v[128:131] offset:0
    ds_write_b128 v24, v[132:135] offset:1024
    ds_write_b128 v24, v[136:139] offset:2048
    s_waitcnt lgkmcnt(0)
    ds_read_b64_tr_b16 v[128:129], v25 offset:0
    ds_read_b64_tr_b16 v[130:131], v25 offset:1536
    ds_read_b64_tr_b16 v[132:133], v25 offset:32
    ds_read_b64_tr_b16 v[134:135], v25 offset:1568
    ds_read_b64_tr_b16 v[136:137], v25 offset:64
    ds_read_b64_tr_b16 v[138:139], v25 offset:1600
    ds_write_b128 v24, v[140:143] offset:3072
    ds_write_b128 v24, v[144:147] offset:4096
    ds_write_b128 v24, v[148:151] offset:5120
    s_waitcnt lgkmcnt(0)
    ds_read_b64_tr_b16 v[140:141], v25 offset:3072
    ds_read_b64_tr_b16 v[142:143], v25 offset:4608
    ds_read_b64_tr_b16 v[144:145], v25 offset:3104
    ds_read_b64_tr_b16 v[146:147], v25 offset:4640
    ds_read_b64_tr_b16 v[148:149], v25 offset:3136
    ds_read_b64_tr_b16 v[150:151], v25 offset:4672
    ds_write_b128 v24, v[152:155] offset:0
    ds_write_b128 v24, v[156:159] offset:1024
    ds_write_b128 v24, v[160:163] offset:2048
    s_waitcnt lgkmcnt(0)
    ds_read_b64_tr_b16 v[152:153], v25 offset:0
    ds_read_b64_tr_b16 v[154:155], v25 offset:1536
    ds_read_b64_tr_b16 v[156:157], v25 offset:32
    ds_read_b64_tr_b16 v[158:159], v25 offset:1568
    ds_read_b64_tr_b16 v[160:161], v25 offset:64
    ds_read_b64_tr_b16 v[162:163], v25 offset:1600
    ds_write_b128 v24, v[164:167] offset:3072
    ds_write_b128 v24, v[168:171] offset:4096
    ds_write_b128 v24, v[172:175] offset:5120
    s_waitcnt lgkmcnt(0)
    ds_read_b64_tr_b16 v[164:165], v25 offset:3072
    ds_read_b64_tr_b16 v[166:167], v25 offset:4608
    ds_read_b64_tr_b16 v[168:169], v25 offset:3104
    ds_read_b64_tr_b16 v[170:171], v25 offset:4640
    ds_read_b64_tr_b16 v[172:173], v25 offset:3136
    ds_read_b64_tr_b16 v[174:175], v25 offset:4672
    ds_write_b128 v24, v[176:179] offset:0
    ds_write_b128 v24, v[180:183] offset:1024
    ds_write_b128 v24, v[184:187] offset:2048
    s_waitcnt lgkmcnt(0)
    ds_read_b64_tr_b16 v[176:177], v25 offset:0
    ds_read_b64_tr_b16 v[178:179], v25 offset:1536
    ds_read_b64_tr_b16 v[180:181], v25 offset:32
    ds_read_b64_tr_b16 v[182:183], v25 offset:1568
    ds_read_b64_tr_b16 v[184:185], v25 offset:64
    ds_read_b64_tr_b16 v[186:187], v25 offset:1600
    ds_write_b128 v24, v[188:191] offset:3072
    ds_write_b128 v24, v[192:195] offset:4096
    ds_write_b128 v24, v[196:199] offset:5120
    s_waitcnt lgkmcnt(0)
    ds_read_b64_tr_b16 v[188:189], v25 offset:3072
    ds_read_b64_tr_b16 v[190:191], v25 offset:4608
    ds_read_b64_tr_b16 v[192:193], v25 offset:3104
    ds_read_b64_tr_b16 v[194:195], v25 offset:4640
    ds_read_b64_tr_b16 v[196:197], v25 offset:3136
    ds_read_b64_tr_b16 v[198:199], v25 offset:4672
    ds_write_b128 v24, v[200:203] offset:0
    ds_write_b128 v24, v[204:207] offset:1024
    ds_write_b128 v24, v[208:211] offset:2048
    s_waitcnt lgkmcnt(0)
    ds_read_b64_tr_b16 v[200:201], v25 offset:0
    ds_read_b64_tr_b16 v[202:203], v25 offset:1536
    ds_read_b64_tr_b16 v[204:205], v25 offset:32
    ds_read_b64_tr_b16 v[206:207], v25 offset:1568
    ds_read_b64_tr_b16 v[208:209], v25 offset:64
    ds_read_b64_tr_b16 v[210:211], v25 offset:1600
    ds_write_b128 v24, v[212:215] offset:3072
    ds_write_b128 v24, v[216:219] offset:4096
    ds_write_b128 v24, v[220:223] offset:5120
    s_waitcnt lgkmcnt(0)
    ds_read_b64_tr_b16 v[212:213], v25 offset:3072
    ds_read_b64_tr_b16 v[214:215], v25 offset:4608
    ds_read_b64_tr_b16 v[216:217], v25 offset:3104
    ds_read_b64_tr_b16 v[218:219], v25 offset:4640
    ds_read_b64_tr_b16 v[220:221], v25 offset:3136
    ds_read_b64_tr_b16 v[222:223], v25 offset:4672
    s_waitcnt lgkmcnt(0)
L_k3h_60:
L_k3_join:
    s_mov_b32 s42, s97
    s_mov_b32 s59, s98
    s_barrier
    s_cmp_eq_u32 s59, 0
    s_cbranch_scc1 L_k4_join
    s_lshl_b32 s46, s101, 11
    s_add_u32 s46, s46, 14450688
    s_mov_b32 s28, s14
    s_and_b32 s29, s15, 0xffff
    s_mov_b32 s30, 0xac0
    s_mov_b32 s31, 0x20000
    s_cmp_ge_u32 s26, 4
    s_cbranch_scc1 L_k4t_61
    s_mul_i32 s45, s26, 6144
    s_add_u32 s45, s45, 98304
    v_lshlrev_b32 v24, 4, v1
    v_add_u32 v24, s45, v24
    v_lshrrev_b32 v26, 4, v1
    v_and_b32 v27, 15, v1
    v_lshrrev_b32 v27, 2, v27
    v_lshl_add_u32 v26, v26, 2, v27
    v_mul_u32_u24 v25, 96, v26
    v_and_b32 v27, 3, v1
    v_lshl_add_u32 v25, v27, 3, v25
    v_add_u32 v25, s45, v25
    ds_write_b128 v24, v[176:179] offset:0
    ds_write_b128 v24, v[180:183] offset:1024
    ds_write_b128 v24, v[184:187] offset:2048
    s_waitcnt lgkmcnt(0)
    ds_read_b64_tr_b16 v[176:177], v25 offset:0
    ds_read_b64_tr_b16 v[178:179], v25 offset:1536
    ds_read_b64_tr_b16 v[180:181], v25 offset:32
    ds_read_b64_tr_b16 v[182:183], v25 offset:1568
    ds_read_b64_tr_b16 v[184:185], v25 offset:64
    ds_read_b64_tr_b16 v[186:187], v25 offset:1600
    ds_write_b128 v24, v[188:191] offset:3072
    ds_write_b128 v24, v[192:195] offset:4096
    ds_write_b128 v24, v[196:199] offset:5120
    s_waitcnt lgkmcnt(0)
    ds_read_b64_tr_b16 v[188:189], v25 offset:3072
    ds_read_b64_tr_b16 v[190:191], v25 offset:4608
    ds_read_b64_tr_b16 v[192:193], v25 offset:3104
    ds_read_b64_tr_b16 v[194:195], v25 offset:4640
    ds_read_b64_tr_b16 v[196:197], v25 offset:3136
    ds_read_b64_tr_b16 v[198:199], v25 offset:4672
    ds_write_b128 v24, v[200:203] offset:0
    ds_write_b128 v24, v[204:207] offset:1024
    ds_write_b128 v24, v[208:211] offset:2048
    s_waitcnt lgkmcnt(0)
    ds_read_b64_tr_b16 v[200:201], v25 offset:0
    ds_read_b64_tr_b16 v[202:203], v25 offset:1536
    ds_read_b64_tr_b16 v[204:205], v25 offset:32
    ds_read_b64_tr_b16 v[206:207], v25 offset:1568
    ds_read_b64_tr_b16 v[208:209], v25 offset:64
    ds_read_b64_tr_b16 v[210:211], v25 offset:1600
    ds_write_b128 v24, v[212:215] offset:3072
    ds_write_b128 v24, v[216:219] offset:4096
    ds_write_b128 v24, v[220:223] offset:5120
    s_waitcnt lgkmcnt(0)
    ds_read_b64_tr_b16 v[212:213], v25 offset:3072
    ds_read_b64_tr_b16 v[214:215], v25 offset:4608
    ds_read_b64_tr_b16 v[216:217], v25 offset:3104
    ds_read_b64_tr_b16 v[218:219], v25 offset:4640
    ds_read_b64_tr_b16 v[220:221], v25 offset:3136
    ds_read_b64_tr_b16 v[222:223], v25 offset:4672
    s_waitcnt lgkmcnt(0)
L_k4t_61:
    v_lshlrev_b32 v4, 4, v1
    s_lshl_b32 s44, s101, 18
    s_lshl_b32 s45, s26, 12
    s_add_u32 s44, s44, s45
    s_add_u32 s44, s44, 10747904
    v_mov_b32 v16, 0
    v_mov_b32 v17, 0
    v_mov_b32 v18, 0
    v_mov_b32 v19, 0
    v_mov_b32 v20, 0
    v_mov_b32 v21, 0
    v_mov_b32 v22, 0
    v_mov_b32 v23, 0
    v_mov_b32 v24, 0
    v_mov_b32 v25, 0
    v_mov_b32 v26, 0
    v_mov_b32 v27, 0
    v_mov_b32 v28, 0
    v_mov_b32 v29, 0
    v_mov_b32 v30, 0
    v_mov_b32 v31, 0
    v_mov_b32 v32, 0
    v_mov_b32 v33, 0
    v_mov_b32 v34, 0
    v_mov_b32 v35, 0
    v_mov_b32 v36, 0
    v_mov_b32 v37, 0
    v_mov_b32 v38, 0
    v_mov_b32 v39, 0
    v_mov_b32 v40, 0
    v_mov_b32 v41, 0
    v_mov_b32 v42, 0
    v_mov_b32 v43, 0
    v_mov_b32 v44, 0
    v_mov_b32 v45, 0
    v_mov_b32 v46, 0
    v_mov_b32 v47, 0
    v_mov_b32 v48, 0
    v_mov_b32 v49, 0
    v_mov_b32 v50, 0
    v_mov_b32 v51, 0
    v_mov_b32 v52, 0
    v_mov_b32 v53, 0
    v_mov_b32 v54, 0
    v_mov_b32 v55, 0
    v_mov_b32 v56, 0
    v_mov_b32 v57, 0
    v_mov_b32 v58, 0
    v_mov_b32 v59, 0
    v_mov_b32 v60, 0
    v_mov_b32 v61, 0
    v_mov_b32 v62, 0
    v_mov_b32 v63, 0
    s_mov_b32 s57, 0
L_k4q_62:
    buffer_load_dwordx4 v[64:67], v4, s[36:39], s44 offen sc1
    s_add_u32 s57, s57, 1
    s_waitcnt vmcnt(0)
    v_max_u32 v5, v64, v66
    v_cmp_eq_u32 vcc, -1, v5
    s_cmp_gt_u32 s57, 30000
    s_cbranch_scc1 L_k4r_63
    s_cbranch_vccz L_k4r_63
    s_sleep 2
    s_branch L_k4q_62
L_k4r_63:
    s_add_u32 s45, s44, 0
    buffer_load_dwordx4 v[64:67], v4, s[36:39], s45 offen offset:0 sc1
    buffer_load_dwordx4 v[68:71], v4, s[36:39], s45 offen offset:1024 sc1
    buffer_load_dwordx4 v[72:75], v4, s[36:39], s45 offen offset:2048 sc1
    buffer_load_dwordx4 v[76:79], v4, s[36:39], s45 offen offset:3072 sc1
    s_add_u32 s45, s44, 32768
    buffer_load_dwordx4 v[80:83], v4, s[36:39], s45 offen offset:0 sc1
    buffer_load_dwordx4 v[84:87], v4, s[36:39], s45 offen offset:1024 sc1
    buffer_load_dwordx4 v[88:91], v4, s[36:39], s45 offen offset:2048 sc1
    buffer_load_dwordx4 v[92:95], v4, s[36:39], s45 offen offset:3072 sc1
    s_add_u32 s45, s44, 65536
    buffer_load_dwordx4 v[96:99], v4, s[36:39], s45 offen offset:0 sc1
    buffer_load_dwordx4 v[100:103], v4, s[36:39], s45 offen offset:1024 sc1
    buffer_load_dwordx4 v[104:107], v4, s[36:39], s45 offen offset:2048 sc1
    buffer_load_dwordx4 v[108:111], v4, s[36:39], s45 offen offset:3072 sc1
    s_add_u32 s45, s44, 98304
    buffer_load_dwordx4 v[112:115], v4, s[36:39], s45 offen offset:0 sc1
    buffer_load_dwordx4 v[116:119], v4, s[36:39], s45 offen offset:1024 sc1
    buffer_load_dwordx4 v[120:123], v4, s[36:39], s45 offen offset:2048 sc1
    buffer_load_dwordx4 v[124:127], v4, s[36:39], s45 offen offset:3072 sc1
    s_waitcnt vmcnt(12)
    s_mov_b32 s57, 0
L_k4c_64:
    v_max3_u32 v5, v64, v66, v68
    v_max3_u32 v5, v5, v70, v72
    v_max3_u32 v5, v5, v74, v76
    v_max_u32 v5, v5, v78
    v_cmp_eq_u32 vcc, -1, v5
    s_add_u32 s57, s57, 1
    s_cbranch_vccz L_k4o_65
    s_cmp_gt_u32 s57, 30000
    s_cbranch_scc1 L_k4o_65
    s_add_u32 s45, s44, 0
    buffer_load_dwordx4 v[64:67], v4, s[36:39], s45 offen offset:0 sc1
    buffer_load_dwordx4 v[68:71], v4, s[36:39], s45 offen offset:1024 sc1
    buffer_load_dwordx4 v[72:75], v4, s[36:39], s45 offen offset:2048 sc1
    buffer_load_dwordx4 v[76:79], v4, s[36:39], s45 offen offset:3072 sc1
    s_waitcnt vmcnt(0)
    s_branch L_k4c_64
L_k4o_65:
    v_mfma_f32_16x16x32_bf16 v[16:19], v[128:131], v[64:67], v[16:19]
    v_mfma_f32_16x16x32_bf16 v[20:23], v[132:135], v[64:67], v[20:23]
    v_mfma_f32_16x16x32_bf16 v[24:27], v[136:139], v[64:67], v[24:27]
    v_mfma_f32_16x16x32_bf16 v[28:31], v[128:131], v[68:71], v[28:31]
    v_mfma_f32_16x16x32_bf16 v[32:35], v[132:135], v[68:71], v[32:35]
    v_mfma_f32_16x16x32_bf16 v[36:39], v[136:139], v[68:71], v[36:39]
    v_mfma_f32_16x16x32_bf16 v[40:43], v[128:131], v[72:75], v[40:43]
    v_mfma_f32_16x16x32_bf16 v[44:47], v[132:135], v[72:75], v[44:47]
    v_mfma_f32_16x16x32_bf16 v[48:51], v[136:139], v[72:75], v[48:51]
    v_mfma_f32_16x16x32_bf16 v[52:55], v[128:131], v[76:79], v[52:55]
    v_mfma_f32_16x16x32_bf16 v[56:59], v[132:135], v[76:79], v[56:59]
    v_mfma_f32_16x16x32_bf16 v[60:63], v[136:139], v[76:79], v[60:63]
    s_add_u32 s45, s44, 131072
    buffer_load_dwordx4 v[64:67], v4, s[36:39], s45 offen offset:0 sc1
    buffer_load_dwordx4 v[68:71], v4, s[36:39], s45 offen offset:1024 sc1
    buffer_load_dwordx4 v[72:75], v4, s[36:39], s45 offen offset:2048 sc1
    buffer_load_dwordx4 v[76:79], v4, s[36:39], s45 offen offset:3072 sc1
    s_waitcnt vmcnt(12)
    s_mov_b32 s57, 0
L_k4c_66:
    v_max3_u32 v5, v80, v82, v84
    v_max3_u32 v5, v5, v86, v88
    v_max3_u32 v5, v5, v90, v92
    v_max_u32 v5, v5, v94
    v_cmp_eq_u32 vcc, -1, v5
    s_add_u32 s57, s57, 1
    s_cbranch_vccz L_k4o_67
    s_cmp_gt_u32 s57, 30000
    s_cbranch_scc1 L_k4o_67
    s_add_u32 s45, s44, 32768
    buffer_load_dwordx4 v[80:83], v4, s[36:39], s45 offen offset:0 sc1
    buffer_load_dwordx4 v[84:87], v4, s[36:39], s45 offen offset:1024 sc1
    buffer_load_dwordx4 v[88:91], v4, s[36:39], s45 offen offset:2048 sc1
    buffer_load_dwordx4 v[92:95], v4, s[36:39], s45 offen offset:3072 sc1
    s_waitcnt vmcnt(0)
    s_branch L_k4c_66
L_k4o_67:
    v_mfma_f32_16x16x32_bf16 v[16:19], v[140:143], v[80:83], v[16:19]
    v_mfma_f32_16x16x32_bf16 v[20:23], v[144:147], v[80:83], v[20:23]
    v_mfma_f32_16x16x32_bf16 v[24:27], v[148:151], v[80:83], v[24:27]
    v_mfma_f32_16x16x32_bf16 v[28:31], v[140:143], v[84:87], v[28:31]
    v_mfma_f32_16x16x32_bf16 v[32:35], v[144:147], v[84:87], v[32:35]
    v_mfma_f32_16x16x32_bf16 v[36:39], v[148:151], v[84:87], v[36:39]
    v_mfma_f32_16x16x32_bf16 v[40:43], v[140:143], v[88:91], v[40:43]
    v_mfma_f32_16x16x32_bf16 v[44:47], v[144:147], v[88:91], v[44:47]
    v_mfma_f32_16x16x32_bf16 v[48:51], v[148:151], v[88:91], v[48:51]
    v_mfma_f32_16x16x32_bf16 v[52:55], v[140:143], v[92:95], v[52:55]
    v_mfma_f32_16x16x32_bf16 v[56:59], v[144:147], v[92:95], v[56:59]
    v_mfma_f32_16x16x32_bf16 v[60:63], v[148:151], v[92:95], v[60:63]
    s_add_u32 s45, s44, 163840
    buffer_load_dwordx4 v[80:83], v4, s[36:39], s45 offen offset:0 sc1
    buffer_load_dwordx4 v[84:87], v4, s[36:39], s45 offen offset:1024 sc1
    buffer_load_dwordx4 v[88:91], v4, s[36:39], s45 offen offset:2048 sc1
    buffer_load_dwordx4 v[92:95], v4, s[36:39], s45 offen offset:3072 sc1
    s_waitcnt vmcnt(12)
    s_mov_b32 s57, 0
L_k4c_68:
    v_max3_u32 v5, v96, v98, v100
    v_max3_u32 v5, v5, v102, v104
    v_max3_u32 v5, v5, v106, v108
    v_max_u32 v5, v5, v110
    v_cmp_eq_u32 vcc, -1, v5
    s_add_u32 s57, s57, 1
    s_cbranch_vccz L_k4o_69
    s_cmp_gt_u32 s57, 30000
    s_cbranch_scc1 L_k4o_69
    s_add_u32 s45, s44, 65536
    buffer_load_dwordx4 v[96:99], v4, s[36:39], s45 offen offset:0 sc1
    buffer_load_dwordx4 v[100:103], v4, s[36:39], s45 offen offset:1024 sc1
    buffer_load_dwordx4 v[104:107], v4, s[36:39], s45 offen offset:2048 sc1
    buffer_load_dwordx4 v[108:111], v4, s[36:39], s45 offen offset:3072 sc1
    s_waitcnt vmcnt(0)
    s_branch L_k4c_68
L_k4o_69:
    v_mfma_f32_16x16x32_bf16 v[16:19], v[152:155], v[96:99], v[16:19]
    v_mfma_f32_16x16x32_bf16 v[20:23], v[156:159], v[96:99], v[20:23]
    v_mfma_f32_16x16x32_bf16 v[24:27], v[160:163], v[96:99], v[24:27]
    v_mfma_f32_16x16x32_bf16 v[28:31], v[152:155], v[100:103], v[28:31]
    v_mfma_f32_16x16x32_bf16 v[32:35], v[156:159], v[100:103], v[32:35]
    v_mfma_f32_16x16x32_bf16 v[36:39], v[160:163], v[100:103], v[36:39]
    v_mfma_f32_16x16x32_bf16 v[40:43], v[152:155], v[104:107], v[40:43]
    v_mfma_f32_16x16x32_bf16 v[44:47], v[156:159], v[104:107], v[44:47]
    v_mfma_f32_16x16x32_bf16 v[48:51], v[160:163], v[104:107], v[48:51]
    v_mfma_f32_16x16x32_bf16 v[52:55], v[152:155], v[108:111], v[52:55]
    v_mfma_f32_16x16x32_bf16 v[56:59], v[156:159], v[108:111], v[56:59]
    v_mfma_f32_16x16x32_bf16 v[60:63], v[160:163], v[108:111], v[60:63]
    s_add_u32 s45, s44, 196608
    buffer_load_dwordx4 v[96:99], v4, s[36:39], s45 offen offset:0 sc1
    buffer_load_dwordx4 v[100:103], v4, s[36:39], s45 offen offset:1024 sc1
    buffer_load_dwordx4 v[104:107], v4, s[36:39], s45 offen offset:2048 sc1
    buffer_load_dwordx4 v[108:111], v4, s[36:39], s45 offen offset:3072 sc1
    s_waitcnt vmcnt(12)
    s_mov_b32 s57, 0
L_k4c_70:
    v_max3_u32 v5, v112, v114, v116
    v_max3_u32 v5, v5, v118, v120
    v_max3_u32 v5, v5, v122, v124
    v_max_u32 v5, v5, v126
    v_cmp_eq_u32 vcc, -1, v5
    s_add_u32 s57, s57, 1
    s_cbranch_vccz L_k4o_71
    s_cmp_gt_u32 s57, 30000
    s_cbranch_scc1 L_k4o_71
    s_add_u32 s45, s44, 98304
    buffer_load_dwordx4 v[112:115], v4, s[36:39], s45 offen offset:0 sc1
    buffer_load_dwordx4 v[116:119], v4, s[36:39], s45 offen offset:1024 sc1
    buffer_load_dwordx4 v[120:123], v4, s[36:39], s45 offen offset:2048 sc1
    buffer_load_dwordx4 v[124:127], v4, s[36:39], s45 offen offset:3072 sc1
    s_waitcnt vmcnt(0)
    s_branch L_k4c_70
L_k4o_71:
    v_mfma_f32_16x16x32_bf16 v[16:19], v[164:167], v[112:115], v[16:19]
    v_mfma_f32_16x16x32_bf16 v[20:23], v[168:171], v[112:115], v[20:23]
    v_mfma_f32_16x16x32_bf16 v[24:27], v[172:175], v[112:115], v[24:27]
    v_mfma_f32_16x16x32_bf16 v[28:31], v[164:167], v[116:119], v[28:31]
    v_mfma_f32_16x16x32_bf16 v[32:35], v[168:171], v[116:119], v[32:35]
    v_mfma_f32_16x16x32_bf16 v[36:39], v[172:175], v[116:119], v[36:39]
    v_mfma_f32_16x16x32_bf16 v[40:43], v[164:167], v[120:123], v[40:43]
    v_mfma_f32_16x16x32_bf16 v[44:47], v[168:171], v[120:123], v[44:47]
    v_mfma_f32_16x16x32_bf16 v[48:51], v[172:175], v[120:123], v[48:51]
    v_mfma_f32_16x16x32_bf16 v[52:55], v[164:167], v[124:127], v[52:55]
    v_mfma_f32_16x16x32_bf16 v[56:59], v[168:171], v[124:127], v[56:59]
    v_mfma_f32_16x16x32_bf16 v[60:63], v[172:175], v[124:127], v[60:63]
    s_add_u32 s45, s44, 229376
    buffer_load_dwordx4 v[112:115], v4, s[36:39], s45 offen offset:0 sc1
    buffer_load_dwordx4 v[116:119], v4, s[36:39], s45 offen offset:1024 sc1
    buffer_load_dwordx4 v[120:123], v4, s[36:39], s45 offen offset:2048 sc1
    buffer_load_dwordx4 v[124:127], v4, s[36:39], s45 offen offset:3072 sc1
    s_waitcnt vmcnt(12)
    s_mov_b32 s57, 0
L_k4c_72:
    v_max3_u32 v5, v64, v66, v68
    v_max3_u32 v5, v5, v70, v72
    v_max3_u32 v5, v5, v74, v76
    v_max_u32 v5, v5, v78
    v_cmp_eq_u32 vcc, -1, v5
    s_add_u32 s57, s57, 1
    s_cbranch_vccz L_k4o_73
    s_cmp_gt_u32 s57, 30000
    s_cbranch_scc1 L_k4o_73
    s_add_u32 s45, s44, 131072
    buffer_load_dwordx4 v[64:67], v4, s[36:39], s45 offen offset:0 sc1
    buffer_load_dwordx4 v[68:71], v4, s[36:39], s45 offen offset:1024 sc1
    buffer_load_dwordx4 v[72:75], v4, s[36:39], s45 offen offset:2048 sc1
    buffer_load_dwordx4 v[76:79], v4, s[36:39], s45 offen offset:3072 sc1
    s_waitcnt vmcnt(0)
    s_branch L_k4c_72
L_k4o_73:
    v_mfma_f32_16x16x32_bf16 v[16:19], v[176:179], v[64:67], v[16:19]
    v_mfma_f32_16x16x32_bf16 v[20:23], v[180:183], v[64:67], v[20:23]
    v_mfma_f32_16x16x32_bf16 v[24:27], v[184:187], v[64:67], v[24:27]
    v_mfma_f32_16x16x32_bf16 v[28:31], v[176:179], v[68:71], v[28:31]
    v_mfma_f32_16x16x32_bf16 v[32:35], v[180:183], v[68:71], v[32:35]
    v_mfma_f32_16x16x32_bf16 v[36:39], v[184:187], v[68:71], v[36:39]
    v_mfma_f32_16x16x32_bf16 v[40:43], v[176:179], v[72:75], v[40:43]
    v_mfma_f32_16x16x32_bf16 v[44:47], v[180:183], v[72:75], v[44:47]
    v_mfma_f32_16x16x32_bf16 v[48:51], v[184:187], v[72:75], v[48:51]
    v_mfma_f32_16x16x32_bf16 v[52:55], v[176:179], v[76:79], v[52:55]
    v_mfma_f32_16x16x32_bf16 v[56:59], v[180:183], v[76:79], v[56:59]
    v_mfma_f32_16x16x32_bf16 v[60:63], v[184:187], v[76:79], v[60:63]
    s_waitcnt vmcnt(8)
    s_mov_b32 s57, 0
L_k4c_74:
    v_max3_u32 v5, v80, v82, v84
    v_max3_u32 v5, v5, v86, v88
    v_max3_u32 v5, v5, v90, v92
    v_max_u32 v5, v5, v94
    v_cmp_eq_u32 vcc, -1, v5
    s_add_u32 s57, s57, 1
    s_cbranch_vccz L_k4o_75
    s_cmp_gt_u32 s57, 30000
    s_cbranch_scc1 L_k4o_75
    s_add_u32 s45, s44, 163840
    buffer_load_dwordx4 v[80:83], v4, s[36:39], s45 offen offset:0 sc1
    buffer_load_dwordx4 v[84:87], v4, s[36:39], s45 offen offset:1024 sc1
    buffer_load_dwordx4 v[88:91], v4, s[36:39], s45 offen offset:2048 sc1
    buffer_load_dwordx4 v[92:95], v4, s[36:39], s45 offen offset:3072 sc1
    s_waitcnt vmcnt(0)
    s_branch L_k4c_74
L_k4o_75:
    v_mfma_f32_16x16x32_bf16 v[16:19], v[188:191], v[80:83], v[16:19]
    v_mfma_f32_16x16x32_bf16 v[20:23], v[192:195], v[80:83], v[20:23]
    v_mfma_f32_16x16x32_bf16 v[24:27], v[196:199], v[80:83], v[24:27]
    v_mfma_f32_16x16x32_bf16 v[28:31], v[188:191], v[84:87], v[28:31]
    v_mfma_f32_16x16x32_bf16 v[32:35], v[192:195], v[84:87], v[32:35]
    v_mfma_f32_16x16x32_bf16 v[36:39], v[196:199], v[84:87], v[36:39]
    v_mfma_f32_16x16x32_bf16 v[40:43], v[188:191], v[88:91], v[40:43]
    v_mfma_f32_16x16x32_bf16 v[44:47], v[192:195], v[88:91], v[44:47]
    v_mfma_f32_16x16x32_bf16 v[48:51], v[196:199], v[88:91], v[48:51]
    v_mfma_f32_16x16x32_bf16 v[52:55], v[188:191], v[92:95], v[52:55]
    v_mfma_f32_16x16x32_bf16 v[56:59], v[192:195], v[92:95], v[56:59]
    v_mfma_f32_16x16x32_bf16 v[60:63], v[196:199], v[92:95], v[60:63]
    s_waitcnt vmcnt(4)
    s_mov_b32 s57, 0
L_k4c_76:
    v_max3_u32 v5, v96, v98, v100
    v_max3_u32 v5, v5, v102, v104
    v_max3_u32 v5, v5, v106, v108
    v_max_u32 v5, v5, v110
    v_cmp_eq_u32 vcc, -1, v5
    s_add_u32 s57, s57, 1
    s_cbranch_vccz L_k4o_77
    s_cmp_gt_u32 s57, 30000
    s_cbranch_scc1 L_k4o_77
    s_add_u32 s45, s44, 196608
    buffer_load_dwordx4 v[96:99], v4, s[36:39], s45 offen offset:0 sc1
    buffer_load_dwordx4 v[100:103], v4, s[36:39], s45 offen offset:1024 sc1
    buffer_load_dwordx4 v[104:107], v4, s[36:39], s45 offen offset:2048 sc1
    buffer_load_dwordx4 v[108:111], v4, s[36:39], s45 offen offset:3072 sc1
    s_waitcnt vmcnt(0)
    s_branch L_k4c_76
L_k4o_77:
    v_mfma_f32_16x16x32_bf16 v[16:19], v[200:203], v[96:99], v[16:19]
    v_mfma_f32_16x16x32_bf16 v[20:23], v[204:207], v[96:99], v[20:23]
    v_mfma_f32_16x16x32_bf16 v[24:27], v[208:211], v[96:99], v[24:27]
    v_mfma_f32_16x16x32_bf16 v[28:31], v[200:203], v[100:103], v[28:31]
    v_mfma_f32_16x16x32_bf16 v[32:35], v[204:207], v[100:103], v[32:35]
    v_mfma_f32_16x16x32_bf16 v[36:39], v[208:211], v[100:103], v[36:39]
    v_mfma_f32_16x16x32_bf16 v[40:43], v[200:203], v[104:107], v[40:43]
    v_mfma_f32_16x16x32_bf16 v[44:47], v[204:207], v[104:107], v[44:47]
    v_mfma_f32_16x16x32_bf16 v[48:51], v[208:211], v[104:107], v[48:51]
    v_mfma_f32_16x16x32_bf16 v[52:55], v[200:203], v[108:111], v[52:55]
    v_mfma_f32_16x16x32_bf16 v[56:59], v[204:207], v[108:111], v[56:59]
    v_mfma_f32_16x16x32_bf16 v[60:63], v[208:211], v[108:111], v[60:63]
    s_waitcnt vmcnt(0)
    s_mov_b32 s57, 0
L_k4c_78:
    v_max3_u32 v5, v112, v114, v116
    v_max3_u32 v5, v5, v118, v120
    v_max3_u32 v5, v5, v122, v124
    v_max_u32 v5, v5, v126
    v_cmp_eq_u32 vcc, -1, v5
    s_add_u32 s57, s57, 1
    s_cbranch_vccz L_k4o_79
    s_cmp_gt_u32 s57, 30000
    s_cbranch_scc1 L_k4o_79
    s_add_u32 s45, s44, 229376
    buffer_load_dwordx4 v[112:115], v4, s[36:39], s45 offen offset:0 sc1
    buffer_load_dwordx4 v[116:119], v4, s[36:39], s45 offen offset:1024 sc1
    buffer_load_dwordx4 v[120:123], v4, s[36:39], s45 offen offset:2048 sc1
    buffer_load_dwordx4 v[124:127], v4, s[36:39], s45 offen offset:3072 sc1
    s_waitcnt vmcnt(0)
    s_branch L_k4c_78
L_k4o_79:
    v_mfma_f32_16x16x32_bf16 v[16:19], v[212:215], v[112:115], v[16:19]
    v_mfma_f32_16x16x32_bf16 v[20:23], v[216:219], v[112:115], v[20:23]
    v_mfma_f32_16x16x32_bf16 v[24:27], v[220:223], v[112:115], v[24:27]
    v_mfma_f32_16x16x32_bf16 v[28:31], v[212:215], v[116:119], v[28:31]
    v_mfma_f32_16x16x32_bf16 v[32:35], v[216:219], v[116:119], v[32:35]
    v_mfma_f32_16x16x32_bf16 v[36:39], v[220:223], v[116:119], v[36:39]
    v_mfma_f32_16x16x32_bf16 v[40:43], v[212:215], v[120:123], v[40:43]
    v_mfma_f32_16x16x32_bf16 v[44:47], v[216:219], v[120:123], v[44:47]
    v_mfma_f32_16x16x32_bf16 v[48:51], v[220:223], v[120:123], v[48:51]
    v_mfma_f32_16x16x32_bf16 v[52:55], v[212:215], v[124:127], v[52:55]
    v_mfma_f32_16x16x32_bf16 v[56:59], v[216:219], v[124:127], v[56:59]
    v_mfma_f32_16x16x32_bf16 v[60:63], v[220:223], v[124:127], v[60:63]
    s_mul_i32 s45, s26, 12288
    v_add_u32 v5, s45, v4
    v_lshrrev_b32 v6, 4, v1
    v_lshlrev_b32 v6, 3, v6
    s_nop 4
    ds_write_b128 v5, v[16:19] offset:0
    ds_write_b128 v5, v[20:23] offset:1024
    ds_write_b128 v5, v[24:27] offset:2048
    ds_write_b128 v5, v[28:31] offset:3072
    ds_write_b128 v5, v[32:35] offset:4096
    ds_write_b128 v5, v[36:39] offset:5120
    ds_write_b128 v5, v[40:43] offset:6144
    ds_write_b128 v5, v[44:47] offset:7168
    ds_write_b128 v5, v[48:51] offset:8192
    ds_write_b128 v5, v[52:55] offset:9216
    ds_write_b128 v5, v[56:59] offset:10240
    ds_write_b128 v5, v[60:63] offset:11264
    s_and_b32 s43, s26, 1
    s_lshr_b32 s47, s26, 1
    s_mul_i32 s45, s42, 96
    s_lshl_b32 s48, s47, 5
    s_add_u32 s45, s45, s48
    buffer_load_dwordx2 v[10:11], v6, s[28:31], s45 offen
    s_waitcnt lgkmcnt(0)
    s_barrier
    s_cmp_ge_u32 s26, 6
    s_cbranch_scc1 L_k4_nostore
    s_cmp_eq_u32 s42, 28
    s_cselect_b32 s48, s47, 0
    s_cmp_eq_u32 s48, 2
    s_cbranch_scc1 L_k4_nostore
    s_mul_i32 s48, s43, 6
    s_add_u32 s48, s48, s47
    s_lshl_b32 s48, s48, 10
    v_add_u32 v5, s48, v4
    ds_read_b128 v[64:67], v5 offset:0
    ds_read_b128 v[68:71], v5 offset:3072
    ds_read_b128 v[72:75], v5 offset:12288
    ds_read_b128 v[76:79], v5 offset:15360
    ds_read_b128 v[80:83], v5 offset:24576
    ds_read_b128 v[84:87], v5 offset:27648
    ds_read_b128 v[88:91], v5 offset:36864
    ds_read_b128 v[92:95], v5 offset:39936
    ds_read_b128 v[96:99], v5 offset:49152
    ds_read_b128 v[100:103], v5 offset:52224
    v_add_u32 v7, 61440, v5
    ds_read_b128 v[104:107], v5 offset:61440
    ds_read_b128 v[108:111], v5 offset:64512
    ds_read_b128 v[112:115], v7 offset:12288
    ds_read_b128 v[116:119], v7 offset:15360
    ds_read_b128 v[120:123], v7 offset:24576
    ds_read_b128 v[124:127], v7 offset:27648
    s_waitcnt vmcnt(0)
    v_lshlrev_b32 v16, 16, v10
    v_and_b32 v17, 0xffff0000, v10
    v_lshlrev_b32 v18, 16, v11
    v_and_b32 v19, 0xffff0000, v11
    v_mov_b32 v20, v16
    v_mov_b32 v21, v17
    v_mov_b32 v22, v18
    v_mov_b32 v23, v19
    s_waitcnt lgkmcnt(14)
    v_pk_add_f32 v[16:17], v[16:17], v[64:65]
    v_pk_add_f32 v[18:19], v[18:19], v[66:67]
    v_pk_add_f32 v[20:21], v[20:21], v[68:69]
    v_pk_add_f32 v[22:23], v[22:23], v[70:71]
    s_waitcnt lgkmcnt(12)
    v_pk_add_f32 v[16:17], v[16:17], v[72:73]
    v_pk_add_f32 v[18:19], v[18:19], v[74:75]
    v_pk_add_f32 v[20:21], v[20:21], v[76:77]
    v_pk_add_f32 v[22:23], v[22:23], v[78:79]
    s_waitcnt lgkmcnt(10)
    v_pk_add_f32 v[16:17], v[16:17], v[80:81]
    v_pk_add_f32 v[18:19], v[18:19], v[82:83]
    v_pk_add_f32 v[20:21], v[20:21], v[84:85]
    v_pk_add_f32 v[22:23], v[22:23], v[86:87]
    s_waitcnt lgkmcnt(8)
    v_pk_add_f32 v[16:17], v[16:17], v[88:89]
    v_pk_add_f32 v[18:19], v[18:19], v[90:91]
    v_pk_add_f32 v[20:21], v[20:21], v[92:93]
    v_pk_add_f32 v[22:23], v[22:23], v[94:95]
    s_waitcnt lgkmcnt(6)
    v_pk_add_f32 v[16:17], v[16:17], v[96:97]
    v_pk_add_f32 v[18:19], v[18:19], v[98:99]
    v_pk_add_f32 v[20:21], v[20:21], v[100:101]
    v_pk_add_f32 v[22:23], v[22:23], v[102:103]
    s_waitcnt lgkmcnt(4)
    v_pk_add_f32 v[16:17], v[16:17], v[104:105]
    v_pk_add_f32 v[18:19], v[18:19], v[106:107]
    v_pk_add_f32 v[20:21], v[20:21], v[108:109]
    v_pk_add_f32 v[22:23], v[22:23], v[110:111]
    s_waitcnt lgkmcnt(2)
    v_pk_add_f32 v[16:17], v[16:17], v[112:113]
    v_pk_add_f32 v[18:19], v[18:19], v[114:115]
    v_pk_add_f32 v[20:21], v[20:21], v[116:117]
    v_pk_add_f32 v[22:23], v[22:23], v[118:119]
    s_waitcnt lgkmcnt(0)
    v_pk_add_f32 v[16:17], v[16:17], v[120:121]
    v_pk_add_f32 v[18:19], v[18:19], v[122:123]
    v_pk_add_f32 v[20:21], v[20:21], v[124:125]
    v_pk_add_f32 v[22:23], v[22:23], v[126:127]
    s_mov_b32 s45, 0xc0135761
    s_mov_b32 s46, 0xbdd2d3e8
    v_mov_b32 v7, s45
    v_mul_f32 v32, v16, v16
    v_mul_f32 v33, v17, v17
    v_mul_f32 v34, v18, v18
    v_mul_f32 v35, v19, v19
    v_mul_f32 v36, v20, v20
    v_mul_f32 v37, v21, v21
    v_mul_f32 v38, v22, v22
    v_mul_f32 v39, v23, v23
    v_fma_f32 v32, s46, v32, v7
    v_fma_f32 v33, s46, v33, v7
    v_fma_f32 v34, s46, v34, v7
    v_fma_f32 v35, s46, v35, v7
    v_fma_f32 v36, s46, v36, v7
    v_fma_f32 v37, s46, v37, v7
    v_fma_f32 v38, s46, v38, v7
    v_fma_f32 v39, s46, v39, v7
    v_mul_f32 v32, v32, v16
    v_mul_f32 v33, v33, v17
    v_mul_f32 v34, v34, v18
    v_mul_f32 v35, v35, v19
    v_mul_f32 v36, v36, v20
    v_mul_f32 v37, v37, v21
    v_mul_f32 v38, v38, v22
    v_mul_f32 v39, v39, v23
    v_exp_f32 v32, v32
    v_exp_f32 v33, v33
    v_exp_f32 v34, v34
    v_exp_f32 v35, v35
    v_exp_f32 v36, v36
    v_exp_f32 v37, v37
    v_exp_f32 v38, v38
    v_exp_f32 v39, v39
    v_add_f32 v32, 1.0, v32
    v_add_f32 v33, 1.0, v33
    v_add_f32 v34, 1.0, v34
    v_add_f32 v35, 1.0, v35
    v_add_f32 v36, 1.0, v36
    v_add_f32 v37, 1.0, v37
    v_add_f32 v38, 1.0, v38
    v_add_f32 v39, 1.0, v39
    v_rcp_f32 v32, v32
    v_rcp_f32 v33, v33
    v_rcp_f32 v34, v34
    v_rcp_f32 v35, v35
    v_rcp_f32 v36, v36
    v_rcp_f32 v37, v37
    v_rcp_f32 v38, v38
    v_rcp_f32 v39, v39
    v_mul_f32 v16, v16, v32
    v_mul_f32 v17, v17, v33
    v_mul_f32 v18, v18, v34
    v_mul_f32 v19, v19, v35
    v_mul_f32 v20, v20, v36
    v_mul_f32 v21, v21, v37
    v_mul_f32 v22, v22, v38
    v_mul_f32 v23, v23, v39
    v_cvt_pk_bf16_f32 v48, v16, v17
    v_cvt_pk_bf16_f32 v49, v18, v19
    v_cvt_pk_bf16_f32 v50, v20, v21
    v_cvt_pk_bf16_f32 v51, v22, v23
    s_lshl_b32 s45, s101, 1
    s_add_u32 s45, s45, s43
    s_mul_i32 s45, s45, 88064
    s_mul_i32 s46, s42, 3
    s_add_u32 s46, s46, s47
    s_lshl_b32 s46, s46, 10
    s_add_u32 s45, s45, s46
    s_add_u32 s45, s45, 12845056
    v_and_b32 v40, 15, v1
    v_lshlrev_b32 v40, 4, v40
    v_bfe_u32 v41, v1, 4, 1
    v_lshl_add_u32 v40, v41, 9, v40
    v_lshrrev_b32 v41, 5, v1
    v_lshl_add_u32 v40, v41, 8, v40
    v_permlane32_swap_b32 v48, v50
    v_permlane32_swap_b32 v49, v51
    buffer_store_dwordx4 v[48:51], v40, s[36:39], s45 offen sc1
L_k4_nostore:
    s_waitcnt vmcnt(0)
L_k4_join:
    s_and_b32 s42, s26, 1
    s_bfe_u32 s43, s26, 0x10001
    s_mov_b32 s28, s18
    s_and_b32 s29, s19, 0xffff
    s_mov_b32 s30, 0x1000
    s_mov_b32 s31, 0x20000
    s_mov_b32 s32, s16
    s_and_b32 s33, s17, 0xffff
    s_mov_b32 s34, 0x560000
    s_mov_b32 s35, 0x20000
    s_mov_b32 s52, s20
    s_and_b32 s53, s21, 0xffff
    s_mov_b32 s54, 0x200000
    s_mov_b32 s55, 0x20000
    s_cmp_ge_u32 s26, 4
    s_cbranch_scc1 L_k5_helper
    s_barrier
    s_cmp_eq_u32 s59, 0
    s_cbranch_scc1 L_k5s_80
    s_lshl_b32 s46, s101, 11
    s_add_u32 s46, s46, 14467072
    s_cmp_lg_u32 s26, 0
    s_cbranch_scc1 L_sig_81
    s_mov_b64 exec, 255
    v_lshlrev_b32 v2, 8, v1
    v_mov_b32 v3, 1
    buffer_atomic_add v3, v2, s[36:39], s46 offen
    s_mov_b64 exec, -1
L_sig_81:
L_k5s_80:
    v_lshlrev_b32 v9, 4, v1
    v_and_b32 v16, 31, v1
    v_lshlrev_b32 v17, 1, v16
    s_lshl_b32 s45, s41, 7
    s_lshl_b32 s46, s43, 6
    s_add_u32 s45, s45, s46
    buffer_load_ushort v8, v17, s[28:31], s45 offen
    v_and_b32 v16, 15, v1
    v_lshrrev_b32 v16, 2, v16
    v_lshrrev_b32 v17, 5, v1
    v_lshl_add_u32 v5, v17, 2, v16
    v_mul_u32_u24 v5, 128, v5
    v_lshrrev_b32 v16, 1, v16
    v_xor_b32 v16, s43, v16
    v_lshl_add_u32 v5, v16, 6, v5
    v_bfe_u32 v16, v1, 4, 1
    v_lshl_add_u32 v5, v16, 5, v5
    v_and_b32 v16, 3, v1
    v_lshl_add_u32 v5, v16, 3, v5
    v_add_u32 v5, 65536, v5
    s_lshl_b32 s45, s42, 12
    v_add_u32 v4, s45, v9
    v_mov_b32 v16, 0
    v_mov_b32 v17, 0
    v_mov_b32 v18, 0
    v_mov_b32 v19, 0
    v_mov_b32 v20, 0
    v_mov_b32 v21, 0
    v_mov_b32 v22, 0
    v_mov_b32 v23, 0
    v_mov_b32 v24, 0
    v_mov_b32 v25, 0
    v_mov_b32 v26, 0
    v_mov_b32 v27, 0
    v_mov_b32 v28, 0
    v_mov_b32 v29, 0
    v_mov_b32 v30, 0
    v_mov_b32 v31, 0
    s_lshl_b32 s46, s40, 11
    s_add_u32 s46, s46, 14467072
    s_cmp_lg_u32 s26, 0
    s_cbranch_scc1 L_w_82
    s_mov_b64 exec, 1
    s_lshl_b32 s56, s27, 0
    s_xor_b32 s56, s56, s3
    s_and_b32 s56, s56, 7
    s_lshl_b32 s56, s56, 8
    v_mov_b32 v2, s56
    s_mov_b32 s57, 0
L_wp_83:
    buffer_load_dword v3, v2, s[36:39], s46 offen sc1
    s_waitcnt vmcnt(0)
    v_readfirstlane_b32 s56, v3
    s_add_u32 s57, s57, 1
    s_cmp_ge_u32 s56, 29
    s_cbranch_scc1 L_wd_84
    s_cmp_gt_u32 s57, 30000
    s_cbranch_scc1 L_wd_84
    s_sleep 1
    s_branch L_wp_83
L_wd_84:
    s_mov_b64 exec, -1
L_w_82:
    s_barrier
    s_barrier
    v_add_u32 v6, 0, v4
    v_add_u32 v7, 0, v5
    ds_read_b128 v[32:35], v6 offset:0
    ds_read_b64_tr_b16 v[36:37], v7 offset:0
    ds_read_b64_tr_b16 v[38:39], v7 offset:1024
    ds_read_b128 v[40:43], v6 offset:1024
    ds_read_b64_tr_b16 v[44:45], v7 offset:2048
    ds_read_b64_tr_b16 v[46:47], v7 offset:3072
    ds_read_b128 v[48:51], v6 offset:2048
    ds_read_b64_tr_b16 v[52:53], v7 offset:4096
    ds_read_b64_tr_b16 v[54:55], v7 offset:5120
    ds_read_b128 v[56:59], v6 offset:3072
    ds_read_b64_tr_b16 v[60:61], v7 offset:6144
    ds_read_b64_tr_b16 v[62:63], v7 offset:7168
    s_barrier
    v_add_u32 v6, 8192, v4
    v_add_u32 v7, 8192, v5
    s_waitcnt lgkmcnt(9)
    v_mfma_f32_32x32x16_bf16 v[16:31], v[32:35], v[36:39], v[16:31]
    ds_read_b128 v[64:67], v6 offset:0
    ds_read_b64_tr_b16 v[68:69], v7 offset:0
    ds_read_b64_tr_b16 v[70:71], v7 offset:1024
    s_waitcnt lgkmcnt(9)
    v_mfma_f32_32x32x16_bf16 v[16:31], v[40:43], v[44:47], v[16:31]
    ds_read_b128 v[72:75], v6 offset:1024
    ds_read_b64_tr_b16 v[76:77], v7 offset:2048
    ds_read_b64_tr_b16 v[78:79], v7 offset:3072
    s_waitcnt lgkmcnt(9)
    v_mfma_f32_32x32x16_bf16 v[16:31], v[48:51], v[52:55], v[16:31]
    ds_read_b128 v[80:83], v6 offset:2048
    ds_read_b64_tr_b16 v[84:85], v7 offset:4096
    ds_read_b64_tr_b16 v[86:87], v7 offset:5120
    s_waitcnt lgkmcnt(9)
    v_mfma_f32_32x32x16_bf16 v[16:31], v[56:59], v[60:63], v[16:31]
    ds_read_b128 v[88:91], v6 offset:3072
    ds_read_b64_tr_b16 v[92:93], v7 offset:6144
    ds_read_b64_tr_b16 v[94:95], v7 offset:7168
    s_barrier
    v_add_u32 v6, 16384, v4
    v_add_u32 v7, 16384, v5
    s_waitcnt lgkmcnt(9)
    v_mfma_f32_32x32x16_bf16 v[16:31], v[64:67], v[68:71], v[16:31]
    ds_read_b128 v[32:35], v6 offset:0
    ds_read_b64_tr_b16 v[36:37], v7 offset:0
    ds_read_b64_tr_b16 v[38:39], v7 offset:1024
    s_waitcnt lgkmcnt(9)
    v_mfma_f32_32x32x16_bf16 v[16:31], v[72:75], v[76:79], v[16:31]
    ds_read_b128 v[40:43], v6 offset:1024
    ds_read_b64_tr_b16 v[44:45], v7 offset:2048
    ds_read_b64_tr_b16 v[46:47], v7 offset:3072
    s_waitcnt lgkmcnt(9)
    v_mfma_f32_32x32x16_bf16 v[16:31], v[80:83], v[84:87], v[16:31]
    ds_read_b128 v[48:51], v6 offset:2048
    ds_read_b64_tr_b16 v[52:53], v7 offset:4096
    ds_read_b64_tr_b16 v[54:55], v7 offset:5120
    s_waitcnt lgkmcnt(9)
    v_mfma_f32_32x32x16_bf16 v[16:31], v[88:91], v[92:95], v[16:31]
    ds_read_b128 v[56:59], v6 offset:3072
    ds_read_b64_tr_b16 v[60:61], v7 offset:6144
    ds_read_b64_tr_b16 v[62:63], v7 offset:7168
    s_barrier
    v_add_u32 v6, 24576, v4
    v_add_u32 v7, 24576, v5
    s_waitcnt lgkmcnt(9)
    v_mfma_f32_32x32x16_bf16 v[16:31], v[32:35], v[36:39], v[16:31]
    ds_read_b128 v[64:67], v6 offset:0
    ds_read_b64_tr_b16 v[68:69], v7 offset:0
    ds_read_b64_tr_b16 v[70:71], v7 offset:1024
    s_waitcnt lgkmcnt(9)
    v_mfma_f32_32x32x16_bf16 v[16:31], v[40:43], v[44:47], v[16:31]
    ds_read_b128 v[72:75], v6 offset:1024
    ds_read_b64_tr_b16 v[76:77], v7 offset:2048
    ds_read_b64_tr_b16 v[78:79], v7 offset:3072
    s_waitcnt lgkmcnt(9)
    v_mfma_f32_32x32x16_bf16 v[16:31], v[48:51], v[52:55], v[16:31]
    ds_read_b128 v[80:83], v6 offset:2048
    ds_read_b64_tr_b16 v[84:85], v7 offset:4096
    ds_read_b64_tr_b16 v[86:87], v7 offset:5120
    s_waitcnt lgkmcnt(9)
    v_mfma_f32_32x32x16_bf16 v[16:31], v[56:59], v[60:63], v[16:31]
    ds_read_b128 v[88:91], v6 offset:3072
    ds_read_b64_tr_b16 v[92:93], v7 offset:6144
    ds_read_b64_tr_b16 v[94:95], v7 offset:7168
    s_barrier
    v_add_u32 v6, 32768, v4
    v_add_u32 v7, 32768, v5
    s_waitcnt lgkmcnt(9)
    v_mfma_f32_32x32x16_bf16 v[16:31], v[64:67], v[68:71], v[16:31]
    ds_read_b128 v[32:35], v6 offset:0
    ds_read_b64_tr_b16 v[36:37], v7 offset:0
    ds_read_b64_tr_b16 v[38:39], v7 offset:1024
    s_waitcnt lgkmcnt(9)
    v_mfma_f32_32x32x16_bf16 v[16:31], v[72:75], v[76:79], v[16:31]
    ds_read_b128 v[40:43], v6 offset:1024
    ds_read_b64_tr_b16 v[44:45], v7 offset:2048
    ds_read_b64_tr_b16 v[46:47], v7 offset:3072
    s_waitcnt lgkmcnt(9)
    v_mfma_f32_32x32x16_bf16 v[16:31], v[80:83], v[84:87], v[16:31]
    ds_read_b128 v[48:51], v6 offset:2048
    ds_read_b64_tr_b16 v[52:53], v7 offset:4096
    ds_read_b64_tr_b16 v[54:55], v7 offset:5120
    s_waitcnt lgkmcnt(9)
    v_mfma_f32_32x32x16_bf16 v[16:31], v[88:91], v[92:95], v[16:31]
    ds_read_b128 v[56:59], v6 offset:3072
    ds_read_b64_tr_b16 v[60:61], v7 offset:6144
    ds_read_b64_tr_b16 v[62:63], v7 offset:7168
    s_barrier
    v_add_u32 v6, 40960, v4
    v_add_u32 v7, 40960, v5
    s_waitcnt lgkmcnt(9)
    v_mfma_f32_32x32x16_bf16 v[16:31], v[32:35], v[36:39], v[16:31]
    ds_read_b128 v[64:67], v6 offset:0
    ds_read_b64_tr_b16 v[68:69], v7 offset:0
    ds_read_b64_tr_b16 v[70:71], v7 offset:1024
    s_waitcnt lgkmcnt(9)
    v_mfma_f32_32x32x16_bf16 v[16:31], v[40:43], v[44:47], v[16:31]
    ds_read_b128 v[72:75], v6 offset:1024
    ds_read_b64_tr_b16 v[76:77], v7 offset:2048
    ds_read_b64_tr_b16 v[78:79], v7 offset:3072
    s_waitcnt lgkmcnt(9)
    v_mfma_f32_32x32x16_bf16 v[16:31], v[48:51], v[52:55], v[16:31]
    ds_read_b128 v[80:83], v6 offset:2048
    ds_read_b64_tr_b16 v[84:85], v7 offset:4096
    ds_read_b64_tr_b16 v[86:87], v7 offset:5120
    s_waitcnt lgkmcnt(9)
    v_mfma_f32_32x32x16_bf16 v[16:31], v[56:59], v[60:63], v[16:31]
    ds_read_b128 v[88:91], v6 offset:3072
    ds_read_b64_tr_b16 v[92:93], v7 offset:6144
    ds_read_b64_tr_b16 v[94:95], v7 offset:7168
    s_barrier
    v_add_u32 v6, 49152, v4
    v_add_u32 v7, 49152, v5
    s_waitcnt lgkmcnt(9)
    v_mfma_f32_32x32x16_bf16 v[16:31], v[64:67], v[68:71], v[16:31]
    ds_read_b128 v[32:35], v6 offset:0
    ds_read_b64_tr_b16 v[36:37], v7 offset:0
    ds_read_b64_tr_b16 v[38:39], v7 offset:1024
    s_waitcnt lgkmcnt(9)
    v_mfma_f32_32x32x16_bf16 v[16:31], v[72:75], v[76:79], v[16:31]
    ds_read_b128 v[40:43], v6 offset:1024
    ds_read_b64_tr_b16 v[44:45], v7 offset:2048
    ds_read_b64_tr_b16 v[46:47], v7 offset:3072
    s_waitcnt lgkmcnt(9)
    v_mfma_f32_32x32x16_bf16 v[16:31], v[80:83], v[84:87], v[16:31]
    ds_read_b128 v[48:51], v6 offset:2048
    ds_read_b64_tr_b16 v[52:53], v7 offset:4096
    ds_read_b64_tr_b16 v[54:55], v7 offset:5120
    s_waitcnt lgkmcnt(9)
    v_mfma_f32_32x32x16_bf16 v[16:31], v[88:91], v[92:95], v[16:31]
    ds_read_b128 v[56:59], v6 offset:3072
    ds_read_b64_tr_b16 v[60:61], v7 offset:6144
    ds_read_b64_tr_b16 v[62:63], v7 offset:7168
    s_barrier
    v_add_u32 v6, 57344, v4
    v_add_u32 v7, 57344, v5
    s_waitcnt lgkmcnt(9)
    v_mfma_f32_32x32x16_bf16 v[16:31], v[32:35], v[36:39], v[16:31]
    ds_read_b128 v[64:67], v6 offset:0
    ds_read_b64_tr_b16 v[68:69], v7 offset:0
    ds_read_b64_tr_b16 v[70:71], v7 offset:1024
    s_waitcnt lgkmcnt(9)
    v_mfma_f32_32x32x16_bf16 v[16:31], v[40:43], v[44:47], v[16:31]
    ds_read_b128 v[72:75], v6 offset:1024
    ds_read_b64_tr_b16 v[76:77], v7 offset:2048
    ds_read_b64_tr_b16 v[78:79], v7 offset:3072
    s_waitcnt lgkmcnt(9)
    v_mfma_f32_32x32x16_bf16 v[16:31], v[48:51], v[52:55], v[16:31]
    ds_read_b128 v[80:83], v6 offset:2048
    ds_read_b64_tr_b16 v[84:85], v7 offset:4096
    ds_read_b64_tr_b16 v[86:87], v7 offset:5120
    s_waitcnt lgkmcnt(9)
    v_mfma_f32_32x32x16_bf16 v[16:31], v[56:59], v[60:63], v[16:31]
    ds_read_b128 v[88:91], v6 offset:3072
    ds_read_b64_tr_b16 v[92:93], v7 offset:6144
    ds_read_b64_tr_b16 v[94:95], v7 offset:7168
    s_barrier
    v_add_u32 v6, 0, v4
    v_add_u32 v7, 65536, v5
    s_waitcnt lgkmcnt(9)
    v_mfma_f32_32x32x16_bf16 v[16:31], v[64:67], v[68:71], v[16:31]
    ds_read_b128 v[32:35], v6 offset:0
    ds_read_b64_tr_b16 v[36:37], v7 offset:0
    ds_read_b64_tr_b16 v[38:39], v7 offset:1024
    s_waitcnt lgkmcnt(9)
    v_mfma_f32_32x32x16_bf16 v[16:31], v[72:75], v[76:79], v[16:31]
    ds_read_b128 v[40:43], v6 offset:1024
    ds_read_b64_tr_b16 v[44:45], v7 offset:2048
    ds_read_b64_tr_b16 v[46:47], v7 offset:3072
    s_waitcnt lgkmcnt(9)
    v_mfma_f32_32x32x16_bf16 v[16:31], v[80:83], v[84:87], v[16:31]
    ds_read_b128 v[48:51], v6 offset:2048
    ds_read_b64_tr_b16 v[52:53], v7 offset:4096
    ds_read_b64_tr_b16 v[54:55], v7 offset:5120
    s_waitcnt lgkmcnt(9)
    v_mfma_f32_32x32x16_bf16 v[16:31], v[88:91], v[92:95], v[16:31]
    ds_read_b128 v[56:59], v6 offset:3072
    ds_read_b64_tr_b16 v[60:61], v7 offset:6144
    ds_read_b64_tr_b16 v[62:63], v7 offset:7168
    s_barrier
    v_add_u32 v6, 8192, v4
    v_add_u32 v7, 73728, v5
    s_waitcnt lgkmcnt(9)
    v_mfma_f32_32x32x16_bf16 v[16:31], v[32:35], v[36:39], v[16:31]
    ds_read_b128 v[64:67], v6 offset:0
    ds_read_b64_tr_b16 v[68:69], v7 offset:0
    ds_read_b64_tr_b16 v[70:71], v7 offset:1024
    s_waitcnt lgkmcnt(9)
    v_mfma_f32_32x32x16_bf16 v[16:31], v[40:43], v[44:47], v[16:31]
    ds_read_b128 v[72:75], v6 offset:1024
    ds_read_b64_tr_b16 v[76:77], v7 offset:2048
    ds_read_b64_tr_b16 v[78:79], v7 offset:3072
    s_waitcnt lgkmcnt(9)
    v_mfma_f32_32x32x16_bf16 v[16:31], v[48:51], v[52:55], v[16:31]
    ds_read_b128 v[80:83], v6 offset:2048
    ds_read_b64_tr_b16 v[84:85], v7 offset:4096
    ds_read_b64_tr_b16 v[86:87], v7 offset:5120
    s_waitcnt lgkmcnt(9)
    v_mfma_f32_32x32x16_bf16 v[16:31], v[56:59], v[60:63], v[16:31]
    ds_read_b128 v[88:91], v6 offset:3072
    ds_read_b64_tr_b16 v[92:93], v7 offset:6144
    ds_read_b64_tr_b16 v[94:95], v7 offset:7168
    s_barrier
    v_add_u32 v6, 16384, v4
    v_add_u32 v7, 81920, v5
    s_waitcnt lgkmcnt(9)
    v_mfma_f32_32x32x16_bf16 v[16:31], v[64:67], v[68:71], v[16:31]
    ds_read_b128 v[32:35], v6 offset:0
    ds_read_b64_tr_b16 v[36:37], v7 offset:0
    ds_read_b64_tr_b16 v[38:39], v7 offset:1024
    s_waitcnt lgkmcnt(9)
    v_mfma_f32_32x32x16_bf16 v[16:31], v[72:75], v[76:79], v[16:31]
    ds_read_b128 v[40:43], v6 offset:1024
    ds_read_b64_tr_b16 v[44:45], v7 offset:2048
    ds_read_b64_tr_b16 v[46:47], v7 offset:3072
    s_waitcnt lgkmcnt(9)
    v_mfma_f32_32x32x16_bf16 v[16:31], v[80:83], v[84:87], v[16:31]
    ds_read_b128 v[48:51], v6 offset:2048
    ds_read_b64_tr_b16 v[52:53], v7 offset:4096
    ds_read_b64_tr_b16 v[54:55], v7 offset:5120
    s_waitcnt lgkmcnt(9)
    v_mfma_f32_32x32x16_bf16 v[16:31], v[88:91], v[92:95], v[16:31]
    ds_read_b128 v[56:59], v6 offset:3072
    ds_read_b64_tr_b16 v[60:61], v7 offset:6144
    ds_read_b64_tr_b16 v[62:63], v7 offset:7168
    s_barrier
    v_add_u32 v6, 24576, v4
    v_add_u32 v7, 90112, v5
    s_waitcnt lgkmcnt(9)
    v_mfma_f32_32x32x16_bf16 v[16:31], v[32:35], v[36:39], v[16:31]
    ds_read_b128 v[64:67], v6 offset:0
    ds_read_b64_tr_b16 v[68:69], v7 offset:0
    ds_read_b64_tr_b16 v[70:71], v7 offset:1024
    s_waitcnt lgkmcnt(9)
    v_mfma_f32_32x32x16_bf16 v[16:31], v[40:43], v[44:47], v[16:31]
    ds_read_b128 v[72:75], v6 offset:1024
    ds_read_b64_tr_b16 v[76:77], v7 offset:2048
    ds_read_b64_tr_b16 v[78:79], v7 offset:3072
    s_waitcnt lgkmcnt(9)
    v_mfma_f32_32x32x16_bf16 v[16:31], v[48:51], v[52:55], v[16:31]
    ds_read_b128 v[80:83], v6 offset:2048
    ds_read_b64_tr_b16 v[84:85], v7 offset:4096
    ds_read_b64_tr_b16 v[86:87], v7 offset:5120
    s_waitcnt lgkmcnt(9)
    v_mfma_f32_32x32x16_bf16 v[16:31], v[56:59], v[60:63], v[16:31]
    ds_read_b128 v[88:91], v6 offset:3072
    ds_read_b64_tr_b16 v[92:93], v7 offset:6144
    ds_read_b64_tr_b16 v[94:95], v7 offset:7168
    s_barrier
    v_add_u32 v6, 32768, v4
    v_add_u32 v7, 0, v5
    s_waitcnt lgkmcnt(9)
    v_mfma_f32_32x32x16_bf16 v[16:31], v[64:67], v[68:71], v[16:31]
    ds_read_b128 v[32:35], v6 offset:0
    ds_read_b64_tr_b16 v[36:37], v7 offset:0
    ds_read_b64_tr_b16 v[38:39], v7 offset:1024
    s_waitcnt lgkmcnt(9)
    v_mfma_f32_32x32x16_bf16 v[16:31], v[72:75], v[76:79], v[16:31]
    ds_read_b128 v[40:43], v6 offset:1024
    ds_read_b64_tr_b16 v[44:45], v7 offset:2048
    ds_read_b64_tr_b16 v[46:47], v7 offset:3072
    s_waitcnt lgkmcnt(9)
    v_mfma_f32_32x32x16_bf16 v[16:31], v[80:83], v[84:87], v[16:31]
    ds_read_b128 v[48:51], v6 offset:2048
    ds_read_b64_tr_b16 v[52:53], v7 offset:4096
    ds_read_b64_tr_b16 v[54:55], v7 offset:5120
    s_waitcnt lgkmcnt(9)
    v_mfma_f32_32x32x16_bf16 v[16:31], v[88:91], v[92:95], v[16:31]
    ds_read_b128 v[56:59], v6 offset:3072
    ds_read_b64_tr_b16 v[60:61], v7 offset:6144
    ds_read_b64_tr_b16 v[62:63], v7 offset:7168
    s_barrier
    v_add_u32 v6, 40960, v4
    v_add_u32 v7, 8192, v5
    s_waitcnt lgkmcnt(9)
    v_mfma_f32_32x32x16_bf16 v[16:31], v[32:35], v[36:39], v[16:31]
    ds_read_b128 v[64:67], v6 offset:0
    ds_read_b64_tr_b16 v[68:69], v7 offset:0
    ds_read_b64_tr_b16 v[70:71], v7 offset:1024
    s_waitcnt lgkmcnt(9)
    v_mfma_f32_32x32x16_bf16 v[16:31], v[40:43], v[44:47], v[16:31]
    ds_read_b128 v[72:75], v6 offset:1024
    ds_read_b64_tr_b16 v[76:77], v7 offset:2048
    ds_read_b64_tr_b16 v[78:79], v7 offset:3072
    s_waitcnt lgkmcnt(9)
    v_mfma_f32_32x32x16_bf16 v[16:31], v[48:51], v[52:55], v[16:31]
    ds_read_b128 v[80:83], v6 offset:2048
    ds_read_b64_tr_b16 v[84:85], v7 offset:4096
    ds_read_b64_tr_b16 v[86:87], v7 offset:5120
    s_waitcnt lgkmcnt(9)
    v_mfma_f32_32x32x16_bf16 v[16:31], v[56:59], v[60:63], v[16:31]
    ds_read_b128 v[88:91], v6 offset:3072
    ds_read_b64_tr_b16 v[92:93], v7 offset:6144
    ds_read_b64_tr_b16 v[94:95], v7 offset:7168
    s_barrier
    v_add_u32 v6, 49152, v4
    v_add_u32 v7, 16384, v5
    s_waitcnt lgkmcnt(9)
    v_mfma_f32_32x32x16_bf16 v[16:31], v[64:67], v[68:71], v[16:31]
    ds_read_b128 v[32:35], v6 offset:0
    ds_read_b64_tr_b16 v[36:37], v7 offset:0
    ds_read_b64_tr_b16 v[38:39], v7 offset:1024
    s_waitcnt lgkmcnt(9)
    v_mfma_f32_32x32x16_bf16 v[16:31], v[72:75], v[76:79], v[16:31]
    ds_read_b128 v[40:43], v6 offset:1024
    ds_read_b64_tr_b16 v[44:45], v7 offset:2048
    ds_read_b64_tr_b16 v[46:47], v7 offset:3072
    s_waitcnt lgkmcnt(9)
    v_mfma_f32_32x32x16_bf16 v[16:31], v[80:83], v[84:87], v[16:31]
    ds_read_b128 v[48:51], v6 offset:2048
    ds_read_b64_tr_b16 v[52:53], v7 offset:4096
    ds_read_b64_tr_b16 v[54:55], v7 offset:5120
    s_waitcnt lgkmcnt(9)
    v_mfma_f32_32x32x16_bf16 v[16:31], v[88:91], v[92:95], v[16:31]
    ds_read_b128 v[56:59], v6 offset:3072
    ds_read_b64_tr_b16 v[60:61], v7 offset:6144
    ds_read_b64_tr_b16 v[62:63], v7 offset:7168
    s_barrier
    v_add_u32 v6, 57344, v4
    v_add_u32 v7, 24576, v5
    s_waitcnt lgkmcnt(9)
    v_mfma_f32_32x32x16_bf16 v[16:31], v[32:35], v[36:39], v[16:31]
    ds_read_b128 v[64:67], v6 offset:0
    ds_read_b64_tr_b16 v[68:69], v7 offset:0
    ds_read_b64_tr_b16 v[70:71], v7 offset:1024
    s_waitcnt lgkmcnt(9)
    v_mfma_f32_32x32x16_bf16 v[16:31], v[40:43], v[44:47], v[16:31]
    ds_read_b128 v[72:75], v6 offset:1024
    ds_read_b64_tr_b16 v[76:77], v7 offset:2048
    ds_read_b64_tr_b16 v[78:79], v7 offset:3072
    s_waitcnt lgkmcnt(9)
    v_mfma_f32_32x32x16_bf16 v[16:31], v[48:51], v[52:55], v[16:31]
    ds_read_b128 v[80:83], v6 offset:2048
    ds_read_b64_tr_b16 v[84:85], v7 offset:4096
    ds_read_b64_tr_b16 v[86:87], v7 offset:5120
    s_waitcnt lgkmcnt(9)
    v_mfma_f32_32x32x16_bf16 v[16:31], v[56:59], v[60:63], v[16:31]
    ds_read_b128 v[88:91], v6 offset:3072
    ds_read_b64_tr_b16 v[92:93], v7 offset:6144
    ds_read_b64_tr_b16 v[94:95], v7 offset:7168
    s_barrier
    v_add_u32 v6, 0, v4
    v_add_u32 v7, 32768, v5
    s_waitcnt lgkmcnt(9)
    v_mfma_f32_32x32x16_bf16 v[16:31], v[64:67], v[68:71], v[16:31]
    ds_read_b128 v[32:35], v6 offset:0
    ds_read_b64_tr_b16 v[36:37], v7 offset:0
    ds_read_b64_tr_b16 v[38:39], v7 offset:1024
    s_waitcnt lgkmcnt(9)
    v_mfma_f32_32x32x16_bf16 v[16:31], v[72:75], v[76:79], v[16:31]
    ds_read_b128 v[40:43], v6 offset:1024
    ds_read_b64_tr_b16 v[44:45], v7 offset:2048
    ds_read_b64_tr_b16 v[46:47], v7 offset:3072
    s_waitcnt lgkmcnt(9)
    v_mfma_f32_32x32x16_bf16 v[16:31], v[80:83], v[84:87], v[16:31]
    ds_read_b128 v[48:51], v6 offset:2048
    ds_read_b64_tr_b16 v[52:53], v7 offset:4096
    ds_read_b64_tr_b16 v[54:55], v7 offset:5120
    s_waitcnt lgkmcnt(9)
    v_mfma_f32_32x32x16_bf16 v[16:31], v[88:91], v[92:95], v[16:31]
    ds_read_b128 v[56:59], v6 offset:3072
    ds_read_b64_tr_b16 v[60:61], v7 offset:6144
    ds_read_b64_tr_b16 v[62:63], v7 offset:7168
    s_barrier
    v_add_u32 v6, 8192, v4
    v_add_u32 v7, 40960, v5
    s_waitcnt lgkmcnt(9)
    v_mfma_f32_32x32x16_bf16 v[16:31], v[32:35], v[36:39], v[16:31]
    ds_read_b128 v[64:67], v6 offset:0
    ds_read_b64_tr_b16 v[68:69], v7 offset:0
    ds_read_b64_tr_b16 v[70:71], v7 offset:1024
    s_waitcnt lgkmcnt(9)
    v_mfma_f32_32x32x16_bf16 v[16:31], v[40:43], v[44:47], v[16:31]
    ds_read_b128 v[72:75], v6 offset:1024
    ds_read_b64_tr_b16 v[76:77], v7 offset:2048
    ds_read_b64_tr_b16 v[78:79], v7 offset:3072
    s_waitcnt lgkmcnt(9)
    v_mfma_f32_32x32x16_bf16 v[16:31], v[48:51], v[52:55], v[16:31]
    ds_read_b128 v[80:83], v6 offset:2048
    ds_read_b64_tr_b16 v[84:85], v7 offset:4096
    ds_read_b64_tr_b16 v[86:87], v7 offset:5120
    s_waitcnt lgkmcnt(9)
    v_mfma_f32_32x32x16_bf16 v[16:31], v[56:59], v[60:63], v[16:31]
    ds_read_b128 v[88:91], v6 offset:3072
    ds_read_b64_tr_b16 v[92:93], v7 offset:6144
    ds_read_b64_tr_b16 v[94:95], v7 offset:7168
    s_barrier
    v_add_u32 v6, 16384, v4
    v_add_u32 v7, 49152, v5
    s_waitcnt lgkmcnt(9)
    v_mfma_f32_32x32x16_bf16 v[16:31], v[64:67], v[68:71], v[16:31]
    ds_read_b128 v[32:35], v6 offset:0
    ds_read_b64_tr_b16 v[36:37], v7 offset:0
    ds_read_b64_tr_b16 v[38:39], v7 offset:1024
    s_waitcnt lgkmcnt(9)
    v_mfma_f32_32x32x16_bf16 v[16:31], v[72:75], v[76:79], v[16:31]
    ds_read_b128 v[40:43], v6 offset:1024
    ds_read_b64_tr_b16 v[44:45], v7 offset:2048
    ds_read_b64_tr_b16 v[46:47], v7 offset:3072
    s_waitcnt lgkmcnt(9)
    v_mfma_f32_32x32x16_bf16 v[16:31], v[80:83], v[84:87], v[16:31]
    ds_read_b128 v[48:51], v6 offset:2048
    ds_read_b64_tr_b16 v[52:53], v7 offset:4096
    ds_read_b64_tr_b16 v[54:55], v7 offset:5120
    s_waitcnt lgkmcnt(9)
    v_mfma_f32_32x32x16_bf16 v[16:31], v[88:91], v[92:95], v[16:31]
    ds_read_b128 v[56:59], v6 offset:3072
    ds_read_b64_tr_b16 v[60:61], v7 offset:6144
    ds_read_b64_tr_b16 v[62:63], v7 offset:7168
    s_barrier
    v_add_u32 v6, 24576, v4
    v_add_u32 v7, 57344, v5
    s_waitcnt lgkmcnt(9)
    v_mfma_f32_32x32x16_bf16 v[16:31], v[32:35], v[36:39], v[16:31]
    ds_read_b128 v[64:67], v6 offset:0
    ds_read_b64_tr_b16 v[68:69], v7 offset:0
    ds_read_b64_tr_b16 v[70:71], v7 offset:1024
    s_waitcnt lgkmcnt(9)
    v_mfma_f32_32x32x16_bf16 v[16:31], v[40:43], v[44:47], v[16:31]
    ds_read_b128 v[72:75], v6 offset:1024
    ds_read_b64_tr_b16 v[76:77], v7 offset:2048
    ds_read_b64_tr_b16 v[78:79], v7 offset:3072
    s_waitcnt lgkmcnt(9)
    v_mfma_f32_32x32x16_bf16 v[16:31], v[48:51], v[52:55], v[16:31]
    ds_read_b128 v[80:83], v6 offset:2048
    ds_read_b64_tr_b16 v[84:85], v7 offset:4096
    ds_read_b64_tr_b16 v[86:87], v7 offset:5120
    s_waitcnt lgkmcnt(9)
    v_mfma_f32_32x32x16_bf16 v[16:31], v[56:59], v[60:63], v[16:31]
    ds_read_b128 v[88:91], v6 offset:3072
    ds_read_b64_tr_b16 v[92:93], v7 offset:6144
    ds_read_b64_tr_b16 v[94:95], v7 offset:7168
    s_barrier
    v_add_u32 v6, 32768, v4
    v_add_u32 v7, 65536, v5
    s_waitcnt lgkmcnt(9)
    v_mfma_f32_32x32x16_bf16 v[16:31], v[64:67], v[68:71], v[16:31]
    ds_read_b128 v[32:35], v6 offset:0
    ds_read_b64_tr_b16 v[36:37], v7 offset:0
    ds_read_b64_tr_b16 v[38:39], v7 offset:1024
    s_waitcnt lgkmcnt(9)
    v_mfma_f32_32x32x16_bf16 v[16:31], v[72:75], v[76:79], v[16:31]
    ds_read_b128 v[40:43], v6 offset:1024
    ds_read_b64_tr_b16 v[44:45], v7 offset:2048
    ds_read_b64_tr_b16 v[46:47], v7 offset:3072
    s_waitcnt lgkmcnt(9)
    v_mfma_f32_32x32x16_bf16 v[16:31], v[80:83], v[84:87], v[16:31]
    ds_read_b128 v[48:51], v6 offset:2048
    ds_read_b64_tr_b16 v[52:53], v7 offset:4096
    ds_read_b64_tr_b16 v[54:55], v7 offset:5120
    s_waitcnt lgkmcnt(9)
    v_mfma_f32_32x32x16_bf16 v[16:31], v[88:91], v[92:95], v[16:31]
    ds_read_b128 v[56:59], v6 offset:3072
    ds_read_b64_tr_b16 v[60:61], v7 offset:6144
    ds_read_b64_tr_b16 v[62:63], v7 offset:7168
    s_barrier
    v_add_u32 v6, 40960, v4
    v_add_u32 v7, 73728, v5
    s_waitcnt lgkmcnt(9)
    v_mfma_f32_32x32x16_bf16 v[16:31], v[32:35], v[36:39], v[16:31]
    ds_read_b128 v[64:67], v6 offset:0
    ds_read_b64_tr_b16 v[68:69], v7 offset:0
    ds_read_b64_tr_b16 v[70:71], v7 offset:1024
    s_waitcnt lgkmcnt(9)
    v_mfma_f32_32x32x16_bf16 v[16:31], v[40:43], v[44:47], v[16:31]
    ds_read_b128 v[72:75], v6 offset:1024
    ds_read_b64_tr_b16 v[76:77], v7 offset:2048
    ds_read_b64_tr_b16 v[78:79], v7 offset:3072
    s_waitcnt lgkmcnt(9)
    v_mfma_f32_32x32x16_bf16 v[16:31], v[48:51], v[52:55], v[16:31]
    s_waitcnt lgkmcnt(6)
    v_mfma_f32_32x32x16_bf16 v[16:31], v[56:59], v[60:63], v[16:31]
    s_waitcnt lgkmcnt(3)
    v_mfma_f32_32x32x16_bf16 v[16:31], v[64:67], v[68:71], v[16:31]
    s_waitcnt lgkmcnt(0)
    v_mfma_f32_32x32x16_bf16 v[16:31], v[72:75], v[76:79], v[16:31]
    s_waitcnt vmcnt(0)
    v_lshlrev_b32 v32, 16, v248
    v_and_b32 v33, 0xffff0000, v248
    v_lshlrev_b32 v34, 16, v249
    v_and_b32 v35, 0xffff0000, v249
    v_lshlrev_b32 v36, 16, v250
    v_and_b32 v37, 0xffff0000, v250
    v_lshlrev_b32 v38, 16, v251
    v_and_b32 v39, 0xffff0000, v251
    v_lshlrev_b32 v40, 16, v252
    v_and_b32 v41, 0xffff0000, v252
    v_lshlrev_b32 v42, 16, v253
    v_and_b32 v43, 0xffff0000, v253
    v_lshlrev_b32 v44, 16, v254
    v_and_b32 v45, 0xffff0000, v254
    v_lshlrev_b32 v46, 16, v255
    v_and_b32 v47, 0xffff0000, v255
    v_lshlrev_b32 v8, 16, v8
    v_add_f32 v32, v32, v8
    v_add_f32 v33, v33, v8
    v_add_f32 v34, v34, v8
    v_add_f32 v35, v35, v8
    v_add_f32 v36, v36, v8
    v_add_f32 v37, v37, v8
    v_add_f32 v38, v38, v8
    v_add_f32 v39, v39, v8
    v_add_f32 v40, v40, v8
    v_add_f32 v41, v41, v8
    v_add_f32 v42, v42, v8
    v_add_f32 v43, v43, v8
    v_add_f32 v44, v44, v8
    v_add_f32 v45, v45, v8
    v_add_f32 v46, v46, v8
    v_add_f32 v47, v47, v8
    v_add_f32 v32, v32, v16
    v_add_f32 v33, v33, v17
    v_add_f32 v34, v34, v18
    v_add_f32 v35, v35, v19
    v_add_f32 v36, v36, v20
    v_add_f32 v37, v37, v21
    v_add_f32 v38, v38, v22
    v_add_f32 v39, v39, v23
    v_add_f32 v40, v40, v24
    v_add_f32 v41, v41, v25
    v_add_f32 v42, v42, v26
    v_add_f32 v43, v43, v27
    v_add_f32 v44, v44, v28
    v_add_f32 v45, v45, v29
    v_add_f32 v46, v46, v30
    v_add_f32 v47, v47, v31
    v_cvt_pk_bf16_f32 v48, v32, v33
    v_cvt_pk_bf16_f32 v49, v34, v35
    v_cvt_pk_bf16_f32 v50, v36, v37
    v_cvt_pk_bf16_f32 v51, v38, v39
    v_cvt_pk_bf16_f32 v52, v40, v41
    v_cvt_pk_bf16_f32 v53, v42, v43
    v_cvt_pk_bf16_f32 v54, v44, v45
    v_cvt_pk_bf16_f32 v55, v46, v47
    v_and_b32 v16, 31, v1
    v_lshlrev_b32 v16, 10, v16
    v_lshrrev_b32 v17, 5, v1
    v_lshl_add_u32 v16, v17, 4, v16
    s_lshl_b32 s44, s41, 16
    s_lshl_b32 s45, s43, 15
    s_add_u32 s44, s44, s45
    s_lshl_b32 s45, s40, 7
    s_add_u32 s44, s44, s45
    s_lshl_b32 s45, s42, 6
    s_add_u32 s44, s44, s45
    s_nop 1
    v_permlane32_swap_b32 v48, v50
    v_permlane32_swap_b32 v49, v51
    v_permlane32_swap_b32 v52, v54
    v_permlane32_swap_b32 v53, v55
    buffer_store_dwordx4 v[48:51], v16, s[52:55], s44 offen
    buffer_store_dwordx4 v[52:55], v16, s[52:55], s44 offen offset:32
    s_branch L_fin
L_k5_helper:
    s_and_b32 s43, s26, 3
    v_lshrrev_b32 v6, 3, v1
    v_mul_u32_u24 v4, 4096, v6
    v_bfe_u32 v6, v1, 4, 1
    v_lshlrev_b32 v6, 2, v6
    v_and_b32 v7, 7, v1
    v_xor_b32 v6, v6, v7
    v_lshl_add_u32 v4, v6, 4, v4
    v_lshlrev_b32 v5, 4, v1
    s_lshr_b32 s44, s43, 1
    s_and_b32 s45, s43, 1
    s_lshl_b32 s46, s40, 1
    s_add_u32 s46, s46, s44
    s_mul_i32 s46, s46, 88064
    s_lshl_b32 s47, s45, 11
    s_add_u32 s46, s46, s47
    s_add_u32 s46, s46, 12845056
    s_lshl_b32 s48, s44, 12
    s_add_u32 s48, s48, s47
    s_lshl_b32 s49, s43, 16
    s_lshl_b32 s50, s41, 7
    s_add_u32 s49, s49, s50
    s_lshl_b32 s50, s43, 11
    s_add_u32 s50, s50, 65536
    s_lshr_b32 s57, s3, 2
    s_mul_i32 s57, s57, 2
    s_barrier
    s_add_u32 s58, s57, 0
    s_cmp_ge_u32 s58, 21
    s_cselect_b32 s56, 21, 0
    s_sub_u32 s58, s58, s56
    s_lshl_b32 s58, s58, 18
    s_add_u32 s58, s58, s49
    s_add_u32 m0, s50, 0
    s_add_u32 s51, s58, 0
    buffer_load_dwordx4 v4, s[32:35], s51 offen lds
    s_add_u32 m0, s50, 1024
    s_add_u32 s51, s58, 32768
    buffer_load_dwordx4 v4, s[32:35], s51 offen lds
    s_add_u32 s58, s57, 1
    s_cmp_ge_u32 s58, 21
    s_cselect_b32 s56, 21, 0
    s_sub_u32 s58, s58, s56
    s_lshl_b32 s58, s58, 18
    s_add_u32 s58, s58, s49
    s_add_u32 m0, s50, 8192
    s_add_u32 s51, s58, 0
    buffer_load_dwordx4 v4, s[32:35], s51 offen lds
    s_add_u32 m0, s50, 9216
    s_add_u32 s51, s58, 32768
    buffer_load_dwordx4 v4, s[32:35], s51 offen lds
    s_add_u32 s58, s57, 2
    s_cmp_ge_u32 s58, 21
    s_cselect_b32 s56, 21, 0
    s_sub_u32 s58, s58, s56
    s_lshl_b32 s58, s58, 18
    s_add_u32 s58, s58, s49
    s_add_u32 m0, s50, 16384
    s_add_u32 s51, s58, 0
    buffer_load_dwordx4 v4, s[32:35], s51 offen lds
    s_add_u32 m0, s50, 17408
    s_add_u32 s51, s58, 32768
    buffer_load_dwordx4 v4, s[32:35], s51 offen lds
    s_add_u32 s58, s57, 3
    s_cmp_ge_u32 s58, 21
    s_cselect_b32 s56, 21, 0
    s_sub_u32 s58, s58, s56
    s_lshl_b32 s58, s58, 18
    s_add_u32 s58, s58, s49
    s_add_u32 m0, s50, 24576
    s_add_u32 s51, s58, 0
    buffer_load_dwordx4 v4, s[32:35], s51 offen lds
    s_add_u32 m0, s50, 25600
    s_add_u32 s51, s58, 32768
    buffer_load_dwordx4 v4, s[32:35], s51 offen lds
    s_add_u32 s58, s57, 4
    s_cmp_ge_u32 s58, 21
    s_cselect_b32 s56, 21, 0
    s_sub_u32 s58, s58, s56
    s_lshl_b32 s58, s58, 18
    s_add_u32 s58, s58, s49
    s_add_u32 m0, s50, 32768
    s_add_u32 s51, s58, 0
    buffer_load_dwordx4 v4, s[32:35], s51 offen lds
    s_add_u32 m0, s50, 33792
    s_add_u32 s51, s58, 32768
    buffer_load_dwordx4 v4, s[32:35], s51 offen lds
    s_add_u32 s58, s57, 5
    s_cmp_ge_u32 s58, 21
    s_cselect_b32 s56, 21, 0
    s_sub_u32 s58, s58, s56
    s_lshl_b32 s58, s58, 18
    s_add_u32 s58, s58, s49
    s_add_u32 m0, s50, 40960
    s_add_u32 s51, s58, 0
    buffer_load_dwordx4 v4, s[32:35], s51 offen lds
    s_add_u32 m0, s50, 41984
    s_add_u32 s51, s58, 32768
    buffer_load_dwordx4 v4, s[32:35], s51 offen lds
    s_add_u32 s58, s57, 6
    s_cmp_ge_u32 s58, 21
    s_cselect_b32 s56, 21, 0
    s_sub_u32 s58, s58, s56
    s_lshl_b32 s58, s58, 18
    s_add_u32 s58, s58, s49
    s_add_u32 m0, s50, 49152
    s_add_u32 s51, s58, 0
    buffer_load_dwordx4 v4, s[32:35], s51 offen lds
    s_add_u32 m0, s50, 50176
    s_add_u32 s51, s58, 32768
    buffer_load_dwordx4 v4, s[32:35], s51 offen lds
    s_add_u32 s58, s57, 7
    s_cmp_ge_u32 s58, 21
    s_cselect_b32 s56, 21, 0
    s_sub_u32 s58, s58, s56
    s_lshl_b32 s58, s58, 18
    s_add_u32 s58, s58, s49
    s_add_u32 m0, s50, 57344
    s_add_u32 s51, s58, 0
    buffer_load_dwordx4 v4, s[32:35], s51 offen lds
    s_add_u32 m0, s50, 58368
    s_add_u32 s51, s58, 32768
    buffer_load_dwordx4 v4, s[32:35], s51 offen lds
    s_add_u32 s58, s57, 8
    s_cmp_ge_u32 s58, 21
    s_cselect_b32 s56, 21, 0
    s_sub_u32 s58, s58, s56
    s_lshl_b32 s58, s58, 18
    s_add_u32 s58, s58, s49
    s_add_u32 m0, s50, 65536
    s_add_u32 s51, s58, 0
    buffer_load_dwordx4 v4, s[32:35], s51 offen lds
    s_add_u32 m0, s50, 66560
    s_add_u32 s51, s58, 32768
    buffer_load_dwordx4 v4, s[32:35], s51 offen lds
    s_add_u32 s58, s57, 9
    s_cmp_ge_u32 s58, 21
    s_cselect_b32 s56, 21, 0
    s_sub_u32 s58, s58, s56
    s_lshl_b32 s58, s58, 18
    s_add_u32 s58, s58, s49
    s_add_u32 m0, s50, 73728
    s_add_u32 s51, s58, 0
    buffer_load_dwordx4 v4, s[32:35], s51 offen lds
    s_add_u32 m0, s50, 74752
    s_add_u32 s51, s58, 32768
    buffer_load_dwordx4 v4, s[32:35], s51 offen lds
    s_add_u32 s58, s57, 10
    s_cmp_ge_u32 s58, 21
    s_cselect_b32 s56, 21, 0
    s_sub_u32 s58, s58, s56
    s_lshl_b32 s58, s58, 18
    s_add_u32 s58, s58, s49
    s_add_u32 m0, s50, 81920
    s_add_u32 s51, s58, 0
    buffer_load_dwordx4 v4, s[32:35], s51 offen lds
    s_add_u32 m0, s50, 82944
    s_add_u32 s51, s58, 32768
    buffer_load_dwordx4 v4, s[32:35], s51 offen lds
    s_add_u32 s58, s57, 11
    s_cmp_ge_u32 s58, 21
    s_cselect_b32 s56, 21, 0
    s_sub_u32 s58, s58, s56
    s_lshl_b32 s58, s58, 18
    s_add_u32 s58, s58, s49
    s_add_u32 m0, s50, 90112
    s_add_u32 s51, s58, 0
    buffer_load_dwordx4 v4, s[32:35], s51 offen lds
    s_add_u32 m0, s50, 91136
    s_add_u32 s51, s58, 32768
    buffer_load_dwordx4 v4, s[32:35], s51 offen lds
    s_barrier
    s_add_u32 s58, s57, 0
    s_cmp_ge_u32 s58, 21
    s_cselect_b32 s56, 21, 0
    s_sub_u32 s58, s58, s56
    s_lshl_b32 s58, s58, 12
    s_add_u32 s58, s58, s46
    s_add_u32 m0, s48, 0
    s_add_u32 s51, s58, 0
    buffer_load_dwordx4 v5, s[36:39], s51 offen sc1 lds
    s_add_u32 m0, s48, 1024
    s_add_u32 s51, s58, 1024
    buffer_load_dwordx4 v5, s[36:39], s51 offen sc1 lds
    s_add_u32 s58, s57, 1
    s_cmp_ge_u32 s58, 21
    s_cselect_b32 s56, 21, 0
    s_sub_u32 s58, s58, s56
    s_lshl_b32 s58, s58, 12
    s_add_u32 s58, s58, s46
    s_add_u32 m0, s48, 8192
    s_add_u32 s51, s58, 0
    buffer_load_dwordx4 v5, s[36:39], s51 offen sc1 lds
    s_add_u32 m0, s48, 9216
    s_add_u32 s51, s58, 1024
    buffer_load_dwordx4 v5, s[36:39], s51 offen sc1 lds
    s_add_u32 s58, s57, 2
    s_cmp_ge_u32 s58, 21
    s_cselect_b32 s56, 21, 0
    s_sub_u32 s58, s58, s56
    s_lshl_b32 s58, s58, 12
    s_add_u32 s58, s58, s46
    s_add_u32 m0, s48, 16384
    s_add_u32 s51, s58, 0
    buffer_load_dwordx4 v5, s[36:39], s51 offen sc1 lds
    s_add_u32 m0, s48, 17408
    s_add_u32 s51, s58, 1024
    buffer_load_dwordx4 v5, s[36:39], s51 offen sc1 lds
    s_add_u32 s58, s57, 3
    s_cmp_ge_u32 s58, 21
    s_cselect_b32 s56, 21, 0
    s_sub_u32 s58, s58, s56
    s_lshl_b32 s58, s58, 12
    s_add_u32 s58, s58, s46
    s_add_u32 m0, s48, 24576
    s_add_u32 s51, s58, 0
    buffer_load_dwordx4 v5, s[36:39], s51 offen sc1 lds
    s_add_u32 m0, s48, 25600
    s_add_u32 s51, s58, 1024
    buffer_load_dwordx4 v5, s[36:39], s51 offen sc1 lds
    s_add_u32 s58, s57, 4
    s_cmp_ge_u32 s58, 21
    s_cselect_b32 s56, 21, 0
    s_sub_u32 s58, s58, s56
    s_lshl_b32 s58, s58, 12
    s_add_u32 s58, s58, s46
    s_add_u32 m0, s48, 32768
    s_add_u32 s51, s58, 0
    buffer_load_dwordx4 v5, s[36:39], s51 offen sc1 lds
    s_add_u32 m0, s48, 33792
    s_add_u32 s51, s58, 1024
    buffer_load_dwordx4 v5, s[36:39], s51 offen sc1 lds
    s_add_u32 s58, s57, 5
    s_cmp_ge_u32 s58, 21
    s_cselect_b32 s56, 21, 0
    s_sub_u32 s58, s58, s56
    s_lshl_b32 s58, s58, 12
    s_add_u32 s58, s58, s46
    s_add_u32 m0, s48, 40960
    s_add_u32 s51, s58, 0
    buffer_load_dwordx4 v5, s[36:39], s51 offen sc1 lds
    s_add_u32 m0, s48, 41984
    s_add_u32 s51, s58, 1024
    buffer_load_dwordx4 v5, s[36:39], s51 offen sc1 lds
    s_add_u32 s58, s57, 6
    s_cmp_ge_u32 s58, 21
    s_cselect_b32 s56, 21, 0
    s_sub_u32 s58, s58, s56
    s_lshl_b32 s58, s58, 12
    s_add_u32 s58, s58, s46
    s_add_u32 m0, s48, 49152
    s_add_u32 s51, s58, 0
    buffer_load_dwordx4 v5, s[36:39], s51 offen sc1 lds
    s_add_u32 m0, s48, 50176
    s_add_u32 s51, s58, 1024
    buffer_load_dwordx4 v5, s[36:39], s51 offen sc1 lds
    s_add_u32 s58, s57, 7
    s_cmp_ge_u32 s58, 21
    s_cselect_b32 s56, 21, 0
    s_sub_u32 s58, s58, s56
    s_lshl_b32 s58, s58, 12
    s_add_u32 s58, s58, s46
    s_add_u32 m0, s48, 57344
    s_add_u32 s51, s58, 0
    buffer_load_dwordx4 v5, s[36:39], s51 offen sc1 lds
    s_add_u32 m0, s48, 58368
    s_add_u32 s51, s58, 1024
    buffer_load_dwordx4 v5, s[36:39], s51 offen sc1 lds
    s_waitcnt vmcnt(14)
    s_barrier
    s_waitcnt vmcnt(12)
    s_barrier
    s_waitcnt vmcnt(10)
    s_barrier
    s_add_u32 s58, s57, 8
    s_cmp_ge_u32 s58, 21
    s_cselect_b32 s56, 21, 0
    s_sub_u32 s58, s58, s56
    s_lshl_b32 s58, s58, 12
    s_add_u32 s58, s58, s46
    s_add_u32 m0, s48, 0
    s_add_u32 s51, s58, 0
    buffer_load_dwordx4 v5, s[36:39], s51 offen sc1 lds
    s_add_u32 m0, s48, 1024
    s_add_u32 s51, s58, 1024
    buffer_load_dwordx4 v5, s[36:39], s51 offen sc1 lds
    s_add_u32 s58, s57, 12
    s_cmp_ge_u32 s58, 21
    s_cselect_b32 s56, 21, 0
    s_sub_u32 s58, s58, s56
    s_lshl_b32 s58, s58, 18
    s_add_u32 s58, s58, s49
    s_add_u32 m0, s50, 0
    s_add_u32 s51, s58, 0
    buffer_load_dwordx4 v4, s[32:35], s51 offen lds
    s_add_u32 m0, s50, 1024
    s_add_u32 s51, s58, 32768
    buffer_load_dwordx4 v4, s[32:35], s51 offen lds
    s_waitcnt vmcnt(12)
    s_barrier
    s_add_u32 s58, s57, 9
    s_cmp_ge_u32 s58, 21
    s_cselect_b32 s56, 21, 0
    s_sub_u32 s58, s58, s56
    s_lshl_b32 s58, s58, 12
    s_add_u32 s58, s58, s46
    s_add_u32 m0, s48, 8192
    s_add_u32 s51, s58, 0
    buffer_load_dwordx4 v5, s[36:39], s51 offen sc1 lds
    s_add_u32 m0, s48, 9216
    s_add_u32 s51, s58, 1024
    buffer_load_dwordx4 v5, s[36:39], s51 offen sc1 lds
    s_add_u32 s58, s57, 13
    s_cmp_ge_u32 s58, 21
    s_cselect_b32 s56, 21, 0
    s_sub_u32 s58, s58, s56
    s_lshl_b32 s58, s58, 18
    s_add_u32 s58, s58, s49
    s_add_u32 m0, s50, 8192
    s_add_u32 s51, s58, 0
    buffer_load_dwordx4 v4, s[32:35], s51 offen lds
    s_add_u32 m0, s50, 9216
    s_add_u32 s51, s58, 32768
    buffer_load_dwordx4 v4, s[32:35], s51 offen lds
    s_waitcnt vmcnt(14)
    s_barrier
    s_add_u32 s58, s57, 10
    s_cmp_ge_u32 s58, 21
    s_cselect_b32 s56, 21, 0
    s_sub_u32 s58, s58, s56
    s_lshl_b32 s58, s58, 12
    s_add_u32 s58, s58, s46
    s_add_u32 m0, s48, 16384
    s_add_u32 s51, s58, 0
    buffer_load_dwordx4 v5, s[36:39], s51 offen sc1 lds
    s_add_u32 m0, s48, 17408
    s_add_u32 s51, s58, 1024
    buffer_load_dwordx4 v5, s[36:39], s51 offen sc1 lds
    s_add_u32 s58, s57, 14
    s_cmp_ge_u32 s58, 21
    s_cselect_b32 s56, 21, 0
    s_sub_u32 s58, s58, s56
    s_lshl_b32 s58, s58, 18
    s_add_u32 s58, s58, s49
    s_add_u32 m0, s50, 16384
    s_add_u32 s51, s58, 0
    buffer_load_dwordx4 v4, s[32:35], s51 offen lds
    s_add_u32 m0, s50, 17408
    s_add_u32 s51, s58, 32768
    buffer_load_dwordx4 v4, s[32:35], s51 offen lds
    s_waitcnt vmcnt(16)
    s_barrier
    s_add_u32 s58, s57, 11
    s_cmp_ge_u32 s58, 21
    s_cselect_b32 s56, 21, 0
    s_sub_u32 s58, s58, s56
    s_lshl_b32 s58, s58, 12
    s_add_u32 s58, s58, s46
    s_add_u32 m0, s48, 24576
    s_add_u32 s51, s58, 0
    buffer_load_dwordx4 v5, s[36:39], s51 offen sc1 lds
    s_add_u32 m0, s48, 25600
    s_add_u32 s51, s58, 1024
    buffer_load_dwordx4 v5, s[36:39], s51 offen sc1 lds
    s_add_u32 s58, s57, 15
    s_cmp_ge_u32 s58, 21
    s_cselect_b32 s56, 21, 0
    s_sub_u32 s58, s58, s56
    s_lshl_b32 s58, s58, 18
    s_add_u32 s58, s58, s49
    s_add_u32 m0, s50, 24576
    s_add_u32 s51, s58, 0
    buffer_load_dwordx4 v4, s[32:35], s51 offen lds
    s_add_u32 m0, s50, 25600
    s_add_u32 s51, s58, 32768
    buffer_load_dwordx4 v4, s[32:35], s51 offen lds
    s_waitcnt vmcnt(18)
    s_barrier
    s_add_u32 s58, s57, 12
    s_cmp_ge_u32 s58, 21
    s_cselect_b32 s56, 21, 0
    s_sub_u32 s58, s58, s56
    s_lshl_b32 s58, s58, 12
    s_add_u32 s58, s58, s46
    s_add_u32 m0, s48, 32768
    s_add_u32 s51, s58, 0
    buffer_load_dwordx4 v5, s[36:39], s51 offen sc1 lds
    s_add_u32 m0, s48, 33792
    s_add_u32 s51, s58, 1024
    buffer_load_dwordx4 v5, s[36:39], s51 offen sc1 lds
    s_add_u32 s58, s57, 16
    s_cmp_ge_u32 s58, 21
    s_cselect_b32 s56, 21, 0
    s_sub_u32 s58, s58, s56
    s_lshl_b32 s58, s58, 18
    s_add_u32 s58, s58, s49
    s_add_u32 m0, s50, 32768
    s_add_u32 s51, s58, 0
    buffer_load_dwordx4 v4, s[32:35], s51 offen lds
    s_add_u32 m0, s50, 33792
    s_add_u32 s51, s58, 32768
    buffer_load_dwordx4 v4, s[32:35], s51 offen lds
    s_waitcnt vmcnt(20)
    s_barrier
    s_add_u32 s58, s57, 13
    s_cmp_ge_u32 s58, 21
    s_cselect_b32 s56, 21, 0
    s_sub_u32 s58, s58, s56
    s_lshl_b32 s58, s58, 12
    s_add_u32 s58, s58, s46
    s_add_u32 m0, s48, 40960
    s_add_u32 s51, s58, 0
    buffer_load_dwordx4 v5, s[36:39], s51 offen sc1 lds
    s_add_u32 m0, s48, 41984
    s_add_u32 s51, s58, 1024
    buffer_load_dwordx4 v5, s[36:39], s51 offen sc1 lds
    s_add_u32 s58, s57, 17
    s_cmp_ge_u32 s58, 21
    s_cselect_b32 s56, 21, 0
    s_sub_u32 s58, s58, s56
    s_lshl_b32 s58, s58, 18
    s_add_u32 s58, s58, s49
    s_add_u32 m0, s50, 40960
    s_add_u32 s51, s58, 0
    buffer_load_dwordx4 v4, s[32:35], s51 offen lds
    s_add_u32 m0, s50, 41984
    s_add_u32 s51, s58, 32768
    buffer_load_dwordx4 v4, s[32:35], s51 offen lds
    s_waitcnt vmcnt(22)
    s_barrier
    s_add_u32 s58, s57, 14
    s_cmp_ge_u32 s58, 21
    s_cselect_b32 s56, 21, 0
    s_sub_u32 s58, s58, s56
    s_lshl_b32 s58, s58, 12
    s_add_u32 s58, s58, s46
    s_add_u32 m0, s48, 49152
    s_add_u32 s51, s58, 0
    buffer_load_dwordx4 v5, s[36:39], s51 offen sc1 lds
    s_add_u32 m0, s48, 50176
    s_add_u32 s51, s58, 1024
    buffer_load_dwordx4 v5, s[36:39], s51 offen sc1 lds
    s_add_u32 s58, s57, 18
    s_cmp_ge_u32 s58, 21
    s_cselect_b32 s56, 21, 0
    s_sub_u32 s58, s58, s56
    s_lshl_b32 s58, s58, 18
    s_add_u32 s58, s58, s49
    s_add_u32 m0, s50, 49152
    s_add_u32 s51, s58, 0
    buffer_load_dwordx4 v4, s[32:35], s51 offen lds
    s_add_u32 m0, s50, 50176
    s_add_u32 s51, s58, 32768
    buffer_load_dwordx4 v4, s[32:35], s51 offen lds
    s_waitcnt vmcnt(22)
    s_barrier
    s_add_u32 s58, s57, 15
    s_cmp_ge_u32 s58, 21
    s_cselect_b32 s56, 21, 0
    s_sub_u32 s58, s58, s56
    s_lshl_b32 s58, s58, 12
    s_add_u32 s58, s58, s46
    s_add_u32 m0, s48, 57344
    s_add_u32 s51, s58, 0
    buffer_load_dwordx4 v5, s[36:39], s51 offen sc1 lds
    s_add_u32 m0, s48, 58368
    s_add_u32 s51, s58, 1024
    buffer_load_dwordx4 v5, s[36:39], s51 offen sc1 lds
    s_add_u32 s58, s57, 19
    s_cmp_ge_u32 s58, 21
    s_cselect_b32 s56, 21, 0
    s_sub_u32 s58, s58, s56
    s_lshl_b32 s58, s58, 18
    s_add_u32 s58, s58, s49
    s_add_u32 m0, s50, 57344
    s_add_u32 s51, s58, 0
    buffer_load_dwordx4 v4, s[32:35], s51 offen lds
    s_add_u32 m0, s50, 58368
    s_add_u32 s51, s58, 32768
    buffer_load_dwordx4 v4, s[32:35], s51 offen lds
    s_waitcnt vmcnt(22)
    s_barrier
    s_add_u32 s58, s57, 16
    s_cmp_ge_u32 s58, 21
    s_cselect_b32 s56, 21, 0
    s_sub_u32 s58, s58, s56
    s_lshl_b32 s58, s58, 12
    s_add_u32 s58, s58, s46
    s_add_u32 m0, s48, 0
    s_add_u32 s51, s58, 0
    buffer_load_dwordx4 v5, s[36:39], s51 offen sc1 lds
    s_add_u32 m0, s48, 1024
    s_add_u32 s51, s58, 1024
    buffer_load_dwordx4 v5, s[36:39], s51 offen sc1 lds
    s_add_u32 s58, s57, 20
    s_cmp_ge_u32 s58, 21
    s_cselect_b32 s56, 21, 0
    s_sub_u32 s58, s58, s56
    s_lshl_b32 s58, s58, 18
    s_add_u32 s58, s58, s49
    s_add_u32 m0, s50, 65536
    s_add_u32 s51, s58, 0
    buffer_load_dwordx4 v4, s[32:35], s51 offen lds
    s_add_u32 m0, s50, 66560
    s_add_u32 s51, s58, 32768
    buffer_load_dwordx4 v4, s[32:35], s51 offen lds
    s_waitcnt vmcnt(22)
    s_barrier
    s_add_u32 s58, s57, 17
    s_cmp_ge_u32 s58, 21
    s_cselect_b32 s56, 21, 0
    s_sub_u32 s58, s58, s56
    s_lshl_b32 s58, s58, 12
    s_add_u32 s58, s58, s46
    s_add_u32 m0, s48, 8192
    s_add_u32 s51, s58, 0
    buffer_load_dwordx4 v5, s[36:39], s51 offen sc1 lds
    s_add_u32 m0, s48, 9216
    s_add_u32 s51, s58, 1024
    buffer_load_dwordx4 v5, s[36:39], s51 offen sc1 lds
    s_mov_b32 s58, 21
    s_lshl_b32 s58, s58, 18
    s_add_u32 s58, s58, s49
    s_add_u32 m0, s50, 73728
    s_add_u32 s51, s58, 0
    buffer_load_dwordx4 v4, s[32:35], s51 offen lds
    s_add_u32 m0, s50, 74752
    s_add_u32 s51, s58, 32768
    buffer_load_dwordx4 v4, s[32:35], s51 offen lds
    s_waitcnt vmcnt(22)
    s_barrier
    s_add_u32 s58, s57, 18
    s_cmp_ge_u32 s58, 21
    s_cselect_b32 s56, 21, 0
    s_sub_u32 s58, s58, s56
    s_lshl_b32 s58, s58, 12
    s_add_u32 s58, s58, s46
    s_add_u32 m0, s48, 16384
    s_add_u32 s51, s58, 0
    buffer_load_dwordx4 v5, s[36:39], s51 offen sc1 lds
    s_add_u32 m0, s48, 17408
    s_add_u32 s51, s58, 1024
    buffer_load_dwordx4 v5, s[36:39], s51 offen sc1 lds
    s_waitcnt vmcnt(20)
    s_barrier
    s_add_u32 s58, s57, 19
    s_cmp_ge_u32 s58, 21
    s_cselect_b32 s56, 21, 0
    s_sub_u32 s58, s58, s56
    s_lshl_b32 s58, s58, 12
    s_add_u32 s58, s58, s46
    s_add_u32 m0, s48, 24576
    s_add_u32 s51, s58, 0
    buffer_load_dwordx4 v5, s[36:39], s51 offen sc1 lds
    s_add_u32 m0, s48, 25600
    s_add_u32 s51, s58, 1024
    buffer_load_dwordx4 v5, s[36:39], s51 offen sc1 lds
    s_waitcnt vmcnt(18)
    s_barrier
    s_add_u32 s58, s57, 20
    s_cmp_ge_u32 s58, 21
    s_cselect_b32 s56, 21, 0
    s_sub_u32 s58, s58, s56
    s_lshl_b32 s58, s58, 12
    s_add_u32 s58, s58, s46
    s_add_u32 m0, s48, 32768
    s_add_u32 s51, s58, 0
    buffer_load_dwordx4 v5, s[36:39], s51 offen sc1 lds
    s_add_u32 m0, s48, 33792
    s_add_u32 s51, s58, 1024
    buffer_load_dwordx4 v5, s[36:39], s51 offen sc1 lds
    s_waitcnt vmcnt(16)
    s_barrier
    s_mov_b32 s58, 21
    s_lshl_b32 s58, s58, 12
    s_add_u32 s58, s58, s46
    s_add_u32 m0, s48, 40960
    s_add_u32 s51, s58, 0
    buffer_load_dwordx4 v5, s[36:39], s51 offen sc1 lds
    s_add_u32 m0, s48, 41984
    s_add_u32 s51, s58, 1024
    buffer_load_dwordx4 v5, s[36:39], s51 offen sc1 lds
    s_waitcnt vmcnt(14)
    s_barrier
    s_waitcnt vmcnt(10)
    s_barrier
    s_waitcnt vmcnt(6)
    s_barrier
    s_waitcnt vmcnt(4)
    s_barrier
    s_waitcnt vmcnt(2)
    s_barrier
    s_waitcnt vmcnt(0)
    s_barrier
L_fin:
L_end:
    s_endpgm
.section .rodata,"a"
.p2align 6
.amdhsa_kernel sequential_preLN__mha_block__mixer_token_mlp__prompt_kernel
  .amdhsa_next_free_vgpr 256
  .amdhsa_next_free_sgpr 102
  .amdhsa_accum_offset 256
  .amdhsa_group_segment_fixed_size 0
  .amdhsa_kernarg_size 88
  .amdhsa_user_sgpr_count 2
  .amdhsa_user_sgpr_kernarg_segment_ptr 1
  .amdhsa_system_sgpr_workgroup_id_x 1
  .amdhsa_float_denorm_mode_32 3
  .amdhsa_float_denorm_mode_16_64 3
.end_amdhsa_kernel
```
